```python
import torch

def _softmax(x, axis=-1):
    return torch.softmax(x, dim=axis)
def _gelu(x):
    return torch.nn.functional.gelu(x, approximate="tanh")
def _silu(x):
    return torch.nn.functional.silu(x)
def _sigmoid(x):
    return torch.sigmoid(x)
def _layernorm(x, axis=-1, eps=1e-5):
    m = x.mean(dim=axis, keepdim=True)
    v = x.var(dim=axis, keepdim=True, unbiased=False)
    return (x - m) / torch.sqrt(v + eps)
def _scatter_add(tgt, idx, src, axis=0):
    return tgt.clone().index_add_(axis, idx, src)
def _segment_sum(src, seg, n):
    out = torch.zeros((n,) + src.shape[1:], dtype=src.dtype)
    return out.index_add_(0, seg, src)
def _pad(x, pw):
    flat = tuple(v for pair in reversed(pw) for v in pair)
    return torch.nn.functional.pad(x, flat)

kernel_name = 'parallel_sum__mha_block__glu_gated_swiglu__prompt'

def setup_inputs():

    _w = (lambda a: (lambda t: t.to(torch.bfloat16) if t.is_floating_point() else t)(torch.as_tensor(a)))
    def _A_setup():
        B, S, D, H = 1, 2048, 512, 32
        return {
            "x": _w((lambda *s: torch.randn(*s, dtype=torch.bfloat16) * 0.05)(B, S, D)),
            "wqkv": _w((lambda *s: torch.randn(*s, dtype=torch.bfloat16) * 0.05)(D, 3 * D)),
            "wo": _w((lambda *s: torch.randn(*s, dtype=torch.bfloat16) * 0.05)(D, D)),
        }
    _A_in = _A_setup()

    def _B_setup():
        B, S, D, F = 1, 2048, 512, 1792
        return {
            "x": _w((lambda *s: torch.randn(*s, dtype=torch.bfloat16) * 0.05)(B, S, D)),
            "w1": _w((lambda *s: torch.randn(*s, dtype=torch.bfloat16) * 0.4)(D, F) * (2.0 / D) ** 0.5),
            "w3": _w((lambda *s: torch.randn(*s, dtype=torch.bfloat16) * 0.4)(D, F) * (2.0 / D) ** 0.5),
            "w2": _w((lambda *s: torch.randn(*s, dtype=torch.bfloat16) * 0.4)(F, D) * (2.0 / F) ** 0.5),
        }
    _B_in = _B_setup()

    return {
        "A_x": _A_in["x"],
        "A_wqkv": _A_in["wqkv"],
        "A_wo": _A_in["wo"],
        "B_x": _B_in["x"],
        "B_w1": _B_in["w1"],
        "B_w3": _B_in["w3"],
        "B_w2": _B_in["w2"],
    }

def reference(A_x, A_wqkv, A_wo, B_x, B_w1, B_w3, B_w2):
    def _A_ref(x, wqkv, wo):
        B, S, D = x.shape
        H = 32
        Dh = D // H
        qkv = (lambda x, *d: x.permute(*d))((x @ wqkv).reshape(B, S, 3, H, Dh), 2, 0, 3, 1, 4)
        q, k, v = qkv[0], qkv[1], qkv[2]
        scores = torch.einsum("bhqd,bhkd->bhqk", q, k) * (Dh ** -0.5)
        p = _softmax(scores, axis=-1)
        o = torch.einsum("bhqk,bhkd->bhqd", p, v)
        return (lambda x, *d: x.permute(*d))(o, 0, 2, 1, 3).reshape(B, S, D) @ wo

    def _B_ref(x, w1, w3, w2):
        gate = torch.einsum("bsd,df->bsf", x, w1)
        up = torch.einsum("bsd,df->bsf", x, w3)
        h = _silu(gate) * up
        out = torch.einsum("bsf,fd->bsd", h, w2)
        return out

    x = A_x
    xn = _layernorm(x, axis=-1)
    return x + _A_ref(xn, A_wqkv, A_wo) + _B_ref(xn, B_w1, B_w3, B_w2)
```

```asm
; @launch grid=(512,1,1) block=(256,1,1) lds=81920
.amdgcn_target "amdgcn-amd-amdhsa--gfx950"
.text
.globl parallel_sum__mha_block__glu_gated_swiglu__prompt_kernel
.p2align 8
.type parallel_sum__mha_block__glu_gated_swiglu__prompt_kernel,@function
parallel_sum__mha_block__glu_gated_swiglu__prompt_kernel:
L_code_begin:
    s_cmp_ge_u32 s2, 512
    s_cbranch_scc1 L_end
    s_load_dwordx4 s[68:71], s[0:1], 0
    s_load_dwordx4 s[72:75], s[0:1], 32
    s_load_dwordx4 s[76:79], s[0:1], 64
    s_mov_b32 s3, 0x20000
    v_and_b32 v1, 63, v0
    v_lshrrev_b32 v2, 6, v0
    s_cmp_lt_u32 s2, 256
    v_readfirstlane_b32 s32, v2
    s_cbranch_scc1 L_g
    s_bfe_u32 s36, s2, 0x50003
    s_cmp_lg_u32 s32, 0
    s_cbranch_scc1 L_a_wpf
    s_getpc_b64 s[6:7]
L_a_pc:
    s_lshl_b32 s37, s36, 7
    v_and_b32 v8, 15, v0
    v_lshlrev_b32 v8, 12, v8
    v_add_u32 v8, s37, v8
    v_min_u32 v8, L_code_end-L_a_pc-4, v8
    global_load_dword v40, v8, s[6:7]
    s_branch L_attn
L_a_wpf:
    s_branch L_attn
L_g:
    s_bfe_u32 s37, s2, 0x20001
    s_and_b32 s38, s2, 1
    s_lshl_b32 s38, s38, 2
    s_or_b32 s37, s37, s38
    s_lshr_b32 s38, s2, 3
    s_and_b32 s35, s37, 3
    s_lshl_b32 s35, s35, 2
    s_and_b32 s39, s38, 3
    s_add_u32 s35, s35, s39
    s_lshr_b32 s40, s38, 2
    s_add_u32 s34, s39, s40
    s_and_b32 s34, s34, 3
    s_lshl_b32 s53, s34, 1
    s_mul_i32 s61, s32, 20480
    s_lshl_b32 s65, s35, 2
    s_add_u32 s65, s65, s32
    s_lshl_b32 s66, s65, 15
    v_lshrrev_b32 v224, 3, v1
    v_and_b32 v225, 7, v1
    v_lshrrev_b32 v226, 4, v1
    v_xor_b32 v227, v225, v226
    v_lshlrev_b32 v227, 4, v227
    v_lshl_add_u32 v13, v224, 10, v227
    v_xor_b32 v14, 64, v13
    v_add_u32 v18, 14336, v13
    v_add_u32 v19, 21504, v14
    v_add_u32 v14, 7168, v14
    s_mov_b32 s10, 2097152
    s_mov_b32 s11, 0x20000
    s_mov_b32 s14, 1572864
    s_mov_b32 s15, 0x20000
    s_lshr_b32 s36, s37, 2
    s_lshl_b32 s36, s36, 3
    s_add_u32 s36, s36, s40
    v_lshlrev_b32 v226, 2, v226
    v_and_b32 v226, 4, v226
    v_xor_b32 v225, v225, v226
    v_lshlrev_b32 v225, 4, v225
    v_mul_u32_u24 v226, 3072, v224
    s_mul_i32 s40, s32, 49152
    s_lshl_b32 s37, s36, 7
    s_add_u32 s67, s37, s40
    v_add3_u32 v6, v226, v225, s67
    v_add_u32 v20, 23552, v6
    s_waitcnt lgkmcnt(0)
    s_mov_b32 s8, s68
    s_mov_b32 s9, s69
    s_mov_b32 s12, s70
    s_mov_b32 s13, s71
    s_add_u32 m0, s61, 0
    s_lshl_b32 s39, s53, 7
    s_add_u32 s39, s39, s66
    buffer_load_dwordx4 v13, s[8:11], s39 offen offset:0 lds
    buffer_load_dwordx4 v14, s[8:11], s39 offen offset:1024 lds
    buffer_load_dwordx4 v18, s[8:11], s39 offen offset:2048 lds
    buffer_load_dwordx4 v19, s[8:11], s39 offen offset:3072 lds
    s_add_u32 m0, s61, 8192
    s_mul_i32 s37, s53, 196608
    buffer_load_dwordx4 v6, s[12:15], s37 offen lds
    s_add_u32 s53, s53, 1
    buffer_load_dwordx4 v20, s[12:15], s37 offen offset:1024 lds
    s_and_b32 s53, s53, 7
    s_add_u32 m0, s61, 4096
    s_lshl_b32 s39, s53, 7
    s_add_u32 s39, s39, s66
    buffer_load_dwordx4 v13, s[8:11], s39 offen offset:0 lds
    buffer_load_dwordx4 v14, s[8:11], s39 offen offset:1024 lds
    buffer_load_dwordx4 v18, s[8:11], s39 offen offset:2048 lds
    buffer_load_dwordx4 v19, s[8:11], s39 offen offset:3072 lds
    v_lshrrev_b32 v232, 5, v1
    v_bfe_u32 v233, v1, 4, 1
    v_bfe_u32 v234, v1, 2, 2
    v_and_b32 v235, 3, v1
    v_lshl_add_u32 v236, v232, 3, v234
    v_lshlrev_b32 v237, 7, v236
    v_lshl_add_u32 v237, v235, 3, v237
    v_and_b32 v12, 2, v234
    v_xor_b32 v12, v12, v233
    v_lshl_add_u32 v237, v12, 5, v237
    s_and_b32 s25, s32, 2
    s_lshl_b32 s38, s25, 5
    s_mul_i32 s25, s25, 20480
    s_sub_u32 s26, 40960, s25
    s_and_b32 s27, s32, 1
    s_lshl_b32 s27, s27, 6
    v_lshl_add_u32 v12, v233, 11, v237
    v_xor_b32 v237, s27, v237
    v_add_u32 v8, s25, v237
    v_add_u32 v11, s26, v237
    v_xor_b32 v9, 64, v8
    v_xor_b32 v26, 64, v11
    v_lshlrev_b32 v237, 6, v236
    v_lshl_add_u32 v237, v233, 5, v237
    v_lshl_add_u32 v237, v235, 3, v237
    v_add_u32 v10, s25, v237
    v_add_u32 v27, s61, v237
    v_and_b32 v236, 31, v1
    v_bfe_u32 v237, v1, 1, 3
    v_xor_b32 v237, v237, v232
    v_lshlrev_b32 v237, 4, v237
    v_lshl_add_u32 v236, v236, 7, v237
    v_xor_b32 v236, s38, v236
    v_add_u32 v22, s61, v236
    v_xor_b32 v23, 32, v22
    v_xor_b32 v24, 64, v22
    v_xor_b32 v25, 96, v22
    s_mov_b32 s41, 0xffff0000
    s_mov_b32 s42, 0x3f803f80
    v_and_b32 v236, 15, v1
    v_lshlrev_b32 v237, 2, v233
    v_cmp_eq_u32 s[6:7], v236, v237
    v_mov_b32 v237, s42
    v_mov_b32 v28, 0
    v_mov_b32 v29, 0
    v_mov_b32 v30, 0
    v_mov_b32 v31, 0
    v_mov_b32 v32, 0
    v_mov_b32 v33, 0
    v_mov_b32 v34, 0
    v_mov_b32 v35, 0
    v_cndmask_b32 v124, 0, v237, s[6:7]
    v_cndmask_b32 v125, 0, v237, s[6:7]
    v_cndmask_b32 v126, 0, v237, s[6:7]
    v_cndmask_b32 v127, 0, v237, s[6:7]
    s_add_u32 m0, s61, 10240
    s_mul_i32 s37, s53, 196608
    buffer_load_dwordx4 v6, s[12:15], s37 offen lds
    s_add_u32 s53, s53, 1
    buffer_load_dwordx4 v20, s[12:15], s37 offen offset:1024 lds
    s_and_b32 s53, s53, 7
    v_lshrrev_b32 v228, 2, v1
    v_and_b32 v229, 3, v1
    v_lshlrev_b32 v229, 4, v229
    v_mul_u32_u24 v228, 3072, v228
    s_lshl_b32 s67, s36, 6
    s_add_u32 s67, s67, s40
    s_add_u32 s67, s67, 2048
    v_add3_u32 v7, v228, v229, s67
    s_mov_b32 s28, s78
    s_mov_b32 s29, s79
    s_mov_b32 s30, 268435456
    s_mov_b32 s31, 0x20000
    s_mov_b32 s4, s76
    s_mov_b32 s5, s77
    s_mov_b32 s16, s72
    s_mov_b32 s17, s73
    s_mov_b32 s18, 1835008
    s_mov_b32 s19, 0x20000
    s_mov_b32 s20, s74
    s_mov_b32 s21, s75
    s_mov_b32 s22, 1835008
    s_mov_b32 s23, 0x20000
    s_lshl_b32 s40, s34, 1
    s_mul_i32 s45, s40, 229376
    s_add_u32 s40, s40, 1
    s_and_b32 s40, s40, 7
    s_mul_i32 s46, s40, 229376
    s_add_u32 s40, s40, 1
    s_and_b32 s40, s40, 7
    s_mul_i32 s47, s40, 229376
    s_add_u32 s40, s40, 1
    s_and_b32 s40, s40, 7
    s_mul_i32 s48, s40, 229376
    s_add_u32 s40, s40, 1
    s_and_b32 s40, s40, 7
    s_mul_i32 s49, s40, 229376
    s_add_u32 s40, s40, 1
    s_and_b32 s40, s40, 7
    s_mul_i32 s50, s40, 229376
    s_add_u32 s40, s40, 1
    s_and_b32 s40, s40, 7
    s_mul_i32 s51, s40, 229376
    s_add_u32 s40, s40, 1
    s_and_b32 s40, s40, 7
    s_mul_i32 s52, s40, 229376
    s_mov_b32 s44, 0xbfb8aa3b
    v_mul_u32_u24 v224, 3584, v224
    s_mul_i32 s40, s32, 57344
    s_lshl_b32 s67, s36, 7
    s_add_u32 s67, s67, s40
    v_add3_u32 v2, v224, v225, s67
    v_xor_b32 v227, 32, v225
    v_add3_u32 v3, v224, v227, s67
    v_lshlrev_b32 v15, 4, v1
    v_and_b32 v224, 0x33, v1
    v_and_b32 v225, 4, v1
    v_lshl_or_b32 v224, v225, 1, v224
    v_and_b32 v225, 8, v1
    v_lshrrev_b32 v225, 1, v225
    v_or_b32 v224, v224, v225
    v_lshlrev_b32 v16, 4, v224
    v_and_b32 v224, 15, v1
    v_lshlrev_b32 v224, 4, v224
    v_lshl_add_u32 v224, v232, 8, v224
    v_lshl_add_u32 v17, v233, 17, v224
    s_mul_i32 s62, s65, 147456
    s_add_u32 s62, s62, 6324224
    s_lshl_b32 s64, s36, 18
    s_lshl_b32 s38, s65, 11
    s_add_u32 s64, s64, s38
    s_add_u32 s64, s64, 2097152
    s_and_b32 s40, s36, 7
    s_lshl_b32 s40, s40, 18
    s_lshl_b32 s38, s65, 10
    s_add_u32 s40, s40, s38
    s_lshl_b32 s38, s40, 1
    s_add_u32 s38, s38, 2097152
    s_cmp_lt_u32 s36, 8
    s_cselect_b32 s63, s40, s38
    s_mov_b32 s38, 0x10000
    s_cselect_b32 s24, s38, 0x20000
    s_cselect_b32 s43, 0x3eb8aa3b, 1.0
    s_cselect_b64 s[6:7], -1, 0
    v_cndmask_b32 v16, v16, v15, s[6:7]
    s_lshl_b32 s38, s24, 1
    s_mul_i32 s40, s24, -3
    s_cmp_eq_u32 s27, 0
    s_cselect_b32 s38, 0, s38
    s_cselect_b32 s54, s24, s40
    s_add_u32 s63, s63, s38
    s_lshl_b32 s38, s36, 13
    s_lshl_b32 s40, s65, 7
    s_add_u32 s38, s38, s40
    s_add_u32 s55, s38, 16777216
    s_add_u32 m0, s61, 16384
    s_lshl_b32 s39, s53, 7
    s_add_u32 s39, s39, s66
    buffer_load_dwordx4 v13, s[8:11], s39 offen offset:0 lds
    buffer_load_dwordx4 v14, s[8:11], s39 offen offset:1024 lds
    buffer_load_dwordx4 v18, s[8:11], s39 offen offset:2048 lds
    buffer_load_dwordx4 v19, s[8:11], s39 offen offset:3072 lds
    s_add_u32 m0, s61, 12288
    s_mul_i32 s37, s53, 196608
    buffer_load_dwordx4 v6, s[12:15], s37 offen lds
    s_add_u32 s53, s53, 1
    buffer_load_dwordx4 v20, s[12:15], s37 offen offset:1024 lds
    s_and_b32 s53, s53, 7
    s_waitcnt vmcnt(12)
    s_barrier
    ds_read_b128 v[128:131], v22 offset:0
    ds_read_b128 v[132:135], v23 offset:0
    ds_read_b128 v[136:139], v24 offset:0
    ds_read_b128 v[140:143], v25 offset:0
    ds_read_b64_tr_b16 v[36:37], v8 offset:8192
    ds_read_b64_tr_b16 v[38:39], v8 offset:8704
    ds_read_b64_tr_b16 v[40:41], v9 offset:8192
    ds_read_b64_tr_b16 v[42:43], v9 offset:8704
    ds_read_b64_tr_b16 v[44:45], v8 offset:28672
    ds_read_b64_tr_b16 v[46:47], v8 offset:29184
    ds_read_b64_tr_b16 v[48:49], v9 offset:28672
    ds_read_b64_tr_b16 v[50:51], v9 offset:29184
    ds_read_b64_tr_b16 v[52:53], v11 offset:8192
    ds_read_b64_tr_b16 v[54:55], v11 offset:8704
    s_waitcnt lgkmcnt(8)
    s_add_u32 m0, s61, 0
    s_lshl_b32 s39, s53, 7
    s_add_u32 s39, s39, s66
    buffer_load_dwordx4 v13, s[8:11], s39 offen offset:0 lds
    v_dot2c_f32_bf16 v32, v128, v128
    v_dot2c_f32_bf16 v33, v129, v129
    v_dot2c_f32_bf16 v34, v130, v130
    v_dot2c_f32_bf16 v35, v131, v131
    v_dot2c_f32_bf16 v32, v132, v132
    v_dot2c_f32_bf16 v33, v133, v133
    v_dot2c_f32_bf16 v34, v134, v134
    v_dot2c_f32_bf16 v35, v135, v135
    v_dot2c_f32_bf16 v32, v136, v136
    v_dot2c_f32_bf16 v33, v137, v137
    v_dot2c_f32_bf16 v34, v138, v138
    v_dot2c_f32_bf16 v35, v139, v139
    v_dot2c_f32_bf16 v32, v140, v140
    v_dot2c_f32_bf16 v33, v141, v141
    v_dot2c_f32_bf16 v34, v142, v142
    v_dot2c_f32_bf16 v35, v143, v143
    v_mfma_f32_16x16x32_bf16 v[120:123], v[124:127], v[128:131], 0
    buffer_load_dwordx4 v14, s[8:11], s39 offen offset:1024 lds
    v_mfma_f32_16x16x32_bf16 v[120:123], v[124:127], v[132:135], v[120:123]
    buffer_load_dwordx4 v18, s[8:11], s39 offen offset:2048 lds
    v_mfma_f32_16x16x32_bf16 v[120:123], v[124:127], v[136:139], v[120:123]
    buffer_load_dwordx4 v19, s[8:11], s39 offen offset:3072 lds
    v_mfma_f32_16x16x32_bf16 v[120:123], v[124:127], v[140:143], v[120:123]
    v_mfma_f32_32x32x16_bf16 v[64:79], v[36:39], v[128:131], 0
    s_waitcnt lgkmcnt(6)
    ds_read_b64_tr_b16 v[56:57], v26 offset:8192
    ds_read_b64_tr_b16 v[58:59], v26 offset:8704
    v_mfma_f32_16x16x32_bf16 v[112:115], v[124:127], v[36:39], 0
    v_mfma_f32_32x32x16_bf16 v[80:95], v[40:43], v[128:131], 0
    s_waitcnt lgkmcnt(6)
    ds_read_b64_tr_b16 v[60:61], v11 offset:28672
    ds_read_b64_tr_b16 v[62:63], v11 offset:29184
    v_mfma_f32_32x32x16_bf16 v[64:79], v[44:47], v[132:135], v[64:79]
    s_waitcnt lgkmcnt(6)
    ds_read_b64_tr_b16 v[36:37], v26 offset:28672
    ds_read_b64_tr_b16 v[38:39], v26 offset:29184
    v_mfma_f32_16x16x32_bf16 v[112:115], v[124:127], v[44:47], v[112:115]
    v_mfma_f32_32x32x16_bf16 v[80:95], v[48:51], v[132:135], v[80:95]
    s_waitcnt lgkmcnt(6)
    s_waitcnt vmcnt(10)
    s_barrier
    ds_read_b128 v[144:147], v22 offset:4096
    ds_read_b128 v[148:151], v23 offset:4096
    ds_read_b128 v[152:155], v24 offset:4096
    ds_read_b128 v[156:159], v25 offset:4096
    ds_read_b64_tr_b16 v[40:41], v8 offset:10240
    ds_read_b64_tr_b16 v[42:43], v8 offset:10752
    v_mfma_f32_32x32x16_bf16 v[64:79], v[52:55], v[136:139], v[64:79]
    s_waitcnt lgkmcnt(10)
    ds_read_b64_tr_b16 v[44:45], v9 offset:10240
    ds_read_b64_tr_b16 v[46:47], v9 offset:10752
    s_add_u32 m0, s61, 14336
    s_mul_i32 s37, s53, 196608
    buffer_load_dwordx4 v6, s[12:15], s37 offen lds
    s_add_u32 s53, s53, 1
    v_mfma_f32_32x32x16_bf16 v[80:95], v[56:59], v[136:139], v[80:95]
    s_waitcnt lgkmcnt(10)
    ds_read_b64_tr_b16 v[48:49], v8 offset:30720
    ds_read_b64_tr_b16 v[50:51], v8 offset:31232
    buffer_load_dwordx4 v20, s[12:15], s37 offen offset:1024 lds
    s_and_b32 s53, s53, 7
    v_mfma_f32_32x32x16_bf16 v[64:79], v[60:63], v[140:143], v[64:79]
    s_waitcnt lgkmcnt(10)
    ds_read_b64_tr_b16 v[52:53], v9 offset:30720
    ds_read_b64_tr_b16 v[54:55], v9 offset:31232
    v_mfma_f32_32x32x16_bf16 v[80:95], v[36:39], v[140:143], v[80:95]
    ds_read_b64_tr_b16 v[56:57], v11 offset:10240
    ds_read_b64_tr_b16 v[58:59], v11 offset:10752
    s_waitcnt lgkmcnt(8)
    s_add_u32 m0, s61, 4096
    s_lshl_b32 s39, s53, 7
    s_add_u32 s39, s39, s66
    buffer_load_dwordx4 v13, s[8:11], s39 offen offset:0 lds
    v_dot2c_f32_bf16 v32, v144, v144
    v_dot2c_f32_bf16 v33, v145, v145
    v_dot2c_f32_bf16 v34, v146, v146
    v_dot2c_f32_bf16 v35, v147, v147
    v_dot2c_f32_bf16 v32, v148, v148
    v_dot2c_f32_bf16 v33, v149, v149
    v_dot2c_f32_bf16 v34, v150, v150
    v_dot2c_f32_bf16 v35, v151, v151
    v_dot2c_f32_bf16 v32, v152, v152
    v_dot2c_f32_bf16 v33, v153, v153
    v_dot2c_f32_bf16 v34, v154, v154
    v_dot2c_f32_bf16 v35, v155, v155
    v_dot2c_f32_bf16 v32, v156, v156
    v_dot2c_f32_bf16 v33, v157, v157
    v_dot2c_f32_bf16 v34, v158, v158
    v_dot2c_f32_bf16 v35, v159, v159
    v_mfma_f32_16x16x32_bf16 v[120:123], v[124:127], v[144:147], v[120:123]
    buffer_load_dwordx4 v14, s[8:11], s39 offen offset:1024 lds
    v_mfma_f32_16x16x32_bf16 v[120:123], v[124:127], v[148:151], v[120:123]
    buffer_load_dwordx4 v18, s[8:11], s39 offen offset:2048 lds
    v_mfma_f32_16x16x32_bf16 v[120:123], v[124:127], v[152:155], v[120:123]
    buffer_load_dwordx4 v19, s[8:11], s39 offen offset:3072 lds
    v_mfma_f32_16x16x32_bf16 v[120:123], v[124:127], v[156:159], v[120:123]
    v_mfma_f32_32x32x16_bf16 v[64:79], v[40:43], v[144:147], v[64:79]
    s_waitcnt lgkmcnt(6)
    ds_read_b64_tr_b16 v[60:61], v26 offset:10240
    ds_read_b64_tr_b16 v[62:63], v26 offset:10752
    v_mfma_f32_16x16x32_bf16 v[112:115], v[124:127], v[40:43], v[112:115]
    v_mfma_f32_32x32x16_bf16 v[80:95], v[44:47], v[144:147], v[80:95]
    s_waitcnt lgkmcnt(6)
    ds_read_b64_tr_b16 v[36:37], v11 offset:30720
    ds_read_b64_tr_b16 v[38:39], v11 offset:31232
    v_mfma_f32_32x32x16_bf16 v[64:79], v[48:51], v[148:151], v[64:79]
    s_waitcnt lgkmcnt(6)
    ds_read_b64_tr_b16 v[40:41], v26 offset:30720
    ds_read_b64_tr_b16 v[42:43], v26 offset:31232
    v_mfma_f32_16x16x32_bf16 v[112:115], v[124:127], v[48:51], v[112:115]
    v_mfma_f32_32x32x16_bf16 v[80:95], v[52:55], v[148:151], v[80:95]
    s_waitcnt lgkmcnt(6)
    s_waitcnt vmcnt(10)
    s_barrier
    ds_read_b128 v[160:163], v22 offset:16384
    ds_read_b128 v[164:167], v23 offset:16384
    ds_read_b128 v[168:171], v24 offset:16384
    ds_read_b128 v[172:175], v25 offset:16384
    ds_read_b64_tr_b16 v[44:45], v8 offset:12288
    ds_read_b64_tr_b16 v[46:47], v8 offset:12800
    v_mfma_f32_32x32x16_bf16 v[64:79], v[56:59], v[152:155], v[64:79]
    s_waitcnt lgkmcnt(10)
    ds_read_b64_tr_b16 v[48:49], v9 offset:12288
    ds_read_b64_tr_b16 v[50:51], v9 offset:12800
    s_add_u32 m0, s61, 8192
    s_mul_i32 s37, s53, 196608
    buffer_load_dwordx4 v6, s[12:15], s37 offen lds
    s_add_u32 s53, s53, 1
    v_mfma_f32_32x32x16_bf16 v[80:95], v[60:63], v[152:155], v[80:95]
    s_waitcnt lgkmcnt(10)
    ds_read_b64_tr_b16 v[52:53], v8 offset:32768
    ds_read_b64_tr_b16 v[54:55], v8 offset:33280
    buffer_load_dwordx4 v20, s[12:15], s37 offen offset:1024 lds
    s_and_b32 s53, s53, 7
    v_mfma_f32_32x32x16_bf16 v[64:79], v[36:39], v[156:159], v[64:79]
    s_waitcnt lgkmcnt(10)
    ds_read_b64_tr_b16 v[56:57], v9 offset:32768
    ds_read_b64_tr_b16 v[58:59], v9 offset:33280
    v_mfma_f32_32x32x16_bf16 v[80:95], v[40:43], v[156:159], v[80:95]
    ds_read_b64_tr_b16 v[60:61], v11 offset:12288
    ds_read_b64_tr_b16 v[62:63], v11 offset:12800
    s_waitcnt lgkmcnt(8)
    s_add_u32 m0, s61, 16384
    s_lshl_b32 s39, s53, 7
    s_add_u32 s39, s39, s66
    buffer_load_dwordx4 v13, s[8:11], s39 offen offset:0 lds
    v_dot2c_f32_bf16 v32, v160, v160
    v_dot2c_f32_bf16 v33, v161, v161
    v_dot2c_f32_bf16 v34, v162, v162
    v_dot2c_f32_bf16 v35, v163, v163
    v_dot2c_f32_bf16 v32, v164, v164
    v_dot2c_f32_bf16 v33, v165, v165
    v_dot2c_f32_bf16 v34, v166, v166
    v_dot2c_f32_bf16 v35, v167, v167
    v_dot2c_f32_bf16 v32, v168, v168
    v_dot2c_f32_bf16 v33, v169, v169
    v_dot2c_f32_bf16 v34, v170, v170
    v_dot2c_f32_bf16 v35, v171, v171
    v_dot2c_f32_bf16 v32, v172, v172
    v_dot2c_f32_bf16 v33, v173, v173
    v_dot2c_f32_bf16 v34, v174, v174
    v_dot2c_f32_bf16 v35, v175, v175
    v_mfma_f32_16x16x32_bf16 v[120:123], v[124:127], v[160:163], v[120:123]
    buffer_load_dwordx4 v14, s[8:11], s39 offen offset:1024 lds
    v_mfma_f32_16x16x32_bf16 v[120:123], v[124:127], v[164:167], v[120:123]
    buffer_load_dwordx4 v18, s[8:11], s39 offen offset:2048 lds
    v_mfma_f32_16x16x32_bf16 v[120:123], v[124:127], v[168:171], v[120:123]
    buffer_load_dwordx4 v19, s[8:11], s39 offen offset:3072 lds
    v_mfma_f32_16x16x32_bf16 v[120:123], v[124:127], v[172:175], v[120:123]
    v_mfma_f32_32x32x16_bf16 v[64:79], v[44:47], v[160:163], v[64:79]
    s_waitcnt lgkmcnt(6)
    ds_read_b64_tr_b16 v[36:37], v26 offset:12288
    ds_read_b64_tr_b16 v[38:39], v26 offset:12800
    v_mfma_f32_16x16x32_bf16 v[112:115], v[124:127], v[44:47], v[112:115]
    v_mfma_f32_32x32x16_bf16 v[80:95], v[48:51], v[160:163], v[80:95]
    s_waitcnt lgkmcnt(6)
    ds_read_b64_tr_b16 v[40:41], v11 offset:32768
    ds_read_b64_tr_b16 v[42:43], v11 offset:33280
    v_mfma_f32_32x32x16_bf16 v[64:79], v[52:55], v[164:167], v[64:79]
    s_waitcnt lgkmcnt(6)
    ds_read_b64_tr_b16 v[44:45], v26 offset:32768
    ds_read_b64_tr_b16 v[46:47], v26 offset:33280
    v_mfma_f32_16x16x32_bf16 v[112:115], v[124:127], v[52:55], v[112:115]
    v_mfma_f32_32x32x16_bf16 v[80:95], v[56:59], v[164:167], v[80:95]
    s_waitcnt lgkmcnt(6)
    s_waitcnt vmcnt(10)
    s_barrier
    ds_read_b128 v[176:179], v22 offset:0
    ds_read_b128 v[180:183], v23 offset:0
    ds_read_b128 v[184:187], v24 offset:0
    ds_read_b128 v[188:191], v25 offset:0
    ds_read_b64_tr_b16 v[48:49], v8 offset:14336
    ds_read_b64_tr_b16 v[50:51], v8 offset:14848
    v_mfma_f32_32x32x16_bf16 v[64:79], v[60:63], v[168:171], v[64:79]
    s_waitcnt lgkmcnt(10)
    ds_read_b64_tr_b16 v[52:53], v9 offset:14336
    ds_read_b64_tr_b16 v[54:55], v9 offset:14848
    s_add_u32 m0, s61, 10240
    s_mul_i32 s37, s53, 196608
    buffer_load_dwordx4 v6, s[12:15], s37 offen lds
    s_add_u32 s53, s53, 1
    v_mfma_f32_32x32x16_bf16 v[80:95], v[36:39], v[168:171], v[80:95]
    s_waitcnt lgkmcnt(10)
    ds_read_b64_tr_b16 v[56:57], v8 offset:34816
    ds_read_b64_tr_b16 v[58:59], v8 offset:35328
    buffer_load_dwordx4 v20, s[12:15], s37 offen offset:1024 lds
    s_and_b32 s53, s53, 7
    v_mfma_f32_32x32x16_bf16 v[64:79], v[40:43], v[172:175], v[64:79]
    s_waitcnt lgkmcnt(10)
    ds_read_b64_tr_b16 v[60:61], v9 offset:34816
    ds_read_b64_tr_b16 v[62:63], v9 offset:35328
    v_mfma_f32_32x32x16_bf16 v[80:95], v[44:47], v[172:175], v[80:95]
    ds_read_b64_tr_b16 v[36:37], v11 offset:14336
    ds_read_b64_tr_b16 v[38:39], v11 offset:14848
    s_waitcnt lgkmcnt(8)
    s_add_u32 m0, s61, 0
    s_lshl_b32 s39, s53, 7
    s_add_u32 s39, s39, s66
    buffer_load_dwordx4 v13, s[8:11], s39 offen offset:0 lds
    v_dot2c_f32_bf16 v32, v176, v176
    v_dot2c_f32_bf16 v33, v177, v177
    v_dot2c_f32_bf16 v34, v178, v178
    v_dot2c_f32_bf16 v35, v179, v179
    v_dot2c_f32_bf16 v32, v180, v180
    v_dot2c_f32_bf16 v33, v181, v181
    v_dot2c_f32_bf16 v34, v182, v182
    v_dot2c_f32_bf16 v35, v183, v183
    v_dot2c_f32_bf16 v32, v184, v184
    v_dot2c_f32_bf16 v33, v185, v185
    v_dot2c_f32_bf16 v34, v186, v186
    v_dot2c_f32_bf16 v35, v187, v187
    v_dot2c_f32_bf16 v32, v188, v188
    v_dot2c_f32_bf16 v33, v189, v189
    v_dot2c_f32_bf16 v34, v190, v190
    v_dot2c_f32_bf16 v35, v191, v191
    v_mfma_f32_16x16x32_bf16 v[120:123], v[124:127], v[176:179], v[120:123]
    buffer_load_dwordx4 v14, s[8:11], s39 offen offset:1024 lds
    v_mfma_f32_16x16x32_bf16 v[120:123], v[124:127], v[180:183], v[120:123]
    buffer_load_dwordx4 v18, s[8:11], s39 offen offset:2048 lds
    v_mfma_f32_16x16x32_bf16 v[120:123], v[124:127], v[184:187], v[120:123]
    buffer_load_dwordx4 v19, s[8:11], s39 offen offset:3072 lds
    v_mfma_f32_16x16x32_bf16 v[120:123], v[124:127], v[188:191], v[120:123]
    v_mfma_f32_32x32x16_bf16 v[64:79], v[48:51], v[176:179], v[64:79]
    s_waitcnt lgkmcnt(6)
    ds_read_b64_tr_b16 v[40:41], v26 offset:14336
    ds_read_b64_tr_b16 v[42:43], v26 offset:14848
    v_mfma_f32_16x16x32_bf16 v[112:115], v[124:127], v[48:51], v[112:115]
    v_mfma_f32_32x32x16_bf16 v[80:95], v[52:55], v[176:179], v[80:95]
    s_waitcnt lgkmcnt(6)
    ds_read_b64_tr_b16 v[44:45], v11 offset:34816
    ds_read_b64_tr_b16 v[46:47], v11 offset:35328
    v_mfma_f32_32x32x16_bf16 v[64:79], v[56:59], v[180:183], v[64:79]
    s_waitcnt lgkmcnt(6)
    ds_read_b64_tr_b16 v[48:49], v26 offset:34816
    ds_read_b64_tr_b16 v[50:51], v26 offset:35328
    v_mfma_f32_16x16x32_bf16 v[112:115], v[124:127], v[56:59], v[112:115]
    v_mfma_f32_32x32x16_bf16 v[80:95], v[60:63], v[180:183], v[80:95]
    s_waitcnt lgkmcnt(6)
    s_waitcnt vmcnt(10)
    s_barrier
    ds_read_b128 v[192:195], v22 offset:4096
    ds_read_b128 v[196:199], v23 offset:4096
    ds_read_b128 v[200:203], v24 offset:4096
    ds_read_b128 v[204:207], v25 offset:4096
    ds_read_b64_tr_b16 v[52:53], v8 offset:8192
    ds_read_b64_tr_b16 v[54:55], v8 offset:8704
    v_mfma_f32_32x32x16_bf16 v[64:79], v[36:39], v[184:187], v[64:79]
    s_waitcnt lgkmcnt(10)
    ds_read_b64_tr_b16 v[56:57], v9 offset:8192
    ds_read_b64_tr_b16 v[58:59], v9 offset:8704
    s_add_u32 m0, s61, 12288
    s_mul_i32 s37, s53, 196608
    buffer_load_dwordx4 v6, s[12:15], s37 offen lds
    s_add_u32 s53, s53, 1
    v_mfma_f32_32x32x16_bf16 v[80:95], v[40:43], v[184:187], v[80:95]
    s_waitcnt lgkmcnt(10)
    ds_read_b64_tr_b16 v[60:61], v8 offset:28672
    ds_read_b64_tr_b16 v[62:63], v8 offset:29184
    buffer_load_dwordx4 v20, s[12:15], s37 offen offset:1024 lds
    s_and_b32 s53, s53, 7
    v_mfma_f32_32x32x16_bf16 v[64:79], v[44:47], v[188:191], v[64:79]
    s_waitcnt lgkmcnt(10)
    ds_read_b64_tr_b16 v[36:37], v9 offset:28672
    ds_read_b64_tr_b16 v[38:39], v9 offset:29184
    v_mfma_f32_32x32x16_bf16 v[80:95], v[48:51], v[188:191], v[80:95]
    ds_read_b64_tr_b16 v[40:41], v11 offset:8192
    ds_read_b64_tr_b16 v[42:43], v11 offset:8704
    s_waitcnt lgkmcnt(8)
    s_add_u32 m0, s61, 4096
    s_lshl_b32 s39, s53, 7
    s_add_u32 s39, s39, s66
    buffer_load_dwordx4 v13, s[8:11], s39 offen offset:0 lds
    v_dot2c_f32_bf16 v32, v192, v192
    v_dot2c_f32_bf16 v33, v193, v193
    v_dot2c_f32_bf16 v34, v194, v194
    v_dot2c_f32_bf16 v35, v195, v195
    v_dot2c_f32_bf16 v32, v196, v196
    v_dot2c_f32_bf16 v33, v197, v197
    v_dot2c_f32_bf16 v34, v198, v198
    v_dot2c_f32_bf16 v35, v199, v199
    v_dot2c_f32_bf16 v32, v200, v200
    v_dot2c_f32_bf16 v33, v201, v201
    v_dot2c_f32_bf16 v34, v202, v202
    v_dot2c_f32_bf16 v35, v203, v203
    v_dot2c_f32_bf16 v32, v204, v204
    v_dot2c_f32_bf16 v33, v205, v205
    v_dot2c_f32_bf16 v34, v206, v206
    v_dot2c_f32_bf16 v35, v207, v207
    v_mfma_f32_16x16x32_bf16 v[120:123], v[124:127], v[192:195], v[120:123]
    buffer_load_dwordx4 v14, s[8:11], s39 offen offset:1024 lds
    v_mfma_f32_16x16x32_bf16 v[120:123], v[124:127], v[196:199], v[120:123]
    buffer_load_dwordx4 v18, s[8:11], s39 offen offset:2048 lds
    v_mfma_f32_16x16x32_bf16 v[120:123], v[124:127], v[200:203], v[120:123]
    buffer_load_dwordx4 v19, s[8:11], s39 offen offset:3072 lds
    v_mfma_f32_16x16x32_bf16 v[120:123], v[124:127], v[204:207], v[120:123]
    v_mfma_f32_32x32x16_bf16 v[64:79], v[52:55], v[192:195], v[64:79]
    s_waitcnt lgkmcnt(6)
    ds_read_b64_tr_b16 v[44:45], v26 offset:8192
    ds_read_b64_tr_b16 v[46:47], v26 offset:8704
    v_mfma_f32_16x16x32_bf16 v[112:115], v[124:127], v[52:55], v[112:115]
    v_mfma_f32_32x32x16_bf16 v[80:95], v[56:59], v[192:195], v[80:95]
    s_waitcnt lgkmcnt(6)
    ds_read_b64_tr_b16 v[48:49], v11 offset:28672
    ds_read_b64_tr_b16 v[50:51], v11 offset:29184
    v_mfma_f32_32x32x16_bf16 v[64:79], v[60:63], v[196:199], v[64:79]
    s_waitcnt lgkmcnt(6)
    ds_read_b64_tr_b16 v[52:53], v26 offset:28672
    ds_read_b64_tr_b16 v[54:55], v26 offset:29184
    v_mfma_f32_16x16x32_bf16 v[112:115], v[124:127], v[60:63], v[112:115]
    v_mfma_f32_32x32x16_bf16 v[80:95], v[36:39], v[196:199], v[80:95]
    s_waitcnt lgkmcnt(6)
    s_waitcnt vmcnt(10)
    s_barrier
    ds_read_b128 v[208:211], v22 offset:16384
    ds_read_b128 v[212:215], v23 offset:16384
    ds_read_b128 v[216:219], v24 offset:16384
    ds_read_b128 v[220:223], v25 offset:16384
    ds_read_b64_tr_b16 v[56:57], v8 offset:10240
    ds_read_b64_tr_b16 v[58:59], v8 offset:10752
    v_mfma_f32_32x32x16_bf16 v[64:79], v[40:43], v[200:203], v[64:79]
    s_waitcnt lgkmcnt(10)
    ds_read_b64_tr_b16 v[60:61], v9 offset:10240
    ds_read_b64_tr_b16 v[62:63], v9 offset:10752
    s_add_u32 m0, s61, 14336
    s_mul_i32 s37, s53, 196608
    buffer_load_dwordx4 v6, s[12:15], s37 offen lds
    s_add_u32 s53, s53, 1
    v_mfma_f32_32x32x16_bf16 v[80:95], v[44:47], v[200:203], v[80:95]
    s_waitcnt lgkmcnt(10)
    ds_read_b64_tr_b16 v[36:37], v8 offset:30720
    ds_read_b64_tr_b16 v[38:39], v8 offset:31232
    buffer_load_dwordx4 v20, s[12:15], s37 offen offset:1024 lds
    s_and_b32 s53, s53, 7
    v_mfma_f32_32x32x16_bf16 v[64:79], v[48:51], v[204:207], v[64:79]
    s_waitcnt lgkmcnt(10)
    ds_read_b64_tr_b16 v[40:41], v9 offset:30720
    ds_read_b64_tr_b16 v[42:43], v9 offset:31232
    v_mfma_f32_32x32x16_bf16 v[80:95], v[52:55], v[204:207], v[80:95]
    ds_read_b64_tr_b16 v[44:45], v11 offset:10240
    ds_read_b64_tr_b16 v[46:47], v11 offset:10752
    s_waitcnt lgkmcnt(8)
    s_add_u32 m0, s61, 16384
    s_mul_i32 s37, s53, 196608
    buffer_load_dwordx4 v7, s[12:15], s37 offen lds
    s_add_u32 s53, s53, 1
    s_and_b32 s53, s53, 7
    v_dot2c_f32_bf16 v32, v208, v208
    v_dot2c_f32_bf16 v33, v209, v209
    v_dot2c_f32_bf16 v34, v210, v210
    v_dot2c_f32_bf16 v35, v211, v211
    v_dot2c_f32_bf16 v32, v212, v212
    v_dot2c_f32_bf16 v33, v213, v213
    v_dot2c_f32_bf16 v34, v214, v214
    v_dot2c_f32_bf16 v35, v215, v215
    v_dot2c_f32_bf16 v32, v216, v216
    v_dot2c_f32_bf16 v33, v217, v217
    v_dot2c_f32_bf16 v34, v218, v218
    v_dot2c_f32_bf16 v35, v219, v219
    v_dot2c_f32_bf16 v32, v220, v220
    v_dot2c_f32_bf16 v33, v221, v221
    v_dot2c_f32_bf16 v34, v222, v222
    v_dot2c_f32_bf16 v35, v223, v223
    v_mfma_f32_16x16x32_bf16 v[120:123], v[124:127], v[208:211], v[120:123]
    s_add_u32 m0, s61, 17408
    s_mul_i32 s37, s53, 196608
    buffer_load_dwordx4 v7, s[12:15], s37 offen lds
    s_add_u32 s53, s53, 1
    s_and_b32 s53, s53, 7
    v_mfma_f32_16x16x32_bf16 v[120:123], v[124:127], v[212:215], v[120:123]
    s_add_u32 m0, s61, 18432
    s_mul_i32 s37, s53, 196608
    buffer_load_dwordx4 v7, s[12:15], s37 offen lds
    s_add_u32 s53, s53, 1
    s_and_b32 s53, s53, 7
    v_mfma_f32_16x16x32_bf16 v[120:123], v[124:127], v[216:219], v[120:123]
    s_add_u32 m0, s61, 19456
    s_mul_i32 s37, s53, 196608
    buffer_load_dwordx4 v7, s[12:15], s37 offen lds
    s_add_u32 s53, s53, 1
    s_and_b32 s53, s53, 7
    v_mfma_f32_16x16x32_bf16 v[120:123], v[124:127], v[220:223], v[120:123]
    v_mfma_f32_32x32x16_bf16 v[64:79], v[56:59], v[208:211], v[64:79]
    s_waitcnt lgkmcnt(6)
    ds_read_b64_tr_b16 v[48:49], v26 offset:10240
    ds_read_b64_tr_b16 v[50:51], v26 offset:10752
    v_mfma_f32_16x16x32_bf16 v[112:115], v[124:127], v[56:59], v[112:115]
    v_mfma_f32_32x32x16_bf16 v[80:95], v[60:63], v[208:211], v[80:95]
    s_waitcnt lgkmcnt(6)
    ds_read_b64_tr_b16 v[52:53], v11 offset:30720
    ds_read_b64_tr_b16 v[54:55], v11 offset:31232
    v_mfma_f32_32x32x16_bf16 v[64:79], v[36:39], v[212:215], v[64:79]
    s_waitcnt lgkmcnt(6)
    ds_read_b64_tr_b16 v[56:57], v26 offset:30720
    ds_read_b64_tr_b16 v[58:59], v26 offset:31232
    v_mfma_f32_16x16x32_bf16 v[112:115], v[124:127], v[36:39], v[112:115]
    v_mfma_f32_32x32x16_bf16 v[80:95], v[40:43], v[212:215], v[80:95]
    s_waitcnt lgkmcnt(6)
    s_waitcnt vmcnt(10)
    s_barrier
    ds_read_b128 v[224:227], v22 offset:0
    ds_read_b128 v[228:231], v23 offset:0
    ds_read_b128 v[232:235], v24 offset:0
    ds_read_b128 v[236:239], v25 offset:0
    ds_read_b64_tr_b16 v[60:61], v8 offset:12288
    ds_read_b64_tr_b16 v[62:63], v8 offset:12800
    v_mfma_f32_32x32x16_bf16 v[64:79], v[44:47], v[216:219], v[64:79]
    s_waitcnt lgkmcnt(10)
    ds_read_b64_tr_b16 v[36:37], v9 offset:12288
    ds_read_b64_tr_b16 v[38:39], v9 offset:12800
    v_mfma_f32_32x32x16_bf16 v[80:95], v[48:51], v[216:219], v[80:95]
    s_waitcnt lgkmcnt(10)
    ds_read_b64_tr_b16 v[40:41], v8 offset:32768
    ds_read_b64_tr_b16 v[42:43], v8 offset:33280
    v_mfma_f32_32x32x16_bf16 v[64:79], v[52:55], v[220:223], v[64:79]
    s_waitcnt lgkmcnt(10)
    ds_read_b64_tr_b16 v[44:45], v9 offset:32768
    ds_read_b64_tr_b16 v[46:47], v9 offset:33280
    v_mfma_f32_32x32x16_bf16 v[80:95], v[56:59], v[220:223], v[80:95]
    ds_read_b64_tr_b16 v[48:49], v11 offset:12288
    ds_read_b64_tr_b16 v[50:51], v11 offset:12800
    s_waitcnt lgkmcnt(8)
    s_add_u32 m0, s61, 0
    s_mul_i32 s37, s53, 196608
    buffer_load_dwordx4 v7, s[12:15], s37 offen lds
    s_add_u32 s53, s53, 1
    s_and_b32 s53, s53, 7
    v_dot2c_f32_bf16 v32, v224, v224
    v_dot2c_f32_bf16 v33, v225, v225
    v_dot2c_f32_bf16 v34, v226, v226
    v_dot2c_f32_bf16 v35, v227, v227
    v_dot2c_f32_bf16 v32, v228, v228
    v_dot2c_f32_bf16 v33, v229, v229
    v_dot2c_f32_bf16 v34, v230, v230
    v_dot2c_f32_bf16 v35, v231, v231
    v_dot2c_f32_bf16 v32, v232, v232
    v_dot2c_f32_bf16 v33, v233, v233
    v_dot2c_f32_bf16 v34, v234, v234
    v_dot2c_f32_bf16 v35, v235, v235
    v_dot2c_f32_bf16 v32, v236, v236
    v_dot2c_f32_bf16 v33, v237, v237
    v_dot2c_f32_bf16 v34, v238, v238
    v_dot2c_f32_bf16 v35, v239, v239
    v_mfma_f32_16x16x32_bf16 v[120:123], v[124:127], v[224:227], v[120:123]
    s_add_u32 m0, s61, 1024
    s_mul_i32 s37, s53, 196608
    buffer_load_dwordx4 v7, s[12:15], s37 offen lds
    s_add_u32 s53, s53, 1
    s_and_b32 s53, s53, 7
    v_mfma_f32_16x16x32_bf16 v[120:123], v[124:127], v[228:231], v[120:123]
    s_add_u32 m0, s61, 2048
    s_mul_i32 s37, s53, 196608
    buffer_load_dwordx4 v7, s[12:15], s37 offen lds
    s_add_u32 s53, s53, 1
    s_and_b32 s53, s53, 7
    v_mfma_f32_16x16x32_bf16 v[120:123], v[124:127], v[232:235], v[120:123]
    s_add_u32 m0, s61, 3072
    s_mul_i32 s37, s53, 196608
    buffer_load_dwordx4 v7, s[12:15], s37 offen lds
    s_add_u32 s53, s53, 1
    s_and_b32 s53, s53, 7
    v_mfma_f32_16x16x32_bf16 v[120:123], v[124:127], v[236:239], v[120:123]
    v_mfma_f32_32x32x16_bf16 v[64:79], v[60:63], v[224:227], v[64:79]
    s_waitcnt lgkmcnt(6)
    ds_read_b64_tr_b16 v[52:53], v26 offset:12288
    ds_read_b64_tr_b16 v[54:55], v26 offset:12800
    v_mfma_f32_16x16x32_bf16 v[112:115], v[124:127], v[60:63], v[112:115]
    v_mfma_f32_32x32x16_bf16 v[80:95], v[36:39], v[224:227], v[80:95]
    s_waitcnt lgkmcnt(6)
    ds_read_b64_tr_b16 v[56:57], v11 offset:32768
    ds_read_b64_tr_b16 v[58:59], v11 offset:33280
    v_mfma_f32_32x32x16_bf16 v[64:79], v[40:43], v[228:231], v[64:79]
    s_waitcnt lgkmcnt(6)
    ds_read_b64_tr_b16 v[60:61], v26 offset:32768
    ds_read_b64_tr_b16 v[62:63], v26 offset:33280
    v_mfma_f32_16x16x32_bf16 v[112:115], v[124:127], v[40:43], v[112:115]
    v_mfma_f32_32x32x16_bf16 v[80:95], v[44:47], v[228:231], v[80:95]
    s_waitcnt lgkmcnt(6)
    s_waitcnt vmcnt(8)
    s_barrier
    ds_read_b128 v[240:243], v22 offset:4096
    ds_read_b128 v[244:247], v23 offset:4096
    ds_read_b128 v[248:251], v24 offset:4096
    ds_read_b128 v[252:255], v25 offset:4096
    ds_read_b64_tr_b16 v[36:37], v8 offset:14336
    ds_read_b64_tr_b16 v[38:39], v8 offset:14848
    v_mfma_f32_32x32x16_bf16 v[64:79], v[48:51], v[232:235], v[64:79]
    s_waitcnt lgkmcnt(10)
    ds_read_b64_tr_b16 v[40:41], v9 offset:14336
    ds_read_b64_tr_b16 v[42:43], v9 offset:14848
    v_mov_b32 v13, 0
    global_load_dword v14, v13, s[4:5] sc1
    v_mfma_f32_32x32x16_bf16 v[80:95], v[52:55], v[232:235], v[80:95]
    s_waitcnt lgkmcnt(10)
    ds_read_b64_tr_b16 v[44:45], v8 offset:34816
    ds_read_b64_tr_b16 v[46:47], v8 offset:35328
    v_mfma_f32_32x32x16_bf16 v[64:79], v[56:59], v[236:239], v[64:79]
    s_waitcnt lgkmcnt(10)
    ds_read_b64_tr_b16 v[48:49], v9 offset:34816
    ds_read_b64_tr_b16 v[50:51], v9 offset:35328
    v_mfma_f32_32x32x16_bf16 v[80:95], v[60:63], v[236:239], v[80:95]
    ds_read_b64_tr_b16 v[52:53], v11 offset:14336
    ds_read_b64_tr_b16 v[54:55], v11 offset:14848
    s_waitcnt lgkmcnt(8)
    s_add_u32 m0, s61, 4096
    s_add_u32 s37, s45, 28672
    buffer_load_dwordx4 v2, s[16:19], s45 offen lds
    v_dot2c_f32_bf16 v32, v240, v240
    v_dot2c_f32_bf16 v33, v241, v241
    v_dot2c_f32_bf16 v34, v242, v242
    v_dot2c_f32_bf16 v35, v243, v243
    v_dot2c_f32_bf16 v32, v244, v244
    v_dot2c_f32_bf16 v33, v245, v245
    v_dot2c_f32_bf16 v34, v246, v246
    v_dot2c_f32_bf16 v35, v247, v247
    v_dot2c_f32_bf16 v32, v248, v248
    v_dot2c_f32_bf16 v33, v249, v249
    v_dot2c_f32_bf16 v34, v250, v250
    v_dot2c_f32_bf16 v35, v251, v251
    v_dot2c_f32_bf16 v32, v252, v252
    v_dot2c_f32_bf16 v33, v253, v253
    v_dot2c_f32_bf16 v34, v254, v254
    v_dot2c_f32_bf16 v35, v255, v255
    v_mfma_f32_16x16x32_bf16 v[120:123], v[124:127], v[240:243], v[120:123]
    s_add_u32 m0, m0, 1024
    s_nop 0
    buffer_load_dwordx4 v2, s[16:19], s37 offen lds
    v_mfma_f32_16x16x32_bf16 v[120:123], v[124:127], v[244:247], v[120:123]
    s_add_u32 m0, s61, 6144
    s_add_u32 s37, s45, 28672
    buffer_load_dwordx4 v3, s[20:23], s45 offen lds
    v_mfma_f32_16x16x32_bf16 v[120:123], v[124:127], v[248:251], v[120:123]
    s_add_u32 m0, m0, 1024
    s_nop 0
    buffer_load_dwordx4 v3, s[20:23], s37 offen lds
    v_mfma_f32_16x16x32_bf16 v[120:123], v[124:127], v[252:255], v[120:123]
    v_mfma_f32_32x32x16_bf16 v[64:79], v[36:39], v[240:243], v[64:79]
    s_waitcnt lgkmcnt(6)
    ds_read_b64_tr_b16 v[56:57], v26 offset:14336
    ds_read_b64_tr_b16 v[58:59], v26 offset:14848
    v_mfma_f32_16x16x32_bf16 v[112:115], v[124:127], v[36:39], v[112:115]
    v_lshlrev_b32 v22, 4, v1
    v_lshrrev_b32 v23, 5, v1
    v_lshl_add_u32 v22, v23, 10, v22
    s_lshl_b32 s38, s32, 2
    s_lshl_b32 s40, s27, 3
    v_mfma_f32_32x32x16_bf16 v[80:95], v[40:43], v[240:243], v[80:95]
    s_waitcnt lgkmcnt(6)
    ds_read_b64_tr_b16 v[60:61], v11 offset:34816
    ds_read_b64_tr_b16 v[62:63], v11 offset:35328
    v_add_f32 v32, v32, v33
    v_add_f32 v34, v34, v35
    v_add_f32 v32, v32, v34
    v_mov_b32 v28, v120
    v_mov_b32 v29, v28
    v_mov_b32 v33, v32
    v_mfma_f32_32x32x16_bf16 v[64:79], v[44:47], v[244:247], v[64:79]
    s_waitcnt lgkmcnt(6)
    ds_read_b64_tr_b16 v[36:37], v26 offset:34816
    ds_read_b64_tr_b16 v[38:39], v26 offset:35328
    v_mfma_f32_16x16x32_bf16 v[112:115], v[124:127], v[44:47], v[112:115]
    s_nop 1
    v_permlane32_swap_b32 v28, v29
    v_permlane32_swap_b32 v32, v33
    s_nop 1
    v_add_f32 v28, v28, v29
    v_add_f32 v32, v32, v33
    v_mfma_f32_32x32x16_bf16 v[80:95], v[48:51], v[244:247], v[80:95]
    s_waitcnt lgkmcnt(6)
    v_mul_f32 v28, 0x3b000000, v28
    v_mul_f32 v32, 0x3b000000, v32
    v_fma_f32 v32, -v28, v28, v32
    v_max_f32 v32, 0, v32
    v_cvt_pk_bf16_f32 v29, v28, v32
    v_cvt_pk_bf16_f32 v31, -v28, -v28
    v_mfma_f32_32x32x16_bf16 v[64:79], v[52:55], v[248:251], v[64:79]
    s_waitcnt lgkmcnt(4)
    s_and_b32 s60, s32, 2
    s_lshl_b32 s60, s60, 1
    s_add_u32 s60, s60, s40
    v_add_u32 v6, s60, v22
    v_add_u32 v22, s38, v22
    v_cvt_pk_bf16_f32 v113, v112, v112
    v_and_b32 v113, s41, v113
    v_sub_f32 v113, v112, v113
    v_cvt_pk_bf16_f32 v112, v112, v113
    v_mov_b32 v113, 0
    ds_write_b32 v6, v112 offset:8192
    ds_write_b32 v6, v113 offset:8200
    v_mfma_f32_32x32x16_bf16 v[80:95], v[56:59], v[248:251], v[80:95]
    s_waitcnt lgkmcnt(4)
    v_and_b32 v24, 31, v1
    v_lshlrev_b32 v25, 4, v24
    v_lshl_add_u32 v24, v24, 2, s61
    v_lshl_add_u32 v23, v23, 4, s61
    v_add_u32 v6, s40, v25
    v_xor_b32 v7, 512, v6
    v_mfma_f32_32x32x16_bf16 v[64:79], v[60:63], v[252:255], v[64:79]
    s_waitcnt lgkmcnt(2)
    s_waitcnt lgkmcnt(0)
    s_barrier
    ds_read_b128 v[112:115], v6 offset:8192
    ds_read_b128 v[116:119], v7 offset:8192
    v_and_b32 v30, s41, v29
    v_lshlrev_b32 v29, 16, v29
    v_add_f32 v30, 0x3727c5ac, v30
    v_cvt_pk_bf16_f32 v30, v30, v30
    v_and_b32 v30, s41, v30
    v_sqrt_f32 v30, v30
    v_mfma_f32_32x32x16_bf16 v[80:95], v[36:39], v[252:255], v[80:95]
    s_mov_b32 s6, -1
    s_mov_b32 s7, 0
    v_cvt_pk_bf16_f32 v30, v30, v30
    v_and_b32 v30, s41, v30
    v_rcp_f32 v18, v30
    v_cndmask_b32 v32, 0, v31, s[6:7]
    v_mov_b32 v19, v18
    v_mul_f32 v20, v29, v18
    v_mov_b32 v33, v32
    v_mov_b32 v34, v32
    v_mov_b32 v35, v32
    v_sub_f32 v20, 0, v20
    v_mul_f32 v28, s43, v18
    v_mov_b32 v21, v20
    ds_write_b32 v24, v18 offset:11264
    s_sub_u32 s38, s26, s25
    v_add_u32 v8, s38, v10
    s_waitcnt lgkmcnt(1)
    v_mfma_f32_32x32x16_bf16 v[64:79], v[112:115], v[32:35], v[64:79]
    v_mfma_f32_32x32x16_bf16 v[80:95], v[116:119], v[32:35], v[80:95]
    s_nop 7
    s_nop 2
    v_mul_f32 v64, v28, v64
    v_mul_f32 v65, v28, v65
    v_mul_f32 v66, v28, v66
    v_mul_f32 v67, v28, v67
    v_mul_f32 v68, v28, v68
    v_mul_f32 v69, v28, v69
    v_mul_f32 v70, v28, v70
    v_mul_f32 v71, v28, v71
    v_cvt_pk_bf16_f32 v64, v64, v65
    v_cvt_pk_bf16_f32 v65, v66, v67
    v_cvt_pk_bf16_f32 v66, v68, v69
    v_cvt_pk_bf16_f32 v67, v70, v71
    buffer_store_dwordx4 v[64:67], v16, s[28:31], s63 offen sc1
    s_add_u32 s63, s63, s24
    v_mul_f32 v72, v28, v72
    v_mul_f32 v73, v28, v73
    v_mul_f32 v74, v28, v74
    v_mul_f32 v75, v28, v75
    v_mul_f32 v76, v28, v76
    v_mul_f32 v77, v28, v77
    v_mul_f32 v78, v28, v78
    v_mul_f32 v79, v28, v79
    v_cvt_pk_bf16_f32 v72, v72, v73
    v_cvt_pk_bf16_f32 v73, v74, v75
    v_cvt_pk_bf16_f32 v74, v76, v77
    v_cvt_pk_bf16_f32 v75, v78, v79
    buffer_store_dwordx4 v[72:75], v16, s[28:31], s63 offen sc1
    s_add_u32 s63, s63, s54
    v_mul_f32 v80, v28, v80
    v_mul_f32 v81, v28, v81
    v_mul_f32 v82, v28, v82
    v_mul_f32 v83, v28, v83
    v_mul_f32 v84, v28, v84
    v_mul_f32 v85, v28, v85
    v_mul_f32 v86, v28, v86
    v_mul_f32 v87, v28, v87
    v_cvt_pk_bf16_f32 v80, v80, v81
    v_cvt_pk_bf16_f32 v81, v82, v83
    v_cvt_pk_bf16_f32 v82, v84, v85
    v_cvt_pk_bf16_f32 v83, v86, v87
    buffer_store_dwordx4 v[80:83], v16, s[28:31], s63 offen sc1
    s_add_u32 s63, s63, s24
    v_mul_f32 v88, v28, v88
    v_mul_f32 v89, v28, v89
    v_mul_f32 v90, v28, v90
    v_mul_f32 v91, v28, v91
    v_mul_f32 v92, v28, v92
    v_mul_f32 v93, v28, v93
    v_mul_f32 v94, v28, v94
    v_mul_f32 v95, v28, v95
    v_cvt_pk_bf16_f32 v88, v88, v89
    v_cvt_pk_bf16_f32 v89, v90, v91
    v_cvt_pk_bf16_f32 v90, v92, v93
    v_cvt_pk_bf16_f32 v91, v94, v95
    buffer_store_dwordx4 v[88:91], v16, s[28:31], s63 offen sc1
    s_add_u32 s63, s63, s54
    s_waitcnt vmcnt(9)
    s_barrier
    ds_read_b64_tr_b16 v[36:37], v27 offset:16384
    ds_read_b64_tr_b16 v[38:39], v27 offset:16640
    ds_read_b64_tr_b16 v[40:41], v27 offset:17408
    ds_read_b64_tr_b16 v[42:43], v27 offset:17664
    ds_read_b64_tr_b16 v[44:45], v27 offset:18432
    ds_read_b64_tr_b16 v[46:47], v27 offset:18688
    ds_read_b64_tr_b16 v[48:49], v27 offset:19456
    ds_read_b64_tr_b16 v[50:51], v27 offset:19712
    ds_read_b64_tr_b16 v[52:53], v27 offset:0
    ds_read_b64_tr_b16 v[54:55], v27 offset:256
    ds_read_b64_tr_b16 v[56:57], v27 offset:1024
    ds_read_b64_tr_b16 v[58:59], v27 offset:1280
    s_add_u32 m0, s61, 12288
    s_add_u32 s37, s46, 28672
    buffer_load_dwordx4 v2, s[16:19], s46 offen lds
    s_add_u32 m0, m0, 1024
    s_nop 0
    buffer_load_dwordx4 v2, s[16:19], s37 offen lds
    s_add_u32 m0, s61, 14336
    s_add_u32 s37, s46, 28672
    buffer_load_dwordx4 v3, s[20:23], s46 offen lds
    s_add_u32 m0, m0, 1024
    s_nop 0
    buffer_load_dwordx4 v3, s[20:23], s37 offen lds
    s_waitcnt lgkmcnt(10)
    v_mfma_f32_16x16x32_bf16 v[120:123], v[124:127], v[36:39], 0
    s_waitcnt lgkmcnt(8)
    ds_read_b64_tr_b16 v[60:61], v27 offset:2048
    ds_read_b64_tr_b16 v[62:63], v27 offset:2304
    v_mfma_f32_16x16x32_bf16 v[120:123], v[124:127], v[40:43], v[120:123]
    s_waitcnt lgkmcnt(8)
    ds_read_b64_tr_b16 v[36:37], v27 offset:3072
    ds_read_b64_tr_b16 v[38:39], v27 offset:3328
    v_mfma_f32_16x16x32_bf16 v[120:123], v[124:127], v[44:47], v[120:123]
    s_waitcnt lgkmcnt(8)
    ds_read_b64_tr_b16 v[40:41], v10 offset:16384
    ds_read_b64_tr_b16 v[42:43], v10 offset:16640
    v_mfma_f32_16x16x32_bf16 v[120:123], v[124:127], v[48:51], v[120:123]
    s_waitcnt lgkmcnt(8)
    ds_read_b64_tr_b16 v[44:45], v10 offset:36864
    ds_read_b64_tr_b16 v[46:47], v10 offset:37120
    v_mfma_f32_16x16x32_bf16 v[120:123], v[124:127], v[52:55], v[120:123]
    s_waitcnt lgkmcnt(8)
    ds_read_b64_tr_b16 v[48:49], v8 offset:16384
    ds_read_b64_tr_b16 v[50:51], v8 offset:16640
    v_mfma_f32_16x16x32_bf16 v[120:123], v[124:127], v[56:59], v[120:123]
    s_waitcnt lgkmcnt(8)
    ds_read_b64_tr_b16 v[52:53], v8 offset:36864
    ds_read_b64_tr_b16 v[54:55], v8 offset:37120
    v_mfma_f32_16x16x32_bf16 v[120:123], v[124:127], v[60:63], v[120:123]
    s_waitcnt lgkmcnt(8)
    ds_read_b64_tr_b16 v[56:57], v10 offset:17408
    ds_read_b64_tr_b16 v[58:59], v10 offset:17664
    v_mfma_f32_16x16x32_bf16 v[120:123], v[124:127], v[36:39], v[120:123]
    s_waitcnt lgkmcnt(8)
    ds_read_b64_tr_b16 v[60:61], v10 offset:37888
    ds_read_b64_tr_b16 v[62:63], v10 offset:38144
    v_mfma_f32_32x32x16_bf16 v[96:111], v[128:131], v[40:43], 0
    s_waitcnt lgkmcnt(8)
    ds_read_b64_tr_b16 v[36:37], v8 offset:17408
    ds_read_b64_tr_b16 v[38:39], v8 offset:17664
    v_mfma_f32_32x32x16_bf16 v[96:111], v[132:135], v[44:47], v[96:111]
    s_waitcnt lgkmcnt(8)
    ds_read_b64_tr_b16 v[40:41], v8 offset:37888
    ds_read_b64_tr_b16 v[42:43], v8 offset:38144
    v_mfma_f32_32x32x16_bf16 v[96:111], v[136:139], v[48:51], v[96:111]
    s_waitcnt lgkmcnt(8)
    ds_read_b64_tr_b16 v[44:45], v10 offset:18432
    ds_read_b64_tr_b16 v[46:47], v10 offset:18688
    v_mfma_f32_32x32x16_bf16 v[96:111], v[140:143], v[52:55], v[96:111]
    s_waitcnt lgkmcnt(8)
    ds_read_b64_tr_b16 v[48:49], v10 offset:38912
    ds_read_b64_tr_b16 v[50:51], v10 offset:39168
    v_cvt_pk_bf16_f32 v121, v120, v120
    v_and_b32 v121, s41, v121
    v_sub_f32 v121, v120, v121
    v_cvt_pk_bf16_f32 v120, v120, v121
    ds_write_b32 v22, v120 offset:9216
    v_mfma_f32_32x32x16_bf16 v[96:111], v[144:147], v[56:59], v[96:111]
    s_waitcnt lgkmcnt(9)
    ds_read_b64_tr_b16 v[52:53], v8 offset:18432
    ds_read_b64_tr_b16 v[54:55], v8 offset:18688
    v_mfma_f32_32x32x16_bf16 v[96:111], v[148:151], v[60:63], v[96:111]
    s_waitcnt lgkmcnt(9)
    ds_read_b64_tr_b16 v[56:57], v8 offset:38912
    ds_read_b64_tr_b16 v[58:59], v8 offset:39168
    v_mfma_f32_32x32x16_bf16 v[96:111], v[152:155], v[36:39], v[96:111]
    s_waitcnt lgkmcnt(9)
    ds_read_b64_tr_b16 v[60:61], v10 offset:19456
    ds_read_b64_tr_b16 v[62:63], v10 offset:19712
    v_mfma_f32_32x32x16_bf16 v[96:111], v[156:159], v[40:43], v[96:111]
    s_waitcnt lgkmcnt(9)
    ds_read_b64_tr_b16 v[36:37], v10 offset:39936
    ds_read_b64_tr_b16 v[38:39], v10 offset:40192
    v_mfma_f32_32x32x16_bf16 v[96:111], v[160:163], v[44:47], v[96:111]
    s_waitcnt lgkmcnt(9)
    ds_read_b64_tr_b16 v[40:41], v8 offset:19456
    ds_read_b64_tr_b16 v[42:43], v8 offset:19712
    v_mfma_f32_32x32x16_bf16 v[96:111], v[164:167], v[48:51], v[96:111]
    s_waitcnt lgkmcnt(8)
    ds_read_b64_tr_b16 v[44:45], v8 offset:39936
    ds_read_b64_tr_b16 v[46:47], v8 offset:40192
    v_mfma_f32_32x32x16_bf16 v[96:111], v[168:171], v[52:55], v[96:111]
    s_waitcnt lgkmcnt(8)
    ds_read_b64_tr_b16 v[48:49], v10 offset:0
    ds_read_b64_tr_b16 v[50:51], v10 offset:256
    v_mfma_f32_32x32x16_bf16 v[96:111], v[172:175], v[56:59], v[96:111]
    s_waitcnt lgkmcnt(8)
    ds_read_b64_tr_b16 v[52:53], v10 offset:20480
    ds_read_b64_tr_b16 v[54:55], v10 offset:20736
    v_mfma_f32_32x32x16_bf16 v[96:111], v[176:179], v[60:63], v[96:111]
    s_waitcnt lgkmcnt(8)
    ds_read_b64_tr_b16 v[56:57], v8 offset:0
    ds_read_b64_tr_b16 v[58:59], v8 offset:256
    s_barrier
    v_mfma_f32_32x32x16_bf16 v[96:111], v[180:183], v[36:39], v[96:111]
    s_waitcnt lgkmcnt(8)
    ds_read_b64_tr_b16 v[60:61], v8 offset:20480
    ds_read_b64_tr_b16 v[62:63], v8 offset:20736
    ds_read_b128 v[120:123], v25 offset:9216
    v_mfma_f32_32x32x16_bf16 v[96:111], v[184:187], v[40:43], v[96:111]
    s_waitcnt lgkmcnt(9)
    ds_read_b64_tr_b16 v[36:37], v10 offset:1024
    ds_read_b64_tr_b16 v[38:39], v10 offset:1280
    v_mfma_f32_32x32x16_bf16 v[96:111], v[188:191], v[44:47], v[96:111]
    s_waitcnt lgkmcnt(9)
    ds_read_b64_tr_b16 v[40:41], v10 offset:21504
    ds_read_b64_tr_b16 v[42:43], v10 offset:21760
    v_mfma_f32_32x32x16_bf16 v[96:111], v[192:195], v[48:51], v[96:111]
    s_waitcnt lgkmcnt(9)
    ds_read_b64_tr_b16 v[44:45], v8 offset:1024
    ds_read_b64_tr_b16 v[46:47], v8 offset:1280
    v_mfma_f32_32x32x16_bf16 v[96:111], v[196:199], v[52:55], v[96:111]
    s_waitcnt lgkmcnt(9)
    ds_read_b64_tr_b16 v[48:49], v8 offset:21504
    ds_read_b64_tr_b16 v[50:51], v8 offset:21760
    v_mfma_f32_32x32x16_bf16 v[96:111], v[200:203], v[56:59], v[96:111]
    s_waitcnt lgkmcnt(9)
    ds_read_b64_tr_b16 v[52:53], v10 offset:2048
    ds_read_b64_tr_b16 v[54:55], v10 offset:2304
    v_mfma_f32_32x32x16_bf16 v[96:111], v[204:207], v[60:63], v[96:111]
    s_waitcnt lgkmcnt(8)
    ds_read_b64_tr_b16 v[56:57], v10 offset:22528
    ds_read_b64_tr_b16 v[58:59], v10 offset:22784
    v_mfma_f32_32x32x16_bf16 v[96:111], v[208:211], v[36:39], v[96:111]
    s_waitcnt lgkmcnt(8)
    ds_read_b64_tr_b16 v[60:61], v8 offset:2048
    ds_read_b64_tr_b16 v[62:63], v8 offset:2304
    v_mfma_f32_32x32x16_bf16 v[96:111], v[212:215], v[40:43], v[96:111]
    s_waitcnt lgkmcnt(8)
    ds_read_b64_tr_b16 v[36:37], v8 offset:22528
    ds_read_b64_tr_b16 v[38:39], v8 offset:22784
    v_mfma_f32_32x32x16_bf16 v[96:111], v[216:219], v[44:47], v[96:111]
    s_waitcnt lgkmcnt(8)
    ds_read_b64_tr_b16 v[40:41], v10 offset:3072
    ds_read_b64_tr_b16 v[42:43], v10 offset:3328
    v_mfma_f32_32x32x16_bf16 v[96:111], v[220:223], v[48:51], v[96:111]
    s_waitcnt lgkmcnt(8)
    ds_read_b64_tr_b16 v[44:45], v10 offset:23552
    ds_read_b64_tr_b16 v[46:47], v10 offset:23808
    v_mfma_f32_32x32x16_bf16 v[96:111], v[224:227], v[52:55], v[96:111]
    s_waitcnt lgkmcnt(8)
    ds_read_b64_tr_b16 v[48:49], v8 offset:3072
    ds_read_b64_tr_b16 v[50:51], v8 offset:3328
    v_mfma_f32_32x32x16_bf16 v[96:111], v[228:231], v[56:59], v[96:111]
    s_waitcnt lgkmcnt(8)
    ds_read_b64_tr_b16 v[52:53], v8 offset:23552
    ds_read_b64_tr_b16 v[54:55], v8 offset:23808
    v_mfma_f32_32x32x16_bf16 v[96:111], v[232:235], v[60:63], v[96:111]
    s_waitcnt lgkmcnt(8)
    ds_read_b128 v[64:67], v23 offset:11264
    v_mfma_f32_32x32x16_bf16 v[96:111], v[236:239], v[36:39], v[96:111]
    s_waitcnt lgkmcnt(7)
    ds_read_b128 v[68:71], v23 offset:11296
    v_mfma_f32_32x32x16_bf16 v[96:111], v[240:243], v[40:43], v[96:111]
    s_waitcnt lgkmcnt(6)
    ds_read_b128 v[72:75], v23 offset:11328
    v_mfma_f32_32x32x16_bf16 v[96:111], v[244:247], v[44:47], v[96:111]
    s_waitcnt lgkmcnt(5)
    ds_read_b128 v[76:79], v23 offset:11360
    v_mfma_f32_32x32x16_bf16 v[96:111], v[248:251], v[48:51], v[96:111]
    s_waitcnt lgkmcnt(4)
    v_mfma_f32_32x32x16_bf16 v[96:111], v[252:255], v[52:55], v[96:111]
    v_mfma_f32_32x32x16_bf16 v[96:111], v[32:35], v[120:123], v[96:111]
    s_waitcnt lgkmcnt(0)
    s_barrier
    s_nop 7
    s_nop 1
    v_mul_f32 v96, v64, v96
    v_mul_f32 v97, v65, v97
    v_mul_f32 v98, v66, v98
    v_mul_f32 v99, v67, v99
    v_mul_f32 v100, v68, v100
    v_mul_f32 v101, v69, v101
    v_mul_f32 v102, v70, v102
    v_mul_f32 v103, v71, v103
    v_cvt_pk_bf16_f32 v96, v96, v97
    v_cvt_pk_bf16_f32 v97, v98, v99
    v_cvt_pk_bf16_f32 v98, v100, v101
    v_cvt_pk_bf16_f32 v99, v102, v103
    buffer_store_dwordx4 v[96:99], v17, s[28:31], s64 offen offset:1024 sc1
    v_mul_f32 v104, v72, v104
    v_mul_f32 v105, v73, v105
    v_mul_f32 v106, v74, v106
    v_mul_f32 v107, v75, v107
    v_mul_f32 v108, v76, v108
    v_mul_f32 v109, v77, v109
    v_mul_f32 v110, v78, v110
    v_mul_f32 v111, v79, v111
    v_cvt_pk_bf16_f32 v104, v104, v105
    v_cvt_pk_bf16_f32 v105, v106, v107
    v_cvt_pk_bf16_f32 v106, v108, v109
    v_cvt_pk_bf16_f32 v107, v110, v111
    buffer_store_dwordx4 v[104:107], v17, s[28:31], s64 offen offset:1536 sc1
    s_setprio 3
    v_mul_f32 v18, s44, v18
    v_mul_f32 v19, s44, v19
    v_mul_f32 v20, s44, v20
    v_mul_f32 v21, s44, v21
    s_mov_b32 s44, 0x40053526
    s_load_dwordx2 s[68:69], s[0:1], 16
    s_load_dwordx4 s[72:75], s[0:1], 48
    v_lshlrev_b32 v28, 16, v128
    v_and_b32 v29, s41, v128
    v_lshlrev_b32 v30, 16, v129
    v_and_b32 v31, s41, v129
    v_lshlrev_b32 v32, 16, v130
    v_and_b32 v33, s41, v130
    v_lshlrev_b32 v34, 16, v131
    v_and_b32 v35, s41, v131
    v_pk_fma_f32 v[28:29], v[28:29], v[18:19], v[20:21]
    v_pk_fma_f32 v[30:31], v[30:31], v[18:19], v[20:21]
    v_pk_fma_f32 v[32:33], v[32:33], v[18:19], v[20:21]
    v_pk_fma_f32 v[34:35], v[34:35], v[18:19], v[20:21]
    v_cvt_pk_bf16_f32 v128, v28, v29
    v_cvt_pk_bf16_f32 v129, v30, v31
    v_cvt_pk_bf16_f32 v130, v32, v33
    v_cvt_pk_bf16_f32 v131, v34, v35
    v_lshlrev_b32 v28, 16, v132
    v_and_b32 v29, s41, v132
    v_lshlrev_b32 v30, 16, v133
    v_and_b32 v31, s41, v133
    v_lshlrev_b32 v32, 16, v134
    v_and_b32 v33, s41, v134
    v_lshlrev_b32 v34, 16, v135
    v_and_b32 v35, s41, v135
    v_pk_fma_f32 v[28:29], v[28:29], v[18:19], v[20:21]
    v_pk_fma_f32 v[30:31], v[30:31], v[18:19], v[20:21]
    v_pk_fma_f32 v[32:33], v[32:33], v[18:19], v[20:21]
    v_pk_fma_f32 v[34:35], v[34:35], v[18:19], v[20:21]
    v_cvt_pk_bf16_f32 v132, v28, v29
    v_cvt_pk_bf16_f32 v133, v30, v31
    v_cvt_pk_bf16_f32 v134, v32, v33
    v_cvt_pk_bf16_f32 v135, v34, v35
    v_lshlrev_b32 v28, 16, v136
    v_and_b32 v29, s41, v136
    v_lshlrev_b32 v30, 16, v137
    v_and_b32 v31, s41, v137
    v_lshlrev_b32 v32, 16, v138
    v_and_b32 v33, s41, v138
    v_lshlrev_b32 v34, 16, v139
    v_and_b32 v35, s41, v139
    v_pk_fma_f32 v[28:29], v[28:29], v[18:19], v[20:21]
    v_pk_fma_f32 v[30:31], v[30:31], v[18:19], v[20:21]
    v_pk_fma_f32 v[32:33], v[32:33], v[18:19], v[20:21]
    v_pk_fma_f32 v[34:35], v[34:35], v[18:19], v[20:21]
    v_cvt_pk_bf16_f32 v136, v28, v29
    v_cvt_pk_bf16_f32 v137, v30, v31
    v_cvt_pk_bf16_f32 v138, v32, v33
    v_cvt_pk_bf16_f32 v139, v34, v35
    v_lshlrev_b32 v28, 16, v140
    v_and_b32 v29, s41, v140
    v_lshlrev_b32 v30, 16, v141
    v_and_b32 v31, s41, v141
    v_lshlrev_b32 v32, 16, v142
    v_and_b32 v33, s41, v142
    v_lshlrev_b32 v34, 16, v143
    v_and_b32 v35, s41, v143
    v_pk_fma_f32 v[28:29], v[28:29], v[18:19], v[20:21]
    v_pk_fma_f32 v[30:31], v[30:31], v[18:19], v[20:21]
    v_pk_fma_f32 v[32:33], v[32:33], v[18:19], v[20:21]
    v_pk_fma_f32 v[34:35], v[34:35], v[18:19], v[20:21]
    v_cvt_pk_bf16_f32 v140, v28, v29
    v_cvt_pk_bf16_f32 v141, v30, v31
    v_cvt_pk_bf16_f32 v142, v32, v33
    v_cvt_pk_bf16_f32 v143, v34, v35
    v_lshlrev_b32 v28, 16, v144
    v_and_b32 v29, s41, v144
    v_lshlrev_b32 v30, 16, v145
    v_and_b32 v31, s41, v145
    v_lshlrev_b32 v32, 16, v146
    v_and_b32 v33, s41, v146
    v_lshlrev_b32 v34, 16, v147
    v_and_b32 v35, s41, v147
    v_pk_fma_f32 v[28:29], v[28:29], v[18:19], v[20:21]
    v_pk_fma_f32 v[30:31], v[30:31], v[18:19], v[20:21]
    v_pk_fma_f32 v[32:33], v[32:33], v[18:19], v[20:21]
    v_pk_fma_f32 v[34:35], v[34:35], v[18:19], v[20:21]
    v_cvt_pk_bf16_f32 v144, v28, v29
    v_cvt_pk_bf16_f32 v145, v30, v31
    v_cvt_pk_bf16_f32 v146, v32, v33
    v_cvt_pk_bf16_f32 v147, v34, v35
    v_lshlrev_b32 v28, 16, v148
    v_and_b32 v29, s41, v148
    v_lshlrev_b32 v30, 16, v149
    v_and_b32 v31, s41, v149
    v_lshlrev_b32 v32, 16, v150
    v_and_b32 v33, s41, v150
    v_lshlrev_b32 v34, 16, v151
    v_and_b32 v35, s41, v151
    v_pk_fma_f32 v[28:29], v[28:29], v[18:19], v[20:21]
    v_pk_fma_f32 v[30:31], v[30:31], v[18:19], v[20:21]
    v_pk_fma_f32 v[32:33], v[32:33], v[18:19], v[20:21]
    v_pk_fma_f32 v[34:35], v[34:35], v[18:19], v[20:21]
    v_cvt_pk_bf16_f32 v148, v28, v29
    v_cvt_pk_bf16_f32 v149, v30, v31
    v_cvt_pk_bf16_f32 v150, v32, v33
    v_cvt_pk_bf16_f32 v151, v34, v35
    v_lshlrev_b32 v28, 16, v152
    v_and_b32 v29, s41, v152
    v_lshlrev_b32 v30, 16, v153
    v_and_b32 v31, s41, v153
    v_lshlrev_b32 v32, 16, v154
    v_and_b32 v33, s41, v154
    v_lshlrev_b32 v34, 16, v155
    v_and_b32 v35, s41, v155
    v_pk_fma_f32 v[28:29], v[28:29], v[18:19], v[20:21]
    v_pk_fma_f32 v[30:31], v[30:31], v[18:19], v[20:21]
    v_pk_fma_f32 v[32:33], v[32:33], v[18:19], v[20:21]
    v_pk_fma_f32 v[34:35], v[34:35], v[18:19], v[20:21]
    v_cvt_pk_bf16_f32 v152, v28, v29
    v_cvt_pk_bf16_f32 v153, v30, v31
    v_cvt_pk_bf16_f32 v154, v32, v33
    v_cvt_pk_bf16_f32 v155, v34, v35
    v_lshlrev_b32 v28, 16, v156
    v_and_b32 v29, s41, v156
    v_lshlrev_b32 v30, 16, v157
    v_and_b32 v31, s41, v157
    v_lshlrev_b32 v32, 16, v158
    v_and_b32 v33, s41, v158
    v_lshlrev_b32 v34, 16, v159
    v_and_b32 v35, s41, v159
    v_pk_fma_f32 v[28:29], v[28:29], v[18:19], v[20:21]
    v_pk_fma_f32 v[30:31], v[30:31], v[18:19], v[20:21]
    v_pk_fma_f32 v[32:33], v[32:33], v[18:19], v[20:21]
    v_pk_fma_f32 v[34:35], v[34:35], v[18:19], v[20:21]
    v_cvt_pk_bf16_f32 v156, v28, v29
    v_cvt_pk_bf16_f32 v157, v30, v31
    v_cvt_pk_bf16_f32 v158, v32, v33
    v_cvt_pk_bf16_f32 v159, v34, v35
    v_lshlrev_b32 v28, 16, v160
    v_and_b32 v29, s41, v160
    v_lshlrev_b32 v30, 16, v161
    v_and_b32 v31, s41, v161
    v_lshlrev_b32 v32, 16, v162
    v_and_b32 v33, s41, v162
    v_lshlrev_b32 v34, 16, v163
    v_and_b32 v35, s41, v163
    v_pk_fma_f32 v[28:29], v[28:29], v[18:19], v[20:21]
    v_pk_fma_f32 v[30:31], v[30:31], v[18:19], v[20:21]
    v_pk_fma_f32 v[32:33], v[32:33], v[18:19], v[20:21]
    v_pk_fma_f32 v[34:35], v[34:35], v[18:19], v[20:21]
    v_cvt_pk_bf16_f32 v160, v28, v29
    v_cvt_pk_bf16_f32 v161, v30, v31
    v_cvt_pk_bf16_f32 v162, v32, v33
    v_cvt_pk_bf16_f32 v163, v34, v35
    v_lshlrev_b32 v28, 16, v164
    v_and_b32 v29, s41, v164
    v_lshlrev_b32 v30, 16, v165
    v_and_b32 v31, s41, v165
    v_lshlrev_b32 v32, 16, v166
    v_and_b32 v33, s41, v166
    v_lshlrev_b32 v34, 16, v167
    v_and_b32 v35, s41, v167
    v_pk_fma_f32 v[28:29], v[28:29], v[18:19], v[20:21]
    v_pk_fma_f32 v[30:31], v[30:31], v[18:19], v[20:21]
    v_pk_fma_f32 v[32:33], v[32:33], v[18:19], v[20:21]
    v_pk_fma_f32 v[34:35], v[34:35], v[18:19], v[20:21]
    v_cvt_pk_bf16_f32 v164, v28, v29
    v_cvt_pk_bf16_f32 v165, v30, v31
    v_cvt_pk_bf16_f32 v166, v32, v33
    v_cvt_pk_bf16_f32 v167, v34, v35
    v_lshlrev_b32 v28, 16, v168
    v_and_b32 v29, s41, v168
    v_lshlrev_b32 v30, 16, v169
    v_and_b32 v31, s41, v169
    v_lshlrev_b32 v32, 16, v170
    v_and_b32 v33, s41, v170
    v_lshlrev_b32 v34, 16, v171
    v_and_b32 v35, s41, v171
    v_pk_fma_f32 v[28:29], v[28:29], v[18:19], v[20:21]
    v_pk_fma_f32 v[30:31], v[30:31], v[18:19], v[20:21]
    v_pk_fma_f32 v[32:33], v[32:33], v[18:19], v[20:21]
    v_pk_fma_f32 v[34:35], v[34:35], v[18:19], v[20:21]
    v_cvt_pk_bf16_f32 v168, v28, v29
    v_cvt_pk_bf16_f32 v169, v30, v31
    v_cvt_pk_bf16_f32 v170, v32, v33
    v_cvt_pk_bf16_f32 v171, v34, v35
    v_lshlrev_b32 v28, 16, v172
    v_and_b32 v29, s41, v172
    v_lshlrev_b32 v30, 16, v173
    v_and_b32 v31, s41, v173
    v_lshlrev_b32 v32, 16, v174
    v_and_b32 v33, s41, v174
    v_lshlrev_b32 v34, 16, v175
    v_and_b32 v35, s41, v175
    v_pk_fma_f32 v[28:29], v[28:29], v[18:19], v[20:21]
    v_pk_fma_f32 v[30:31], v[30:31], v[18:19], v[20:21]
    v_pk_fma_f32 v[32:33], v[32:33], v[18:19], v[20:21]
    v_pk_fma_f32 v[34:35], v[34:35], v[18:19], v[20:21]
    v_cvt_pk_bf16_f32 v172, v28, v29
    v_cvt_pk_bf16_f32 v173, v30, v31
    v_cvt_pk_bf16_f32 v174, v32, v33
    v_cvt_pk_bf16_f32 v175, v34, v35
    v_lshlrev_b32 v28, 16, v176
    v_and_b32 v29, s41, v176
    v_lshlrev_b32 v30, 16, v177
    v_and_b32 v31, s41, v177
    v_lshlrev_b32 v32, 16, v178
    v_and_b32 v33, s41, v178
    v_lshlrev_b32 v34, 16, v179
    v_and_b32 v35, s41, v179
    v_pk_fma_f32 v[28:29], v[28:29], v[18:19], v[20:21]
    v_pk_fma_f32 v[30:31], v[30:31], v[18:19], v[20:21]
    v_pk_fma_f32 v[32:33], v[32:33], v[18:19], v[20:21]
    v_pk_fma_f32 v[34:35], v[34:35], v[18:19], v[20:21]
    v_cvt_pk_bf16_f32 v176, v28, v29
    v_cvt_pk_bf16_f32 v177, v30, v31
    v_cvt_pk_bf16_f32 v178, v32, v33
    v_cvt_pk_bf16_f32 v179, v34, v35
    v_lshlrev_b32 v28, 16, v180
    v_and_b32 v29, s41, v180
    v_lshlrev_b32 v30, 16, v181
    v_and_b32 v31, s41, v181
    v_lshlrev_b32 v32, 16, v182
    v_and_b32 v33, s41, v182
    v_lshlrev_b32 v34, 16, v183
    v_and_b32 v35, s41, v183
    v_pk_fma_f32 v[28:29], v[28:29], v[18:19], v[20:21]
    v_pk_fma_f32 v[30:31], v[30:31], v[18:19], v[20:21]
    v_pk_fma_f32 v[32:33], v[32:33], v[18:19], v[20:21]
    v_pk_fma_f32 v[34:35], v[34:35], v[18:19], v[20:21]
    v_cvt_pk_bf16_f32 v180, v28, v29
    v_cvt_pk_bf16_f32 v181, v30, v31
    v_cvt_pk_bf16_f32 v182, v32, v33
    v_cvt_pk_bf16_f32 v183, v34, v35
    v_lshlrev_b32 v28, 16, v184
    v_and_b32 v29, s41, v184
    v_lshlrev_b32 v30, 16, v185
    v_and_b32 v31, s41, v185
    v_lshlrev_b32 v32, 16, v186
    v_and_b32 v33, s41, v186
    v_lshlrev_b32 v34, 16, v187
    v_and_b32 v35, s41, v187
    v_pk_fma_f32 v[28:29], v[28:29], v[18:19], v[20:21]
    v_pk_fma_f32 v[30:31], v[30:31], v[18:19], v[20:21]
    v_pk_fma_f32 v[32:33], v[32:33], v[18:19], v[20:21]
    v_pk_fma_f32 v[34:35], v[34:35], v[18:19], v[20:21]
    v_cvt_pk_bf16_f32 v184, v28, v29
    v_cvt_pk_bf16_f32 v185, v30, v31
    v_cvt_pk_bf16_f32 v186, v32, v33
    v_cvt_pk_bf16_f32 v187, v34, v35
    v_lshlrev_b32 v28, 16, v188
    v_and_b32 v29, s41, v188
    v_lshlrev_b32 v30, 16, v189
    v_and_b32 v31, s41, v189
    v_lshlrev_b32 v32, 16, v190
    v_and_b32 v33, s41, v190
    v_lshlrev_b32 v34, 16, v191
    v_and_b32 v35, s41, v191
    v_pk_fma_f32 v[28:29], v[28:29], v[18:19], v[20:21]
    v_pk_fma_f32 v[30:31], v[30:31], v[18:19], v[20:21]
    v_pk_fma_f32 v[32:33], v[32:33], v[18:19], v[20:21]
    v_pk_fma_f32 v[34:35], v[34:35], v[18:19], v[20:21]
    v_cvt_pk_bf16_f32 v188, v28, v29
    v_cvt_pk_bf16_f32 v189, v30, v31
    v_cvt_pk_bf16_f32 v190, v32, v33
    v_cvt_pk_bf16_f32 v191, v34, v35
    v_lshlrev_b32 v28, 16, v192
    v_and_b32 v29, s41, v192
    v_lshlrev_b32 v30, 16, v193
    v_and_b32 v31, s41, v193
    v_lshlrev_b32 v32, 16, v194
    v_and_b32 v33, s41, v194
    v_lshlrev_b32 v34, 16, v195
    v_and_b32 v35, s41, v195
    v_pk_fma_f32 v[28:29], v[28:29], v[18:19], v[20:21]
    v_pk_fma_f32 v[30:31], v[30:31], v[18:19], v[20:21]
    v_pk_fma_f32 v[32:33], v[32:33], v[18:19], v[20:21]
    v_pk_fma_f32 v[34:35], v[34:35], v[18:19], v[20:21]
    v_cvt_pk_bf16_f32 v192, v28, v29
    v_cvt_pk_bf16_f32 v193, v30, v31
    v_cvt_pk_bf16_f32 v194, v32, v33
    v_cvt_pk_bf16_f32 v195, v34, v35
    v_lshlrev_b32 v28, 16, v196
    v_and_b32 v29, s41, v196
    v_lshlrev_b32 v30, 16, v197
    v_and_b32 v31, s41, v197
    v_lshlrev_b32 v32, 16, v198
    v_and_b32 v33, s41, v198
    v_lshlrev_b32 v34, 16, v199
    v_and_b32 v35, s41, v199
    v_pk_fma_f32 v[28:29], v[28:29], v[18:19], v[20:21]
    v_pk_fma_f32 v[30:31], v[30:31], v[18:19], v[20:21]
    v_pk_fma_f32 v[32:33], v[32:33], v[18:19], v[20:21]
    v_pk_fma_f32 v[34:35], v[34:35], v[18:19], v[20:21]
    v_cvt_pk_bf16_f32 v196, v28, v29
    v_cvt_pk_bf16_f32 v197, v30, v31
    v_cvt_pk_bf16_f32 v198, v32, v33
    v_cvt_pk_bf16_f32 v199, v34, v35
    v_lshlrev_b32 v28, 16, v200
    v_and_b32 v29, s41, v200
    v_lshlrev_b32 v30, 16, v201
    v_and_b32 v31, s41, v201
    v_lshlrev_b32 v32, 16, v202
    v_and_b32 v33, s41, v202
    v_lshlrev_b32 v34, 16, v203
    v_and_b32 v35, s41, v203
    v_pk_fma_f32 v[28:29], v[28:29], v[18:19], v[20:21]
    v_pk_fma_f32 v[30:31], v[30:31], v[18:19], v[20:21]
    v_pk_fma_f32 v[32:33], v[32:33], v[18:19], v[20:21]
    v_pk_fma_f32 v[34:35], v[34:35], v[18:19], v[20:21]
    v_cvt_pk_bf16_f32 v200, v28, v29
    v_cvt_pk_bf16_f32 v201, v30, v31
    v_cvt_pk_bf16_f32 v202, v32, v33
    v_cvt_pk_bf16_f32 v203, v34, v35
    v_lshlrev_b32 v28, 16, v204
    v_and_b32 v29, s41, v204
    v_lshlrev_b32 v30, 16, v205
    v_and_b32 v31, s41, v205
    v_lshlrev_b32 v32, 16, v206
    v_and_b32 v33, s41, v206
    v_lshlrev_b32 v34, 16, v207
    v_and_b32 v35, s41, v207
    v_pk_fma_f32 v[28:29], v[28:29], v[18:19], v[20:21]
    v_pk_fma_f32 v[30:31], v[30:31], v[18:19], v[20:21]
    v_pk_fma_f32 v[32:33], v[32:33], v[18:19], v[20:21]
    v_pk_fma_f32 v[34:35], v[34:35], v[18:19], v[20:21]
    v_cvt_pk_bf16_f32 v204, v28, v29
    v_cvt_pk_bf16_f32 v205, v30, v31
    v_cvt_pk_bf16_f32 v206, v32, v33
    v_cvt_pk_bf16_f32 v207, v34, v35
    v_lshlrev_b32 v28, 16, v208
    v_and_b32 v29, s41, v208
    v_lshlrev_b32 v30, 16, v209
    v_and_b32 v31, s41, v209
    v_lshlrev_b32 v32, 16, v210
    v_and_b32 v33, s41, v210
    v_lshlrev_b32 v34, 16, v211
    v_and_b32 v35, s41, v211
    v_pk_fma_f32 v[28:29], v[28:29], v[18:19], v[20:21]
    v_pk_fma_f32 v[30:31], v[30:31], v[18:19], v[20:21]
    v_pk_fma_f32 v[32:33], v[32:33], v[18:19], v[20:21]
    v_pk_fma_f32 v[34:35], v[34:35], v[18:19], v[20:21]
    v_cvt_pk_bf16_f32 v208, v28, v29
    v_cvt_pk_bf16_f32 v209, v30, v31
    v_cvt_pk_bf16_f32 v210, v32, v33
    v_cvt_pk_bf16_f32 v211, v34, v35
    v_lshlrev_b32 v28, 16, v212
    v_and_b32 v29, s41, v212
    v_lshlrev_b32 v30, 16, v213
    v_and_b32 v31, s41, v213
    v_lshlrev_b32 v32, 16, v214
    v_and_b32 v33, s41, v214
    v_lshlrev_b32 v34, 16, v215
    v_and_b32 v35, s41, v215
    v_pk_fma_f32 v[28:29], v[28:29], v[18:19], v[20:21]
    v_pk_fma_f32 v[30:31], v[30:31], v[18:19], v[20:21]
    v_pk_fma_f32 v[32:33], v[32:33], v[18:19], v[20:21]
    v_pk_fma_f32 v[34:35], v[34:35], v[18:19], v[20:21]
    v_cvt_pk_bf16_f32 v212, v28, v29
    v_cvt_pk_bf16_f32 v213, v30, v31
    v_cvt_pk_bf16_f32 v214, v32, v33
    v_cvt_pk_bf16_f32 v215, v34, v35
    v_lshlrev_b32 v28, 16, v216
    v_and_b32 v29, s41, v216
    v_lshlrev_b32 v30, 16, v217
    v_and_b32 v31, s41, v217
    v_lshlrev_b32 v32, 16, v218
    v_and_b32 v33, s41, v218
    v_lshlrev_b32 v34, 16, v219
    v_and_b32 v35, s41, v219
    v_pk_fma_f32 v[28:29], v[28:29], v[18:19], v[20:21]
    v_pk_fma_f32 v[30:31], v[30:31], v[18:19], v[20:21]
    v_pk_fma_f32 v[32:33], v[32:33], v[18:19], v[20:21]
    v_pk_fma_f32 v[34:35], v[34:35], v[18:19], v[20:21]
    v_cvt_pk_bf16_f32 v216, v28, v29
    v_cvt_pk_bf16_f32 v217, v30, v31
    v_cvt_pk_bf16_f32 v218, v32, v33
    v_cvt_pk_bf16_f32 v219, v34, v35
    v_lshlrev_b32 v28, 16, v220
    v_and_b32 v29, s41, v220
    v_lshlrev_b32 v30, 16, v221
    v_and_b32 v31, s41, v221
    v_lshlrev_b32 v32, 16, v222
    v_and_b32 v33, s41, v222
    v_lshlrev_b32 v34, 16, v223
    v_and_b32 v35, s41, v223
    v_pk_fma_f32 v[28:29], v[28:29], v[18:19], v[20:21]
    v_pk_fma_f32 v[30:31], v[30:31], v[18:19], v[20:21]
    v_pk_fma_f32 v[32:33], v[32:33], v[18:19], v[20:21]
    v_pk_fma_f32 v[34:35], v[34:35], v[18:19], v[20:21]
    v_cvt_pk_bf16_f32 v220, v28, v29
    v_cvt_pk_bf16_f32 v221, v30, v31
    v_cvt_pk_bf16_f32 v222, v32, v33
    v_cvt_pk_bf16_f32 v223, v34, v35
    v_lshlrev_b32 v28, 16, v224
    v_and_b32 v29, s41, v224
    v_lshlrev_b32 v30, 16, v225
    v_and_b32 v31, s41, v225
    v_lshlrev_b32 v32, 16, v226
    v_and_b32 v33, s41, v226
    v_lshlrev_b32 v34, 16, v227
    v_and_b32 v35, s41, v227
    v_pk_fma_f32 v[28:29], v[28:29], v[18:19], v[20:21]
    v_pk_fma_f32 v[30:31], v[30:31], v[18:19], v[20:21]
    v_pk_fma_f32 v[32:33], v[32:33], v[18:19], v[20:21]
    v_pk_fma_f32 v[34:35], v[34:35], v[18:19], v[20:21]
    v_cvt_pk_bf16_f32 v224, v28, v29
    v_cvt_pk_bf16_f32 v225, v30, v31
    v_cvt_pk_bf16_f32 v226, v32, v33
    v_cvt_pk_bf16_f32 v227, v34, v35
    v_lshlrev_b32 v28, 16, v228
    v_and_b32 v29, s41, v228
    v_lshlrev_b32 v30, 16, v229
    v_and_b32 v31, s41, v229
    v_lshlrev_b32 v32, 16, v230
    v_and_b32 v33, s41, v230
    v_lshlrev_b32 v34, 16, v231
    v_and_b32 v35, s41, v231
    v_pk_fma_f32 v[28:29], v[28:29], v[18:19], v[20:21]
    v_pk_fma_f32 v[30:31], v[30:31], v[18:19], v[20:21]
    v_pk_fma_f32 v[32:33], v[32:33], v[18:19], v[20:21]
    v_pk_fma_f32 v[34:35], v[34:35], v[18:19], v[20:21]
    v_cvt_pk_bf16_f32 v228, v28, v29
    v_cvt_pk_bf16_f32 v229, v30, v31
    v_cvt_pk_bf16_f32 v230, v32, v33
    v_cvt_pk_bf16_f32 v231, v34, v35
    v_lshlrev_b32 v28, 16, v232
    v_and_b32 v29, s41, v232
    v_lshlrev_b32 v30, 16, v233
    v_and_b32 v31, s41, v233
    v_lshlrev_b32 v32, 16, v234
    v_and_b32 v33, s41, v234
    v_lshlrev_b32 v34, 16, v235
    v_and_b32 v35, s41, v235
    v_pk_fma_f32 v[28:29], v[28:29], v[18:19], v[20:21]
    v_pk_fma_f32 v[30:31], v[30:31], v[18:19], v[20:21]
    v_pk_fma_f32 v[32:33], v[32:33], v[18:19], v[20:21]
    v_pk_fma_f32 v[34:35], v[34:35], v[18:19], v[20:21]
    v_cvt_pk_bf16_f32 v232, v28, v29
    v_cvt_pk_bf16_f32 v233, v30, v31
    v_cvt_pk_bf16_f32 v234, v32, v33
    v_cvt_pk_bf16_f32 v235, v34, v35
    s_waitcnt vmcnt(0)
    v_readfirstlane_b32 s33, v14
    s_nop 3
    s_cmp_lg_u32 s33, 0
    s_cbranch_scc1 L_g_havenonce
    v_mov_b32 v13, 0
L_g_nonce:
    global_load_dword v14, v13, s[4:5] sc1
    s_waitcnt vmcnt(0)
    v_readfirstlane_b32 s33, v14
    s_nop 3
    s_cmp_lg_u32 s33, 0
    s_cbranch_scc1 L_g_nonce_done
    s_sleep 2
    s_sub_u32 s3, s3, 1
    s_cbranch_scc0 L_g_nonce
    s_mov_b32 s3, 0
L_g_nonce_done:
L_g_havenonce:
    v_mov_b32 v13, s33
    v_mov_b32 v14, 0
    s_mov_b64 exec, 1
    buffer_store_dword v13, v14, s[28:31], s55 offen sc1
    s_mov_b64 exec, -1
    s_add_u32 m0, s61, 8192
    s_add_u32 s37, s47, 28672
    buffer_load_dwordx4 v2, s[16:19], s47 offen lds
    s_add_u32 m0, m0, 1024
    s_nop 0
    buffer_load_dwordx4 v2, s[16:19], s37 offen lds
    s_add_u32 m0, s61, 10240
    s_add_u32 s37, s47, 28672
    buffer_load_dwordx4 v3, s[20:23], s47 offen lds
    s_add_u32 m0, m0, 1024
    s_nop 0
    buffer_load_dwordx4 v3, s[20:23], s37 offen lds
    s_add_u32 m0, s61, 16384
    s_add_u32 s37, s48, 28672
    buffer_load_dwordx4 v2, s[16:19], s48 offen lds
    s_add_u32 m0, m0, 1024
    s_nop 0
    buffer_load_dwordx4 v2, s[16:19], s37 offen lds
    s_add_u32 m0, s61, 18432
    s_add_u32 s37, s48, 28672
    buffer_load_dwordx4 v3, s[20:23], s48 offen lds
    s_add_u32 m0, m0, 1024
    s_nop 0
    buffer_load_dwordx4 v3, s[20:23], s37 offen lds
    v_lshlrev_b32 v28, 16, v236
    v_and_b32 v29, s41, v236
    v_lshlrev_b32 v30, 16, v237
    v_and_b32 v31, s41, v237
    v_lshlrev_b32 v32, 16, v238
    v_and_b32 v33, s41, v238
    v_lshlrev_b32 v34, 16, v239
    v_and_b32 v35, s41, v239
    v_pk_fma_f32 v[28:29], v[28:29], v[18:19], v[20:21]
    v_pk_fma_f32 v[30:31], v[30:31], v[18:19], v[20:21]
    v_pk_fma_f32 v[32:33], v[32:33], v[18:19], v[20:21]
    v_pk_fma_f32 v[34:35], v[34:35], v[18:19], v[20:21]
    v_cvt_pk_bf16_f32 v236, v28, v29
    v_cvt_pk_bf16_f32 v237, v30, v31
    v_cvt_pk_bf16_f32 v238, v32, v33
    v_cvt_pk_bf16_f32 v239, v34, v35
    v_lshlrev_b32 v28, 16, v240
    v_and_b32 v29, s41, v240
    v_lshlrev_b32 v30, 16, v241
    v_and_b32 v31, s41, v241
    v_lshlrev_b32 v32, 16, v242
    v_and_b32 v33, s41, v242
    v_lshlrev_b32 v34, 16, v243
    v_and_b32 v35, s41, v243
    v_pk_fma_f32 v[28:29], v[28:29], v[18:19], v[20:21]
    v_pk_fma_f32 v[30:31], v[30:31], v[18:19], v[20:21]
    v_pk_fma_f32 v[32:33], v[32:33], v[18:19], v[20:21]
    v_pk_fma_f32 v[34:35], v[34:35], v[18:19], v[20:21]
    v_cvt_pk_bf16_f32 v240, v28, v29
    v_cvt_pk_bf16_f32 v241, v30, v31
    v_cvt_pk_bf16_f32 v242, v32, v33
    v_cvt_pk_bf16_f32 v243, v34, v35
    v_lshlrev_b32 v28, 16, v244
    v_and_b32 v29, s41, v244
    v_lshlrev_b32 v30, 16, v245
    v_and_b32 v31, s41, v245
    v_lshlrev_b32 v32, 16, v246
    v_and_b32 v33, s41, v246
    v_lshlrev_b32 v34, 16, v247
    v_and_b32 v35, s41, v247
    v_pk_fma_f32 v[28:29], v[28:29], v[18:19], v[20:21]
    v_pk_fma_f32 v[30:31], v[30:31], v[18:19], v[20:21]
    v_pk_fma_f32 v[32:33], v[32:33], v[18:19], v[20:21]
    v_pk_fma_f32 v[34:35], v[34:35], v[18:19], v[20:21]
    v_cvt_pk_bf16_f32 v244, v28, v29
    v_cvt_pk_bf16_f32 v245, v30, v31
    v_cvt_pk_bf16_f32 v246, v32, v33
    v_cvt_pk_bf16_f32 v247, v34, v35
    v_lshlrev_b32 v28, 16, v248
    v_and_b32 v29, s41, v248
    v_lshlrev_b32 v30, 16, v249
    v_and_b32 v31, s41, v249
    v_lshlrev_b32 v32, 16, v250
    v_and_b32 v33, s41, v250
    v_lshlrev_b32 v34, 16, v251
    v_and_b32 v35, s41, v251
    v_pk_fma_f32 v[28:29], v[28:29], v[18:19], v[20:21]
    v_pk_fma_f32 v[30:31], v[30:31], v[18:19], v[20:21]
    v_pk_fma_f32 v[32:33], v[32:33], v[18:19], v[20:21]
    v_pk_fma_f32 v[34:35], v[34:35], v[18:19], v[20:21]
    v_cvt_pk_bf16_f32 v248, v28, v29
    v_cvt_pk_bf16_f32 v249, v30, v31
    v_cvt_pk_bf16_f32 v250, v32, v33
    v_cvt_pk_bf16_f32 v251, v34, v35
    v_lshlrev_b32 v28, 16, v252
    v_and_b32 v29, s41, v252
    v_lshlrev_b32 v30, 16, v253
    v_and_b32 v31, s41, v253
    v_lshlrev_b32 v32, 16, v254
    v_and_b32 v33, s41, v254
    v_lshlrev_b32 v34, 16, v255
    v_and_b32 v35, s41, v255
    v_pk_fma_f32 v[28:29], v[28:29], v[18:19], v[20:21]
    v_pk_fma_f32 v[30:31], v[30:31], v[18:19], v[20:21]
    v_pk_fma_f32 v[32:33], v[32:33], v[18:19], v[20:21]
    v_pk_fma_f32 v[34:35], v[34:35], v[18:19], v[20:21]
    v_cvt_pk_bf16_f32 v252, v28, v29
    v_cvt_pk_bf16_f32 v253, v30, v31
    v_cvt_pk_bf16_f32 v254, v32, v33
    v_cvt_pk_bf16_f32 v255, v34, v35
    s_setprio 3
    v_xor_b32 v8, 0, v12
    v_add_u32 v22, s26, v8
    v_add_u32 v8, s25, v8
    v_xor_b32 v9, 32, v12
    v_add_u32 v23, s26, v9
    v_add_u32 v9, s25, v9
    v_xor_b32 v10, 64, v12
    v_add_u32 v24, s26, v10
    v_add_u32 v10, s25, v10
    v_xor_b32 v11, 96, v12
    v_add_u32 v25, s26, v11
    v_add_u32 v11, s25, v11
    s_waitcnt lgkmcnt(0)
    s_mov_b32 s12, s68
    s_mov_b32 s13, s69
    s_mov_b32 s14, 524288
    s_mov_b32 s15, 0x20000
    s_mov_b32 s56, s72
    s_mov_b32 s57, s73
    s_mov_b32 s58, 1835008
    s_mov_b32 s59, 0x20000
    s_mov_b32 s24, s74
    s_mov_b32 s25, s75
    s_mov_b32 s26, 2097152
    s_mov_b32 s27, 0x20000
    s_and_b32 s34, s2, 7
    s_lshl_b32 s34, s34, 2
    s_lshr_b32 s39, s2, 3
    s_and_b32 s39, s39, 3
    s_add_u32 s34, s34, s39
    s_lshr_b32 s35, s2, 5
    s_lshl_b32 s41, s39, 1
    s_add_u32 s41, s41, s35
    s_lshl_b32 s41, s41, 1
    s_and_b32 s41, s41, 15
    s_mov_b32 s63, s41
    s_mul_i32 s53, s39, 3
    s_add_u32 s53, s53, s35
    s_sub_u32 s39, s53, 12
    s_cmp_ge_u32 s53, 12
    s_cselect_b32 s53, s39, s53
    s_add_u32 s53, s53, 16
    s_and_b32 s40, s32, 1
    s_lshl_b32 s39, s34, 1
    s_add_u32 s39, s39, s40
    s_mul_i32 s55, s39, 147456
    s_add_u32 s55, s55, 6291456
    s_lshl_b32 s38, s32, 10
    s_add_u32 s42, s55, s38
    s_add_u32 s42, s42, 32768
    s_mov_b32 s54, 147456
    s_cmp_eq_u32 s40, 0
    s_cselect_b32 s54, s54, 0xfffdc000
    v_lshrrev_b32 v28, 3, v1
    v_and_b32 v29, 7, v1
    v_lshlrev_b32 v30, 1, v28
    v_and_b32 v30, 4, v30
    v_xor_b32 v29, v29, v30
    v_lshlrev_b32 v29, 4, v29
    v_lshl_add_u32 v28, v28, 10, v29
    s_lshl_b32 s68, s35, 7
    s_lshl_b32 s38, s32, 14
    s_add_u32 s69, s68, s38
    v_add_u32 v6, s69, v28
    v_lshrrev_b32 v28, 5, v1
    v_bfe_u32 v29, v1, 4, 1
    v_bfe_u32 v30, v1, 2, 2
    v_and_b32 v31, 3, v1
    v_lshl_add_u32 v32, v28, 2, v30
    v_lshlrev_b32 v32, 7, v32
    v_lshrrev_b32 v33, 1, v30
    v_lshl_add_u32 v32, v33, 6, v32
    s_lshr_b32 s70, s32, 1
    s_lshl_b32 s70, s70, 6
    v_lshl_add_u32 v32, v29, 5, v32
    v_lshl_add_u32 v32, v31, 3, v32
    v_xor_b32 v17, s70, v32
    v_add_u32 v7, s61, v17
    v_xor_b32 v13, 64, v7
    v_and_b32 v32, 31, v1
    v_lshlrev_b32 v18, 7, v32
    v_lshlrev_b32 v32, 10, v32
    v_lshl_add_u32 v32, v28, 3, v32
    s_lshl_b32 s38, s39, 15
    s_add_u32 s38, s38, s68
    s_add_u32 s38, s38, s70
    v_add_u32 v14, s38, v32
    v_lshl_add_u32 v16, v28, 3, v14
    s_lshl_b32 s39, s34, 12
    s_add_u32 s39, s39, 16908288
    v_add_u32 v18, s39, v18
    v_add_u32 v28, 1, v28
    v_lshl_add_u32 v19, v28, 17, v18
    s_lshl_b32 s38, s65, 11
    s_lshl_b32 s39, s36, 7
    s_add_u32 s38, s38, s39
    s_add_u32 s67, s38, 16908288
    s_lshl_b32 s64, s36, 12
    s_add_u32 s64, s64, s62
    s_and_b32 s66, s33, 2
    s_lshl_b32 s66, s66, 2
    s_xor_b32 s66, s66, s36
    s_lshr_b32 s38, s66, 1
    s_add_u32 s38, s38, 4
    s_and_b32 s39, s66, 1
    s_lshl_b32 s39, s39, 6
    s_lshl_b32 s60, s66, 12
    s_lshl_b32 s40, s66, 11
    s_add_u32 s40, s40, 16384
    s_cmp_lt_u32 s66, 8
    s_cselect_b32 s38, s66, s38
    s_cselect_b32 s39, 0, s39
    s_cselect_b32 s60, s60, s40
    s_add_u32 s38, s38, 16
    s_sub_u32 s38, s38, s36
    s_lshl_b32 s38, s38, 7
    v_xor_b32 v4, s39, v2
    v_add_u32 v4, s38, v4
    v_xor_b32 v5, s39, v3
    v_add_u32 v5, s38, v5
    s_add_u32 s60, s60, s62
    s_add_u32 s60, s60, 65536
    v_mov_b32 v26, s33
    v_mov_b32 v27, 0
    s_waitcnt vmcnt(19)
    s_barrier
    ds_read_b64_tr_b16 v[36:37], v8 offset:4096
    ds_read_b64_tr_b16 v[38:39], v8 offset:4608
    ds_read_b64_tr_b16 v[40:41], v9 offset:4096
    ds_read_b64_tr_b16 v[42:43], v9 offset:4608
    ds_read_b64_tr_b16 v[44:45], v10 offset:4096
    ds_read_b64_tr_b16 v[46:47], v10 offset:4608
    ds_read_b64_tr_b16 v[48:49], v11 offset:4096
    ds_read_b64_tr_b16 v[50:51], v11 offset:4608
    ds_read_b64_tr_b16 v[52:53], v8 offset:24576
    ds_read_b64_tr_b16 v[54:55], v8 offset:25088
    ds_read_b64_tr_b16 v[56:57], v9 offset:24576
    ds_read_b64_tr_b16 v[58:59], v9 offset:25088
    s_setprio 0
    s_waitcnt lgkmcnt(10)
    v_mfma_f32_32x32x16_bf16 v[64:79], v[36:39], v[128:131], 0
    s_waitcnt lgkmcnt(8)
    ds_read_b64_tr_b16 v[60:61], v10 offset:24576
    ds_read_b64_tr_b16 v[62:63], v10 offset:25088
    s_add_u32 m0, s61, 0
    s_add_u32 s37, s49, 28672
    buffer_load_dwordx4 v2, s[16:19], s49 offen lds
    v_mfma_f32_32x32x16_bf16 v[80:95], v[40:43], v[128:131], 0
    s_waitcnt lgkmcnt(8)
    ds_read_b64_tr_b16 v[36:37], v11 offset:24576
    ds_read_b64_tr_b16 v[38:39], v11 offset:25088
    s_add_u32 m0, m0, 1024
    s_nop 0
    buffer_load_dwordx4 v2, s[16:19], s37 offen lds
    v_mfma_f32_32x32x16_bf16 v[96:111], v[44:47], v[128:131], 0
    s_waitcnt lgkmcnt(8)
    ds_read_b64_tr_b16 v[40:41], v22 offset:4096
    ds_read_b64_tr_b16 v[42:43], v22 offset:4608
    s_add_u32 m0, s61, 2048
    s_add_u32 s37, s49, 28672
    buffer_load_dwordx4 v3, s[20:23], s49 offen lds
    v_mfma_f32_32x32x16_bf16 v[112:127], v[48:51], v[128:131], 0
    s_waitcnt lgkmcnt(8)
    ds_read_b64_tr_b16 v[44:45], v23 offset:4096
    ds_read_b64_tr_b16 v[46:47], v23 offset:4608
    s_add_u32 m0, m0, 1024
    s_nop 0
    buffer_load_dwordx4 v3, s[20:23], s37 offen lds
    v_mfma_f32_32x32x16_bf16 v[64:79], v[52:55], v[132:135], v[64:79]
    s_waitcnt lgkmcnt(8)
    ds_read_b64_tr_b16 v[48:49], v24 offset:4096
    ds_read_b64_tr_b16 v[50:51], v24 offset:4608
    v_mfma_f32_32x32x16_bf16 v[80:95], v[56:59], v[132:135], v[80:95]
    s_waitcnt lgkmcnt(8)
    ds_read_b64_tr_b16 v[52:53], v25 offset:4096
    ds_read_b64_tr_b16 v[54:55], v25 offset:4608
    v_mfma_f32_32x32x16_bf16 v[96:111], v[60:63], v[132:135], v[96:111]
    s_waitcnt lgkmcnt(8)
    ds_read_b64_tr_b16 v[56:57], v22 offset:24576
    ds_read_b64_tr_b16 v[58:59], v22 offset:25088
    v_mfma_f32_32x32x16_bf16 v[112:127], v[36:39], v[132:135], v[112:127]
    s_waitcnt lgkmcnt(8)
    ds_read_b64_tr_b16 v[60:61], v23 offset:24576
    ds_read_b64_tr_b16 v[62:63], v23 offset:25088
    v_mfma_f32_32x32x16_bf16 v[64:79], v[40:43], v[136:139], v[64:79]
    s_waitcnt lgkmcnt(8)
    ds_read_b64_tr_b16 v[36:37], v24 offset:24576
    ds_read_b64_tr_b16 v[38:39], v24 offset:25088
    v_mfma_f32_32x32x16_bf16 v[80:95], v[44:47], v[136:139], v[80:95]
    s_waitcnt lgkmcnt(8)
    ds_read_b64_tr_b16 v[40:41], v25 offset:24576
    ds_read_b64_tr_b16 v[42:43], v25 offset:25088
    v_mfma_f32_32x32x16_bf16 v[96:111], v[48:51], v[136:139], v[96:111]
    s_waitcnt lgkmcnt(8)
    s_waitcnt vmcnt(15)
    s_barrier
    ds_read_b64_tr_b16 v[44:45], v8 offset:12288
    ds_read_b64_tr_b16 v[46:47], v8 offset:12800
    v_mfma_f32_32x32x16_bf16 v[112:127], v[52:55], v[136:139], v[112:127]
    s_waitcnt lgkmcnt(8)
    ds_read_b64_tr_b16 v[48:49], v9 offset:12288
    ds_read_b64_tr_b16 v[50:51], v9 offset:12800
    v_mfma_f32_32x32x16_bf16 v[64:79], v[56:59], v[140:143], v[64:79]
    s_waitcnt lgkmcnt(8)
    ds_read_b64_tr_b16 v[52:53], v10 offset:12288
    ds_read_b64_tr_b16 v[54:55], v10 offset:12800
    v_mfma_f32_32x32x16_bf16 v[80:95], v[60:63], v[140:143], v[80:95]
    s_waitcnt lgkmcnt(8)
    ds_read_b64_tr_b16 v[56:57], v11 offset:12288
    ds_read_b64_tr_b16 v[58:59], v11 offset:12800
    v_mfma_f32_32x32x16_bf16 v[96:111], v[36:39], v[140:143], v[96:111]
    s_waitcnt lgkmcnt(8)
    ds_read_b64_tr_b16 v[60:61], v8 offset:32768
    ds_read_b64_tr_b16 v[62:63], v8 offset:33280
    v_mfma_f32_32x32x16_bf16 v[112:127], v[40:43], v[140:143], v[112:127]
    s_waitcnt lgkmcnt(8)
    ds_read_b64_tr_b16 v[36:37], v9 offset:32768
    ds_read_b64_tr_b16 v[38:39], v9 offset:33280
    v_mfma_f32_32x32x16_bf16 v[64:79], v[44:47], v[144:147], v[64:79]
    s_waitcnt lgkmcnt(8)
    ds_read_b64_tr_b16 v[40:41], v10 offset:32768
    ds_read_b64_tr_b16 v[42:43], v10 offset:33280
    v_mfma_f32_32x32x16_bf16 v[80:95], v[48:51], v[144:147], v[80:95]
    s_waitcnt lgkmcnt(8)
    ds_read_b64_tr_b16 v[44:45], v11 offset:32768
    ds_read_b64_tr_b16 v[46:47], v11 offset:33280
    v_mfma_f32_32x32x16_bf16 v[96:111], v[52:55], v[144:147], v[96:111]
    s_waitcnt lgkmcnt(8)
    ds_read_b64_tr_b16 v[48:49], v22 offset:12288
    ds_read_b64_tr_b16 v[50:51], v22 offset:12800
    v_mfma_f32_32x32x16_bf16 v[112:127], v[56:59], v[144:147], v[112:127]
    s_waitcnt lgkmcnt(8)
    ds_read_b64_tr_b16 v[52:53], v23 offset:12288
    ds_read_b64_tr_b16 v[54:55], v23 offset:12800
    v_mfma_f32_32x32x16_bf16 v[64:79], v[60:63], v[148:151], v[64:79]
    s_waitcnt lgkmcnt(8)
    ds_read_b64_tr_b16 v[56:57], v24 offset:12288
    ds_read_b64_tr_b16 v[58:59], v24 offset:12800
    v_mfma_f32_32x32x16_bf16 v[80:95], v[36:39], v[148:151], v[80:95]
    s_waitcnt lgkmcnt(8)
    ds_read_b64_tr_b16 v[60:61], v25 offset:12288
    ds_read_b64_tr_b16 v[62:63], v25 offset:12800
    v_mfma_f32_32x32x16_bf16 v[96:111], v[40:43], v[148:151], v[96:111]
    s_waitcnt lgkmcnt(8)
    ds_read_b64_tr_b16 v[36:37], v22 offset:32768
    ds_read_b64_tr_b16 v[38:39], v22 offset:33280
    v_mfma_f32_32x32x16_bf16 v[112:127], v[44:47], v[148:151], v[112:127]
    s_waitcnt lgkmcnt(8)
    ds_read_b64_tr_b16 v[40:41], v23 offset:32768
    ds_read_b64_tr_b16 v[42:43], v23 offset:33280
    v_mfma_f32_32x32x16_bf16 v[64:79], v[48:51], v[152:155], v[64:79]
    s_waitcnt lgkmcnt(8)
    ds_read_b64_tr_b16 v[44:45], v24 offset:32768
    ds_read_b64_tr_b16 v[46:47], v24 offset:33280
    v_mfma_f32_32x32x16_bf16 v[80:95], v[52:55], v[152:155], v[80:95]
    s_waitcnt lgkmcnt(8)
    ds_read_b64_tr_b16 v[48:49], v25 offset:32768
    ds_read_b64_tr_b16 v[50:51], v25 offset:33280
    v_mfma_f32_32x32x16_bf16 v[96:111], v[56:59], v[152:155], v[96:111]
    s_waitcnt lgkmcnt(8)
    s_waitcnt vmcnt(8)
    s_barrier
    ds_read_b64_tr_b16 v[52:53], v8 offset:8192
    ds_read_b64_tr_b16 v[54:55], v8 offset:8704
    s_add_u32 m0, s61, 4096
    s_add_u32 s37, s50, 28672
    buffer_load_dwordx4 v2, s[16:19], s50 offen lds
    v_mfma_f32_32x32x16_bf16 v[112:127], v[60:63], v[152:155], v[112:127]
    s_waitcnt lgkmcnt(8)
    ds_read_b64_tr_b16 v[56:57], v9 offset:8192
    ds_read_b64_tr_b16 v[58:59], v9 offset:8704
    s_add_u32 m0, m0, 1024
    s_nop 0
    buffer_load_dwordx4 v2, s[16:19], s37 offen lds
    v_mfma_f32_32x32x16_bf16 v[64:79], v[36:39], v[156:159], v[64:79]
    s_waitcnt lgkmcnt(8)
    ds_read_b64_tr_b16 v[60:61], v10 offset:8192
    ds_read_b64_tr_b16 v[62:63], v10 offset:8704
    s_add_u32 m0, s61, 6144
    s_add_u32 s37, s50, 28672
    buffer_load_dwordx4 v3, s[20:23], s50 offen lds
    v_mfma_f32_32x32x16_bf16 v[80:95], v[40:43], v[156:159], v[80:95]
    s_waitcnt lgkmcnt(8)
    ds_read_b64_tr_b16 v[36:37], v11 offset:8192
    ds_read_b64_tr_b16 v[38:39], v11 offset:8704
    s_add_u32 m0, m0, 1024
    s_nop 0
    buffer_load_dwordx4 v3, s[20:23], s37 offen lds
    v_mfma_f32_32x32x16_bf16 v[96:111], v[44:47], v[156:159], v[96:111]
    s_waitcnt lgkmcnt(8)
    ds_read_b64_tr_b16 v[40:41], v8 offset:28672
    ds_read_b64_tr_b16 v[42:43], v8 offset:29184
    v_mfma_f32_32x32x16_bf16 v[112:127], v[48:51], v[156:159], v[112:127]
    s_waitcnt lgkmcnt(8)
    ds_read_b64_tr_b16 v[44:45], v9 offset:28672
    ds_read_b64_tr_b16 v[46:47], v9 offset:29184
    v_mfma_f32_32x32x16_bf16 v[64:79], v[52:55], v[160:163], v[64:79]
    s_waitcnt lgkmcnt(8)
    ds_read_b64_tr_b16 v[48:49], v10 offset:28672
    ds_read_b64_tr_b16 v[50:51], v10 offset:29184
    v_mfma_f32_32x32x16_bf16 v[80:95], v[56:59], v[160:163], v[80:95]
    s_waitcnt lgkmcnt(8)
    ds_read_b64_tr_b16 v[52:53], v11 offset:28672
    ds_read_b64_tr_b16 v[54:55], v11 offset:29184
    v_mfma_f32_32x32x16_bf16 v[96:111], v[60:63], v[160:163], v[96:111]
    s_waitcnt lgkmcnt(8)
    ds_read_b64_tr_b16 v[56:57], v22 offset:8192
    ds_read_b64_tr_b16 v[58:59], v22 offset:8704
    v_mfma_f32_32x32x16_bf16 v[112:127], v[36:39], v[160:163], v[112:127]
    s_waitcnt lgkmcnt(8)
    ds_read_b64_tr_b16 v[60:61], v23 offset:8192
    ds_read_b64_tr_b16 v[62:63], v23 offset:8704
    v_mfma_f32_32x32x16_bf16 v[64:79], v[40:43], v[164:167], v[64:79]
    s_waitcnt lgkmcnt(8)
    ds_read_b64_tr_b16 v[36:37], v24 offset:8192
    ds_read_b64_tr_b16 v[38:39], v24 offset:8704
    v_mfma_f32_32x32x16_bf16 v[80:95], v[44:47], v[164:167], v[80:95]
    s_waitcnt lgkmcnt(8)
    ds_read_b64_tr_b16 v[40:41], v25 offset:8192
    ds_read_b64_tr_b16 v[42:43], v25 offset:8704
    v_mfma_f32_32x32x16_bf16 v[96:111], v[48:51], v[164:167], v[96:111]
    s_waitcnt lgkmcnt(8)
    ds_read_b64_tr_b16 v[44:45], v22 offset:28672
    ds_read_b64_tr_b16 v[46:47], v22 offset:29184
    v_mfma_f32_32x32x16_bf16 v[112:127], v[52:55], v[164:167], v[112:127]
    s_waitcnt lgkmcnt(8)
    ds_read_b64_tr_b16 v[48:49], v23 offset:28672
    ds_read_b64_tr_b16 v[50:51], v23 offset:29184
    v_mfma_f32_32x32x16_bf16 v[64:79], v[56:59], v[168:171], v[64:79]
    s_waitcnt lgkmcnt(8)
    ds_read_b64_tr_b16 v[52:53], v24 offset:28672
    ds_read_b64_tr_b16 v[54:55], v24 offset:29184
    v_mfma_f32_32x32x16_bf16 v[80:95], v[60:63], v[168:171], v[80:95]
    s_waitcnt lgkmcnt(8)
    ds_read_b64_tr_b16 v[56:57], v25 offset:28672
    ds_read_b64_tr_b16 v[58:59], v25 offset:29184
    v_mfma_f32_32x32x16_bf16 v[96:111], v[36:39], v[168:171], v[96:111]
    s_waitcnt lgkmcnt(8)
    s_waitcnt vmcnt(8)
    s_barrier
    ds_read_b64_tr_b16 v[60:61], v8 offset:16384
    ds_read_b64_tr_b16 v[62:63], v8 offset:16896
    s_add_u32 m0, s61, 12288
    s_add_u32 s37, s51, 28672
    buffer_load_dwordx4 v2, s[16:19], s51 offen lds
    v_mfma_f32_32x32x16_bf16 v[112:127], v[40:43], v[168:171], v[112:127]
    s_waitcnt lgkmcnt(8)
    ds_read_b64_tr_b16 v[36:37], v9 offset:16384
    ds_read_b64_tr_b16 v[38:39], v9 offset:16896
    s_add_u32 m0, m0, 1024
    s_nop 0
    buffer_load_dwordx4 v2, s[16:19], s37 offen lds
    v_mfma_f32_32x32x16_bf16 v[64:79], v[44:47], v[172:175], v[64:79]
    s_waitcnt lgkmcnt(8)
    ds_read_b64_tr_b16 v[40:41], v10 offset:16384
    ds_read_b64_tr_b16 v[42:43], v10 offset:16896
    s_add_u32 m0, s61, 14336
    s_add_u32 s37, s51, 28672
    buffer_load_dwordx4 v3, s[20:23], s51 offen lds
    v_mfma_f32_32x32x16_bf16 v[80:95], v[48:51], v[172:175], v[80:95]
    s_waitcnt lgkmcnt(8)
    ds_read_b64_tr_b16 v[44:45], v11 offset:16384
    ds_read_b64_tr_b16 v[46:47], v11 offset:16896
    s_add_u32 m0, m0, 1024
    s_nop 0
    buffer_load_dwordx4 v3, s[20:23], s37 offen lds
    v_mfma_f32_32x32x16_bf16 v[96:111], v[52:55], v[172:175], v[96:111]
    s_waitcnt lgkmcnt(8)
    ds_read_b64_tr_b16 v[48:49], v8 offset:36864
    ds_read_b64_tr_b16 v[50:51], v8 offset:37376
    v_mfma_f32_32x32x16_bf16 v[112:127], v[56:59], v[172:175], v[112:127]
    s_waitcnt lgkmcnt(8)
    ds_read_b64_tr_b16 v[52:53], v9 offset:36864
    ds_read_b64_tr_b16 v[54:55], v9 offset:37376
    v_mfma_f32_32x32x16_bf16 v[64:79], v[60:63], v[176:179], v[64:79]
    s_waitcnt lgkmcnt(8)
    ds_read_b64_tr_b16 v[56:57], v10 offset:36864
    ds_read_b64_tr_b16 v[58:59], v10 offset:37376
    v_mfma_f32_32x32x16_bf16 v[80:95], v[36:39], v[176:179], v[80:95]
    s_waitcnt lgkmcnt(8)
    ds_read_b64_tr_b16 v[60:61], v11 offset:36864
    ds_read_b64_tr_b16 v[62:63], v11 offset:37376
    v_mfma_f32_32x32x16_bf16 v[96:111], v[40:43], v[176:179], v[96:111]
    s_waitcnt lgkmcnt(8)
    ds_read_b64_tr_b16 v[36:37], v22 offset:16384
    ds_read_b64_tr_b16 v[38:39], v22 offset:16896
    v_mfma_f32_32x32x16_bf16 v[112:127], v[44:47], v[176:179], v[112:127]
    s_waitcnt lgkmcnt(8)
    ds_read_b64_tr_b16 v[40:41], v23 offset:16384
    ds_read_b64_tr_b16 v[42:43], v23 offset:16896
    v_mfma_f32_32x32x16_bf16 v[64:79], v[48:51], v[180:183], v[64:79]
    s_waitcnt lgkmcnt(8)
    ds_read_b64_tr_b16 v[44:45], v24 offset:16384
    ds_read_b64_tr_b16 v[46:47], v24 offset:16896
    v_mfma_f32_32x32x16_bf16 v[80:95], v[52:55], v[180:183], v[80:95]
    s_waitcnt lgkmcnt(8)
    ds_read_b64_tr_b16 v[48:49], v25 offset:16384
    ds_read_b64_tr_b16 v[50:51], v25 offset:16896
    v_mfma_f32_32x32x16_bf16 v[96:111], v[56:59], v[180:183], v[96:111]
    s_waitcnt lgkmcnt(8)
    ds_read_b64_tr_b16 v[52:53], v22 offset:36864
    ds_read_b64_tr_b16 v[54:55], v22 offset:37376
    v_mfma_f32_32x32x16_bf16 v[112:127], v[60:63], v[180:183], v[112:127]
    s_waitcnt lgkmcnt(8)
    ds_read_b64_tr_b16 v[56:57], v23 offset:36864
    ds_read_b64_tr_b16 v[58:59], v23 offset:37376
    v_mfma_f32_32x32x16_bf16 v[64:79], v[36:39], v[184:187], v[64:79]
    s_waitcnt lgkmcnt(8)
    ds_read_b64_tr_b16 v[60:61], v24 offset:36864
    ds_read_b64_tr_b16 v[62:63], v24 offset:37376
    v_mfma_f32_32x32x16_bf16 v[80:95], v[40:43], v[184:187], v[80:95]
    s_waitcnt lgkmcnt(8)
    ds_read_b64_tr_b16 v[36:37], v25 offset:36864
    ds_read_b64_tr_b16 v[38:39], v25 offset:37376
    v_mfma_f32_32x32x16_bf16 v[96:111], v[44:47], v[184:187], v[96:111]
    s_waitcnt lgkmcnt(8)
    s_waitcnt vmcnt(8)
    s_barrier
    ds_read_b64_tr_b16 v[40:41], v8 offset:0
    ds_read_b64_tr_b16 v[42:43], v8 offset:512
    s_add_u32 m0, s61, 8192
    s_add_u32 s37, s52, 28672
    buffer_load_dwordx4 v2, s[16:19], s52 offen lds
    v_mfma_f32_32x32x16_bf16 v[112:127], v[48:51], v[184:187], v[112:127]
    s_waitcnt lgkmcnt(8)
    ds_read_b64_tr_b16 v[44:45], v9 offset:0
    ds_read_b64_tr_b16 v[46:47], v9 offset:512
    s_add_u32 m0, m0, 1024
    s_nop 0
    buffer_load_dwordx4 v2, s[16:19], s37 offen lds
    v_mfma_f32_32x32x16_bf16 v[64:79], v[52:55], v[188:191], v[64:79]
    s_waitcnt lgkmcnt(8)
    ds_read_b64_tr_b16 v[48:49], v10 offset:0
    ds_read_b64_tr_b16 v[50:51], v10 offset:512
    s_add_u32 m0, s61, 10240
    s_add_u32 s37, s52, 28672
    buffer_load_dwordx4 v3, s[20:23], s52 offen lds
    v_mfma_f32_32x32x16_bf16 v[80:95], v[56:59], v[188:191], v[80:95]
    s_waitcnt lgkmcnt(8)
    ds_read_b64_tr_b16 v[52:53], v11 offset:0
    ds_read_b64_tr_b16 v[54:55], v11 offset:512
    s_add_u32 m0, m0, 1024
    s_nop 0
    buffer_load_dwordx4 v3, s[20:23], s37 offen lds
    v_mfma_f32_32x32x16_bf16 v[96:111], v[60:63], v[188:191], v[96:111]
    s_waitcnt lgkmcnt(8)
    ds_read_b64_tr_b16 v[56:57], v8 offset:20480
    ds_read_b64_tr_b16 v[58:59], v8 offset:20992
    v_mfma_f32_32x32x16_bf16 v[112:127], v[36:39], v[188:191], v[112:127]
    s_waitcnt lgkmcnt(8)
    ds_read_b64_tr_b16 v[60:61], v9 offset:20480
    ds_read_b64_tr_b16 v[62:63], v9 offset:20992
    v_mfma_f32_32x32x16_bf16 v[64:79], v[40:43], v[192:195], v[64:79]
    s_waitcnt lgkmcnt(8)
    ds_read_b64_tr_b16 v[36:37], v10 offset:20480
    ds_read_b64_tr_b16 v[38:39], v10 offset:20992
    v_mfma_f32_32x32x16_bf16 v[80:95], v[44:47], v[192:195], v[80:95]
    s_waitcnt lgkmcnt(8)
    ds_read_b64_tr_b16 v[40:41], v11 offset:20480
    ds_read_b64_tr_b16 v[42:43], v11 offset:20992
    v_mfma_f32_32x32x16_bf16 v[96:111], v[48:51], v[192:195], v[96:111]
    s_waitcnt lgkmcnt(8)
    ds_read_b64_tr_b16 v[44:45], v22 offset:0
    ds_read_b64_tr_b16 v[46:47], v22 offset:512
    v_mfma_f32_32x32x16_bf16 v[112:127], v[52:55], v[192:195], v[112:127]
    s_waitcnt lgkmcnt(8)
    ds_read_b64_tr_b16 v[48:49], v23 offset:0
    ds_read_b64_tr_b16 v[50:51], v23 offset:512
    v_mfma_f32_32x32x16_bf16 v[64:79], v[56:59], v[196:199], v[64:79]
    s_waitcnt lgkmcnt(8)
    ds_read_b64_tr_b16 v[52:53], v24 offset:0
    ds_read_b64_tr_b16 v[54:55], v24 offset:512
    v_mfma_f32_32x32x16_bf16 v[80:95], v[60:63], v[196:199], v[80:95]
    s_waitcnt lgkmcnt(8)
    ds_read_b64_tr_b16 v[56:57], v25 offset:0
    ds_read_b64_tr_b16 v[58:59], v25 offset:512
    v_mfma_f32_32x32x16_bf16 v[96:111], v[36:39], v[196:199], v[96:111]
    s_waitcnt lgkmcnt(8)
    ds_read_b64_tr_b16 v[60:61], v22 offset:20480
    ds_read_b64_tr_b16 v[62:63], v22 offset:20992
    v_mfma_f32_32x32x16_bf16 v[112:127], v[40:43], v[196:199], v[112:127]
    s_waitcnt lgkmcnt(8)
    ds_read_b64_tr_b16 v[36:37], v23 offset:20480
    ds_read_b64_tr_b16 v[38:39], v23 offset:20992
    v_mfma_f32_32x32x16_bf16 v[64:79], v[44:47], v[200:203], v[64:79]
    s_waitcnt lgkmcnt(8)
    ds_read_b64_tr_b16 v[40:41], v24 offset:20480
    ds_read_b64_tr_b16 v[42:43], v24 offset:20992
    v_mfma_f32_32x32x16_bf16 v[80:95], v[48:51], v[200:203], v[80:95]
    s_waitcnt lgkmcnt(8)
    ds_read_b64_tr_b16 v[44:45], v25 offset:20480
    ds_read_b64_tr_b16 v[46:47], v25 offset:20992
    v_mfma_f32_32x32x16_bf16 v[96:111], v[52:55], v[200:203], v[96:111]
    s_waitcnt lgkmcnt(8)
    s_waitcnt vmcnt(8)
    s_barrier
    ds_read_b64_tr_b16 v[48:49], v8 offset:4096
    ds_read_b64_tr_b16 v[50:51], v8 offset:4608
    s_add_u32 m0, s61, 16384
    s_add_u32 s37, s45, 28672
    buffer_load_dwordx4 v4, s[16:19], s45 offen lds
    v_mfma_f32_32x32x16_bf16 v[112:127], v[56:59], v[200:203], v[112:127]
    s_waitcnt lgkmcnt(8)
    ds_read_b64_tr_b16 v[52:53], v9 offset:4096
    ds_read_b64_tr_b16 v[54:55], v9 offset:4608
    s_add_u32 m0, m0, 1024
    s_nop 0
    buffer_load_dwordx4 v4, s[16:19], s37 offen lds
    v_mfma_f32_32x32x16_bf16 v[64:79], v[60:63], v[204:207], v[64:79]
    s_waitcnt lgkmcnt(8)
    ds_read_b64_tr_b16 v[56:57], v10 offset:4096
    ds_read_b64_tr_b16 v[58:59], v10 offset:4608
    s_add_u32 m0, s61, 18432
    s_add_u32 s37, s45, 28672
    buffer_load_dwordx4 v5, s[20:23], s45 offen lds
    v_mfma_f32_32x32x16_bf16 v[80:95], v[36:39], v[204:207], v[80:95]
    s_waitcnt lgkmcnt(8)
    ds_read_b64_tr_b16 v[60:61], v11 offset:4096
    ds_read_b64_tr_b16 v[62:63], v11 offset:4608
    s_add_u32 m0, m0, 1024
    s_nop 0
    buffer_load_dwordx4 v5, s[20:23], s37 offen lds
    v_mfma_f32_32x32x16_bf16 v[96:111], v[40:43], v[204:207], v[96:111]
    s_waitcnt lgkmcnt(8)
    ds_read_b64_tr_b16 v[36:37], v8 offset:24576
    ds_read_b64_tr_b16 v[38:39], v8 offset:25088
    v_mfma_f32_32x32x16_bf16 v[112:127], v[44:47], v[204:207], v[112:127]
    s_waitcnt lgkmcnt(8)
    ds_read_b64_tr_b16 v[40:41], v9 offset:24576
    ds_read_b64_tr_b16 v[42:43], v9 offset:25088
    v_mfma_f32_32x32x16_bf16 v[64:79], v[48:51], v[208:211], v[64:79]
    s_waitcnt lgkmcnt(8)
    ds_read_b64_tr_b16 v[44:45], v10 offset:24576
    ds_read_b64_tr_b16 v[46:47], v10 offset:25088
    v_mfma_f32_32x32x16_bf16 v[80:95], v[52:55], v[208:211], v[80:95]
    s_waitcnt lgkmcnt(8)
    ds_read_b64_tr_b16 v[48:49], v11 offset:24576
    ds_read_b64_tr_b16 v[50:51], v11 offset:25088
    v_mfma_f32_32x32x16_bf16 v[96:111], v[56:59], v[208:211], v[96:111]
    s_waitcnt lgkmcnt(8)
    ds_read_b64_tr_b16 v[52:53], v22 offset:4096
    ds_read_b64_tr_b16 v[54:55], v22 offset:4608
    v_mfma_f32_32x32x16_bf16 v[112:127], v[60:63], v[208:211], v[112:127]
    s_waitcnt lgkmcnt(8)
    ds_read_b64_tr_b16 v[56:57], v23 offset:4096
    ds_read_b64_tr_b16 v[58:59], v23 offset:4608
    v_mfma_f32_32x32x16_bf16 v[64:79], v[36:39], v[212:215], v[64:79]
    s_waitcnt lgkmcnt(8)
    ds_read_b64_tr_b16 v[60:61], v24 offset:4096
    ds_read_b64_tr_b16 v[62:63], v24 offset:4608
    v_mfma_f32_32x32x16_bf16 v[80:95], v[40:43], v[212:215], v[80:95]
    s_waitcnt lgkmcnt(8)
    ds_read_b64_tr_b16 v[36:37], v25 offset:4096
    ds_read_b64_tr_b16 v[38:39], v25 offset:4608
    v_mfma_f32_32x32x16_bf16 v[96:111], v[44:47], v[212:215], v[96:111]
    s_waitcnt lgkmcnt(8)
    ds_read_b64_tr_b16 v[40:41], v22 offset:24576
    ds_read_b64_tr_b16 v[42:43], v22 offset:25088
    v_mfma_f32_32x32x16_bf16 v[112:127], v[48:51], v[212:215], v[112:127]
    s_waitcnt lgkmcnt(8)
    ds_read_b64_tr_b16 v[44:45], v23 offset:24576
    ds_read_b64_tr_b16 v[46:47], v23 offset:25088
    v_mfma_f32_32x32x16_bf16 v[64:79], v[52:55], v[216:219], v[64:79]
    s_waitcnt lgkmcnt(8)
    ds_read_b64_tr_b16 v[48:49], v24 offset:24576
    ds_read_b64_tr_b16 v[50:51], v24 offset:25088
    v_mfma_f32_32x32x16_bf16 v[80:95], v[56:59], v[216:219], v[80:95]
    s_waitcnt lgkmcnt(8)
    ds_read_b64_tr_b16 v[52:53], v25 offset:24576
    ds_read_b64_tr_b16 v[54:55], v25 offset:25088
    v_mfma_f32_32x32x16_bf16 v[96:111], v[60:63], v[216:219], v[96:111]
    s_waitcnt lgkmcnt(8)
    s_waitcnt vmcnt(8)
    s_barrier
    ds_read_b64_tr_b16 v[56:57], v8 offset:12288
    ds_read_b64_tr_b16 v[58:59], v8 offset:12800
    s_add_u32 m0, s61, 0
    s_add_u32 s37, s46, 28672
    buffer_load_dwordx4 v4, s[16:19], s46 offen lds
    v_mfma_f32_32x32x16_bf16 v[112:127], v[36:39], v[216:219], v[112:127]
    s_waitcnt lgkmcnt(8)
    ds_read_b64_tr_b16 v[60:61], v9 offset:12288
    ds_read_b64_tr_b16 v[62:63], v9 offset:12800
    s_add_u32 m0, m0, 1024
    s_nop 0
    buffer_load_dwordx4 v4, s[16:19], s37 offen lds
    v_mfma_f32_32x32x16_bf16 v[64:79], v[40:43], v[220:223], v[64:79]
    s_waitcnt lgkmcnt(8)
    ds_read_b64_tr_b16 v[36:37], v10 offset:12288
    ds_read_b64_tr_b16 v[38:39], v10 offset:12800
    s_add_u32 m0, s61, 2048
    s_add_u32 s37, s46, 28672
    buffer_load_dwordx4 v5, s[20:23], s46 offen lds
    v_mfma_f32_32x32x16_bf16 v[80:95], v[44:47], v[220:223], v[80:95]
    s_waitcnt lgkmcnt(8)
    ds_read_b64_tr_b16 v[40:41], v11 offset:12288
    ds_read_b64_tr_b16 v[42:43], v11 offset:12800
    s_add_u32 m0, m0, 1024
    s_nop 0
    buffer_load_dwordx4 v5, s[20:23], s37 offen lds
    v_mfma_f32_32x32x16_bf16 v[96:111], v[48:51], v[220:223], v[96:111]
    s_waitcnt lgkmcnt(8)
    ds_read_b64_tr_b16 v[44:45], v8 offset:32768
    ds_read_b64_tr_b16 v[46:47], v8 offset:33280
    v_mfma_f32_32x32x16_bf16 v[112:127], v[52:55], v[220:223], v[112:127]
    s_waitcnt lgkmcnt(8)
    ds_read_b64_tr_b16 v[48:49], v9 offset:32768
    ds_read_b64_tr_b16 v[50:51], v9 offset:33280
    v_mfma_f32_32x32x16_bf16 v[64:79], v[56:59], v[224:227], v[64:79]
    s_waitcnt lgkmcnt(8)
    ds_read_b64_tr_b16 v[52:53], v10 offset:32768
    ds_read_b64_tr_b16 v[54:55], v10 offset:33280
    v_mfma_f32_32x32x16_bf16 v[80:95], v[60:63], v[224:227], v[80:95]
    s_waitcnt lgkmcnt(8)
    ds_read_b64_tr_b16 v[56:57], v11 offset:32768
    ds_read_b64_tr_b16 v[58:59], v11 offset:33280
    v_mfma_f32_32x32x16_bf16 v[96:111], v[36:39], v[224:227], v[96:111]
    s_waitcnt lgkmcnt(8)
    ds_read_b64_tr_b16 v[60:61], v22 offset:12288
    ds_read_b64_tr_b16 v[62:63], v22 offset:12800
    v_mfma_f32_32x32x16_bf16 v[112:127], v[40:43], v[224:227], v[112:127]
    s_waitcnt lgkmcnt(8)
    ds_read_b64_tr_b16 v[36:37], v23 offset:12288
    ds_read_b64_tr_b16 v[38:39], v23 offset:12800
    v_mfma_f32_32x32x16_bf16 v[64:79], v[44:47], v[228:231], v[64:79]
    s_waitcnt lgkmcnt(8)
    ds_read_b64_tr_b16 v[40:41], v24 offset:12288
    ds_read_b64_tr_b16 v[42:43], v24 offset:12800
    v_mfma_f32_32x32x16_bf16 v[80:95], v[48:51], v[228:231], v[80:95]
    s_waitcnt lgkmcnt(8)
    ds_read_b64_tr_b16 v[44:45], v25 offset:12288
    ds_read_b64_tr_b16 v[46:47], v25 offset:12800
    v_mfma_f32_32x32x16_bf16 v[96:111], v[52:55], v[228:231], v[96:111]
    s_waitcnt lgkmcnt(8)
    ds_read_b64_tr_b16 v[48:49], v22 offset:32768
    ds_read_b64_tr_b16 v[50:51], v22 offset:33280
    v_mfma_f32_32x32x16_bf16 v[112:127], v[56:59], v[228:231], v[112:127]
    s_waitcnt lgkmcnt(8)
    ds_read_b64_tr_b16 v[52:53], v23 offset:32768
    ds_read_b64_tr_b16 v[54:55], v23 offset:33280
    v_mfma_f32_32x32x16_bf16 v[64:79], v[60:63], v[232:235], v[64:79]
    s_waitcnt lgkmcnt(8)
    ds_read_b64_tr_b16 v[56:57], v24 offset:32768
    ds_read_b64_tr_b16 v[58:59], v24 offset:33280
    v_mfma_f32_32x32x16_bf16 v[80:95], v[36:39], v[232:235], v[80:95]
    s_waitcnt lgkmcnt(8)
    ds_read_b64_tr_b16 v[60:61], v25 offset:32768
    ds_read_b64_tr_b16 v[62:63], v25 offset:33280
    v_mfma_f32_32x32x16_bf16 v[96:111], v[40:43], v[232:235], v[96:111]
    s_waitcnt lgkmcnt(8)
    s_waitcnt vmcnt(8)
    s_barrier
    ds_read_b64_tr_b16 v[36:37], v8 offset:8192
    ds_read_b64_tr_b16 v[38:39], v8 offset:8704
    s_add_u32 m0, s61, 4096
    s_add_u32 s37, s47, 28672
    buffer_load_dwordx4 v4, s[16:19], s47 offen lds
    v_mfma_f32_32x32x16_bf16 v[112:127], v[44:47], v[232:235], v[112:127]
    s_waitcnt lgkmcnt(8)
    ds_read_b64_tr_b16 v[40:41], v9 offset:8192
    ds_read_b64_tr_b16 v[42:43], v9 offset:8704
    s_add_u32 m0, m0, 1024
    s_nop 0
    buffer_load_dwordx4 v4, s[16:19], s37 offen lds
    v_mfma_f32_32x32x16_bf16 v[64:79], v[48:51], v[236:239], v[64:79]
    s_waitcnt lgkmcnt(8)
    ds_read_b64_tr_b16 v[44:45], v10 offset:8192
    ds_read_b64_tr_b16 v[46:47], v10 offset:8704
    s_add_u32 m0, s61, 6144
    s_add_u32 s37, s47, 28672
    buffer_load_dwordx4 v5, s[20:23], s47 offen lds
    v_mfma_f32_32x32x16_bf16 v[80:95], v[52:55], v[236:239], v[80:95]
    s_waitcnt lgkmcnt(8)
    ds_read_b64_tr_b16 v[48:49], v11 offset:8192
    ds_read_b64_tr_b16 v[50:51], v11 offset:8704
    s_add_u32 m0, m0, 1024
    s_nop 0
    buffer_load_dwordx4 v5, s[20:23], s37 offen lds
    v_mfma_f32_32x32x16_bf16 v[96:111], v[56:59], v[236:239], v[96:111]
    s_waitcnt lgkmcnt(8)
    ds_read_b64_tr_b16 v[52:53], v8 offset:28672
    ds_read_b64_tr_b16 v[54:55], v8 offset:29184
    v_mfma_f32_32x32x16_bf16 v[112:127], v[60:63], v[236:239], v[112:127]
    s_waitcnt lgkmcnt(8)
    ds_read_b64_tr_b16 v[56:57], v9 offset:28672
    ds_read_b64_tr_b16 v[58:59], v9 offset:29184
    v_mfma_f32_32x32x16_bf16 v[64:79], v[36:39], v[240:243], v[64:79]
    s_waitcnt lgkmcnt(8)
    ds_read_b64_tr_b16 v[60:61], v10 offset:28672
    ds_read_b64_tr_b16 v[62:63], v10 offset:29184
    v_mfma_f32_32x32x16_bf16 v[80:95], v[40:43], v[240:243], v[80:95]
    s_waitcnt lgkmcnt(8)
    ds_read_b64_tr_b16 v[36:37], v11 offset:28672
    ds_read_b64_tr_b16 v[38:39], v11 offset:29184
    v_mfma_f32_32x32x16_bf16 v[96:111], v[44:47], v[240:243], v[96:111]
    s_waitcnt lgkmcnt(8)
    ds_read_b64_tr_b16 v[40:41], v22 offset:8192
    ds_read_b64_tr_b16 v[42:43], v22 offset:8704
    v_mfma_f32_32x32x16_bf16 v[112:127], v[48:51], v[240:243], v[112:127]
    s_waitcnt lgkmcnt(8)
    ds_read_b64_tr_b16 v[44:45], v23 offset:8192
    ds_read_b64_tr_b16 v[46:47], v23 offset:8704
    v_mfma_f32_32x32x16_bf16 v[64:79], v[52:55], v[244:247], v[64:79]
    s_waitcnt lgkmcnt(8)
    ds_read_b64_tr_b16 v[48:49], v24 offset:8192
    ds_read_b64_tr_b16 v[50:51], v24 offset:8704
    v_mfma_f32_32x32x16_bf16 v[80:95], v[56:59], v[244:247], v[80:95]
    s_waitcnt lgkmcnt(8)
    ds_read_b64_tr_b16 v[52:53], v25 offset:8192
    ds_read_b64_tr_b16 v[54:55], v25 offset:8704
    v_mfma_f32_32x32x16_bf16 v[96:111], v[60:63], v[244:247], v[96:111]
    s_waitcnt lgkmcnt(8)
    ds_read_b64_tr_b16 v[56:57], v22 offset:28672
    ds_read_b64_tr_b16 v[58:59], v22 offset:29184
    v_mfma_f32_32x32x16_bf16 v[112:127], v[36:39], v[244:247], v[112:127]
    s_waitcnt lgkmcnt(8)
    ds_read_b64_tr_b16 v[60:61], v23 offset:28672
    ds_read_b64_tr_b16 v[62:63], v23 offset:29184
    v_mfma_f32_32x32x16_bf16 v[64:79], v[40:43], v[248:251], v[64:79]
    s_waitcnt lgkmcnt(8)
    ds_read_b64_tr_b16 v[36:37], v24 offset:28672
    ds_read_b64_tr_b16 v[38:39], v24 offset:29184
    v_mfma_f32_32x32x16_bf16 v[80:95], v[44:47], v[248:251], v[80:95]
    s_waitcnt lgkmcnt(8)
    ds_read_b64_tr_b16 v[40:41], v25 offset:28672
    ds_read_b64_tr_b16 v[42:43], v25 offset:29184
    s_cmp_ge_u32 s66, 8
    s_cbranch_scc1 L_g_m2b
    v_mfma_f32_32x32x16_bf16 v[96:111], v[48:51], v[248:251], v[96:111]
    s_waitcnt lgkmcnt(8)
    s_waitcnt vmcnt(8)
    s_barrier
    ds_read_b64_tr_b16 v[44:45], v8 offset:16384
    ds_read_b64_tr_b16 v[46:47], v8 offset:16896
    s_add_u32 m0, s61, 12288
    s_add_u32 s37, s48, 28672
    buffer_load_dwordx4 v4, s[16:19], s48 offen lds
    v_mfma_f32_32x32x16_bf16 v[112:127], v[52:55], v[248:251], v[112:127]
    s_waitcnt lgkmcnt(8)
    ds_read_b64_tr_b16 v[48:49], v9 offset:16384
    ds_read_b64_tr_b16 v[50:51], v9 offset:16896
    s_add_u32 m0, m0, 1024
    s_nop 0
    buffer_load_dwordx4 v4, s[16:19], s37 offen lds
    v_mfma_f32_32x32x16_bf16 v[64:79], v[56:59], v[252:255], v[64:79]
    s_waitcnt lgkmcnt(8)
    ds_read_b64_tr_b16 v[52:53], v10 offset:16384
    ds_read_b64_tr_b16 v[54:55], v10 offset:16896
    s_add_u32 m0, s61, 14336
    s_add_u32 s37, s48, 28672
    buffer_load_dwordx4 v5, s[20:23], s48 offen lds
    v_mfma_f32_32x32x16_bf16 v[80:95], v[60:63], v[252:255], v[80:95]
    s_waitcnt lgkmcnt(8)
    ds_read_b64_tr_b16 v[56:57], v11 offset:16384
    ds_read_b64_tr_b16 v[58:59], v11 offset:16896
    s_add_u32 m0, m0, 1024
    s_nop 0
    buffer_load_dwordx4 v5, s[20:23], s37 offen lds
    v_mfma_f32_32x32x16_bf16 v[96:111], v[36:39], v[252:255], v[96:111]
    s_waitcnt lgkmcnt(8)
    ds_read_b64_tr_b16 v[60:61], v8 offset:36864
    ds_read_b64_tr_b16 v[62:63], v8 offset:37376
    v_mfma_f32_32x32x16_bf16 v[112:127], v[40:43], v[252:255], v[112:127]
    s_waitcnt lgkmcnt(8)
    ds_read_b64_tr_b16 v[36:37], v9 offset:36864
    ds_read_b64_tr_b16 v[38:39], v9 offset:37376
    s_setprio 3
    s_nop 7
    v_exp_f32 v28, v64
    v_exp_f32 v29, v65
    v_exp_f32 v30, v66
    v_exp_f32 v31, v67
    v_exp_f32 v32, v68
    v_exp_f32 v33, v69
    v_exp_f32 v34, v70
    v_exp_f32 v35, v71
    v_mul_f32 v64, v64, v72
    v_mul_f32 v65, v65, v73
    v_mul_f32 v66, v66, v74
    v_mul_f32 v67, v67, v75
    v_mul_f32 v68, v68, v76
    v_mul_f32 v69, v69, v77
    v_mul_f32 v70, v70, v78
    v_mul_f32 v71, v71, v79
    v_fma_f32 v28, v28, s44, s44
    v_fma_f32 v29, v29, s44, s44
    v_fma_f32 v30, v30, s44, s44
    v_fma_f32 v31, v31, s44, s44
    v_fma_f32 v32, v32, s44, s44
    v_fma_f32 v33, v33, s44, s44
    v_fma_f32 v34, v34, s44, s44
    v_fma_f32 v35, v35, s44, s44
    v_rcp_f32 v28, v28
    v_rcp_f32 v29, v29
    v_rcp_f32 v30, v30
    v_rcp_f32 v31, v31
    v_rcp_f32 v32, v32
    v_rcp_f32 v33, v33
    v_rcp_f32 v34, v34
    v_rcp_f32 v35, v35
    v_mul_f32 v64, v64, v28
    v_mul_f32 v65, v65, v29
    v_mul_f32 v66, v66, v30
    v_mul_f32 v67, v67, v31
    v_mul_f32 v68, v68, v32
    v_mul_f32 v69, v69, v33
    v_mul_f32 v70, v70, v34
    v_mul_f32 v71, v71, v35
    v_cvt_pk_bf16_f32 v72, v64, v65
    v_cvt_pk_bf16_f32 v73, v66, v67
    v_cvt_pk_bf16_f32 v74, v68, v69
    v_cvt_pk_bf16_f32 v75, v70, v71
    buffer_store_dwordx4 v[72:75], v15, s[28:31], s64 offen offset:0 sc1
    v_exp_f32 v28, v80
    v_exp_f32 v29, v81
    v_exp_f32 v30, v82
    v_exp_f32 v31, v83
    v_exp_f32 v32, v84
    v_exp_f32 v33, v85
    v_exp_f32 v34, v86
    v_exp_f32 v35, v87
    v_mul_f32 v80, v80, v88
    v_mul_f32 v81, v81, v89
    v_mul_f32 v82, v82, v90
    v_mul_f32 v83, v83, v91
    v_mul_f32 v84, v84, v92
    v_mul_f32 v85, v85, v93
    v_mul_f32 v86, v86, v94
    v_mul_f32 v87, v87, v95
    v_fma_f32 v28, v28, s44, s44
    v_fma_f32 v29, v29, s44, s44
    v_fma_f32 v30, v30, s44, s44
    v_fma_f32 v31, v31, s44, s44
    v_fma_f32 v32, v32, s44, s44
    v_fma_f32 v33, v33, s44, s44
    v_fma_f32 v34, v34, s44, s44
    v_fma_f32 v35, v35, s44, s44
    v_rcp_f32 v28, v28
    v_rcp_f32 v29, v29
    v_rcp_f32 v30, v30
    v_rcp_f32 v31, v31
    v_rcp_f32 v32, v32
    v_rcp_f32 v33, v33
    v_rcp_f32 v34, v34
    v_rcp_f32 v35, v35
    v_mul_f32 v80, v80, v28
    v_mul_f32 v81, v81, v29
    v_mul_f32 v82, v82, v30
    v_mul_f32 v83, v83, v31
    v_mul_f32 v84, v84, v32
    v_mul_f32 v85, v85, v33
    v_mul_f32 v86, v86, v34
    v_mul_f32 v87, v87, v35
    v_cvt_pk_bf16_f32 v88, v80, v81
    v_cvt_pk_bf16_f32 v89, v82, v83
    v_cvt_pk_bf16_f32 v90, v84, v85
    v_cvt_pk_bf16_f32 v91, v86, v87
    buffer_store_dwordx4 v[88:91], v15, s[28:31], s64 offen offset:1024 sc1
    v_exp_f32 v28, v96
    v_exp_f32 v29, v97
    v_exp_f32 v30, v98
    v_exp_f32 v31, v99
    v_exp_f32 v32, v100
    v_exp_f32 v33, v101
    v_exp_f32 v34, v102
    v_exp_f32 v35, v103
    v_mul_f32 v96, v96, v104
    v_mul_f32 v97, v97, v105
    v_mul_f32 v98, v98, v106
    v_mul_f32 v99, v99, v107
    v_mul_f32 v100, v100, v108
    v_mul_f32 v101, v101, v109
    v_mul_f32 v102, v102, v110
    v_mul_f32 v103, v103, v111
    v_fma_f32 v28, v28, s44, s44
    v_fma_f32 v29, v29, s44, s44
    v_fma_f32 v30, v30, s44, s44
    v_fma_f32 v31, v31, s44, s44
    v_fma_f32 v32, v32, s44, s44
    v_fma_f32 v33, v33, s44, s44
    v_fma_f32 v34, v34, s44, s44
    v_fma_f32 v35, v35, s44, s44
    v_rcp_f32 v28, v28
    v_rcp_f32 v29, v29
    v_rcp_f32 v30, v30
    v_rcp_f32 v31, v31
    v_rcp_f32 v32, v32
    v_rcp_f32 v33, v33
    v_rcp_f32 v34, v34
    v_rcp_f32 v35, v35
    v_mul_f32 v96, v96, v28
    v_mul_f32 v97, v97, v29
    v_mul_f32 v98, v98, v30
    v_mul_f32 v99, v99, v31
    v_mul_f32 v100, v100, v32
    v_mul_f32 v101, v101, v33
    v_mul_f32 v102, v102, v34
    v_mul_f32 v103, v103, v35
    v_cvt_pk_bf16_f32 v104, v96, v97
    v_cvt_pk_bf16_f32 v105, v98, v99
    v_cvt_pk_bf16_f32 v106, v100, v101
    v_cvt_pk_bf16_f32 v107, v102, v103
    buffer_store_dwordx4 v[104:107], v15, s[28:31], s64 offen offset:2048 sc1
    v_exp_f32 v28, v112
    v_exp_f32 v29, v113
    v_exp_f32 v30, v114
    v_exp_f32 v31, v115
    v_exp_f32 v32, v116
    v_exp_f32 v33, v117
    v_exp_f32 v34, v118
    v_exp_f32 v35, v119
    v_mul_f32 v112, v112, v120
    v_mul_f32 v113, v113, v121
    v_mul_f32 v114, v114, v122
    v_mul_f32 v115, v115, v123
    v_mul_f32 v116, v116, v124
    v_mul_f32 v117, v117, v125
    v_mul_f32 v118, v118, v126
    v_mul_f32 v119, v119, v127
    v_fma_f32 v28, v28, s44, s44
    v_fma_f32 v29, v29, s44, s44
    v_fma_f32 v30, v30, s44, s44
    v_fma_f32 v31, v31, s44, s44
    v_fma_f32 v32, v32, s44, s44
    v_fma_f32 v33, v33, s44, s44
    v_fma_f32 v34, v34, s44, s44
    v_fma_f32 v35, v35, s44, s44
    v_rcp_f32 v28, v28
    v_rcp_f32 v29, v29
    v_rcp_f32 v30, v30
    v_rcp_f32 v31, v31
    v_rcp_f32 v32, v32
    v_rcp_f32 v33, v33
    v_rcp_f32 v34, v34
    v_rcp_f32 v35, v35
    v_mul_f32 v112, v112, v28
    v_mul_f32 v113, v113, v29
    v_mul_f32 v114, v114, v30
    v_mul_f32 v115, v115, v31
    v_mul_f32 v116, v116, v32
    v_mul_f32 v117, v117, v33
    v_mul_f32 v118, v118, v34
    v_mul_f32 v119, v119, v35
    v_cvt_pk_bf16_f32 v120, v112, v113
    v_cvt_pk_bf16_f32 v121, v114, v115
    v_cvt_pk_bf16_f32 v122, v116, v117
    v_cvt_pk_bf16_f32 v123, v118, v119
    buffer_store_dwordx4 v[120:123], v15, s[28:31], s64 offen offset:3072 sc1
    s_setprio 0
    s_nop 0
    v_mfma_f32_32x32x16_bf16 v[64:79], v[44:47], v[128:131], 0
    s_waitcnt lgkmcnt(8)
    ds_read_b64_tr_b16 v[40:41], v10 offset:36864
    ds_read_b64_tr_b16 v[42:43], v10 offset:37376
    v_mfma_f32_32x32x16_bf16 v[80:95], v[48:51], v[128:131], 0
    s_waitcnt lgkmcnt(8)
    ds_read_b64_tr_b16 v[44:45], v11 offset:36864
    ds_read_b64_tr_b16 v[46:47], v11 offset:37376
    v_mfma_f32_32x32x16_bf16 v[96:111], v[52:55], v[128:131], 0
    s_waitcnt lgkmcnt(8)
    ds_read_b64_tr_b16 v[48:49], v22 offset:16384
    ds_read_b64_tr_b16 v[50:51], v22 offset:16896
    v_mfma_f32_32x32x16_bf16 v[112:127], v[56:59], v[128:131], 0
    s_waitcnt lgkmcnt(8)
    ds_read_b64_tr_b16 v[52:53], v23 offset:16384
    ds_read_b64_tr_b16 v[54:55], v23 offset:16896
    v_mfma_f32_32x32x16_bf16 v[64:79], v[60:63], v[132:135], v[64:79]
    s_waitcnt lgkmcnt(8)
    ds_read_b64_tr_b16 v[56:57], v24 offset:16384
    ds_read_b64_tr_b16 v[58:59], v24 offset:16896
    v_mfma_f32_32x32x16_bf16 v[80:95], v[36:39], v[132:135], v[80:95]
    s_waitcnt lgkmcnt(8)
    ds_read_b64_tr_b16 v[60:61], v25 offset:16384
    ds_read_b64_tr_b16 v[62:63], v25 offset:16896
    v_mfma_f32_32x32x16_bf16 v[96:111], v[40:43], v[132:135], v[96:111]
    s_waitcnt lgkmcnt(8)
    ds_read_b64_tr_b16 v[36:37], v22 offset:36864
    ds_read_b64_tr_b16 v[38:39], v22 offset:37376
    v_mfma_f32_32x32x16_bf16 v[112:127], v[44:47], v[132:135], v[112:127]
    s_waitcnt lgkmcnt(8)
    ds_read_b64_tr_b16 v[40:41], v23 offset:36864
    ds_read_b64_tr_b16 v[42:43], v23 offset:37376
    v_mfma_f32_32x32x16_bf16 v[64:79], v[48:51], v[136:139], v[64:79]
    s_waitcnt lgkmcnt(8)
    ds_read_b64_tr_b16 v[44:45], v24 offset:36864
    ds_read_b64_tr_b16 v[46:47], v24 offset:37376
    v_mfma_f32_32x32x16_bf16 v[80:95], v[52:55], v[136:139], v[80:95]
    s_waitcnt lgkmcnt(8)
    ds_read_b64_tr_b16 v[48:49], v25 offset:36864
    ds_read_b64_tr_b16 v[50:51], v25 offset:37376
    v_mfma_f32_32x32x16_bf16 v[96:111], v[56:59], v[136:139], v[96:111]
    s_waitcnt lgkmcnt(8)
    s_waitcnt vmcnt(0)
    s_mov_b64 exec, 1
    buffer_store_dword v26, v27, s[28:31], s67 offen sc1
    s_mov_b64 exec, -1
    s_add_u32 s67, s67, 131072
    s_barrier
    ds_read_b64_tr_b16 v[52:53], v8 offset:0
    ds_read_b64_tr_b16 v[54:55], v8 offset:512
    s_add_u32 m0, s61, 8192
    s_add_u32 s37, s49, 28672
    buffer_load_dwordx4 v4, s[16:19], s49 offen lds
    v_mfma_f32_32x32x16_bf16 v[112:127], v[60:63], v[136:139], v[112:127]
    s_waitcnt lgkmcnt(8)
    ds_read_b64_tr_b16 v[56:57], v9 offset:0
    ds_read_b64_tr_b16 v[58:59], v9 offset:512
    s_add_u32 m0, m0, 1024
    s_nop 0
    buffer_load_dwordx4 v4, s[16:19], s37 offen lds
    v_mfma_f32_32x32x16_bf16 v[64:79], v[36:39], v[140:143], v[64:79]
    s_waitcnt lgkmcnt(8)
    ds_read_b64_tr_b16 v[60:61], v10 offset:0
    ds_read_b64_tr_b16 v[62:63], v10 offset:512
    s_add_u32 m0, s61, 10240
    s_add_u32 s37, s49, 28672
    buffer_load_dwordx4 v5, s[20:23], s49 offen lds
    v_mfma_f32_32x32x16_bf16 v[80:95], v[40:43], v[140:143], v[80:95]
    s_waitcnt lgkmcnt(8)
    ds_read_b64_tr_b16 v[36:37], v11 offset:0
    ds_read_b64_tr_b16 v[38:39], v11 offset:512
    s_add_u32 m0, m0, 1024
    s_nop 0
    buffer_load_dwordx4 v5, s[20:23], s37 offen lds
    v_mfma_f32_32x32x16_bf16 v[96:111], v[44:47], v[140:143], v[96:111]
    s_waitcnt lgkmcnt(8)
    ds_read_b64_tr_b16 v[40:41], v8 offset:20480
    ds_read_b64_tr_b16 v[42:43], v8 offset:20992
    v_mfma_f32_32x32x16_bf16 v[112:127], v[48:51], v[140:143], v[112:127]
    s_waitcnt lgkmcnt(8)
    ds_read_b64_tr_b16 v[44:45], v9 offset:20480
    ds_read_b64_tr_b16 v[46:47], v9 offset:20992
    v_mfma_f32_32x32x16_bf16 v[64:79], v[52:55], v[144:147], v[64:79]
    s_waitcnt lgkmcnt(8)
    ds_read_b64_tr_b16 v[48:49], v10 offset:20480
    ds_read_b64_tr_b16 v[50:51], v10 offset:20992
    v_mfma_f32_32x32x16_bf16 v[80:95], v[56:59], v[144:147], v[80:95]
    s_waitcnt lgkmcnt(8)
    ds_read_b64_tr_b16 v[52:53], v11 offset:20480
    ds_read_b64_tr_b16 v[54:55], v11 offset:20992
    v_mfma_f32_32x32x16_bf16 v[96:111], v[60:63], v[144:147], v[96:111]
    s_waitcnt lgkmcnt(8)
    ds_read_b64_tr_b16 v[56:57], v22 offset:0
    ds_read_b64_tr_b16 v[58:59], v22 offset:512
    v_mfma_f32_32x32x16_bf16 v[112:127], v[36:39], v[144:147], v[112:127]
    s_waitcnt lgkmcnt(8)
    ds_read_b64_tr_b16 v[60:61], v23 offset:0
    ds_read_b64_tr_b16 v[62:63], v23 offset:512
    v_mfma_f32_32x32x16_bf16 v[64:79], v[40:43], v[148:151], v[64:79]
    s_waitcnt lgkmcnt(8)
    ds_read_b64_tr_b16 v[36:37], v24 offset:0
    ds_read_b64_tr_b16 v[38:39], v24 offset:512
    v_mfma_f32_32x32x16_bf16 v[80:95], v[44:47], v[148:151], v[80:95]
    s_waitcnt lgkmcnt(8)
    ds_read_b64_tr_b16 v[40:41], v25 offset:0
    ds_read_b64_tr_b16 v[42:43], v25 offset:512
    v_mfma_f32_32x32x16_bf16 v[96:111], v[48:51], v[148:151], v[96:111]
    s_waitcnt lgkmcnt(8)
    ds_read_b64_tr_b16 v[44:45], v22 offset:20480
    ds_read_b64_tr_b16 v[46:47], v22 offset:20992
    v_mfma_f32_32x32x16_bf16 v[112:127], v[52:55], v[148:151], v[112:127]
    s_waitcnt lgkmcnt(8)
    ds_read_b64_tr_b16 v[48:49], v23 offset:20480
    ds_read_b64_tr_b16 v[50:51], v23 offset:20992
    v_mfma_f32_32x32x16_bf16 v[64:79], v[56:59], v[152:155], v[64:79]
    s_waitcnt lgkmcnt(8)
    ds_read_b64_tr_b16 v[52:53], v24 offset:20480
    ds_read_b64_tr_b16 v[54:55], v24 offset:20992
    v_mfma_f32_32x32x16_bf16 v[80:95], v[60:63], v[152:155], v[80:95]
    s_waitcnt lgkmcnt(8)
    ds_read_b64_tr_b16 v[56:57], v25 offset:20480
    ds_read_b64_tr_b16 v[58:59], v25 offset:20992
    v_mfma_f32_32x32x16_bf16 v[96:111], v[36:39], v[152:155], v[96:111]
    s_waitcnt lgkmcnt(8)
    s_waitcnt vmcnt(13)
    s_barrier
    ds_read_b64_tr_b16 v[60:61], v8 offset:4096
    ds_read_b64_tr_b16 v[62:63], v8 offset:4608
    s_add_u32 m0, s61, 16384
    s_add_u32 s37, s50, 28672
    buffer_load_dwordx4 v4, s[16:19], s50 offen lds
    v_mfma_f32_32x32x16_bf16 v[112:127], v[40:43], v[152:155], v[112:127]
    s_waitcnt lgkmcnt(8)
    ds_read_b64_tr_b16 v[36:37], v9 offset:4096
    ds_read_b64_tr_b16 v[38:39], v9 offset:4608
    s_add_u32 m0, m0, 1024
    s_nop 0
    buffer_load_dwordx4 v4, s[16:19], s37 offen lds
    v_mfma_f32_32x32x16_bf16 v[64:79], v[44:47], v[156:159], v[64:79]
    s_waitcnt lgkmcnt(8)
    ds_read_b64_tr_b16 v[40:41], v10 offset:4096
    ds_read_b64_tr_b16 v[42:43], v10 offset:4608
    s_add_u32 m0, s61, 18432
    s_add_u32 s37, s50, 28672
    buffer_load_dwordx4 v5, s[20:23], s50 offen lds
    v_mfma_f32_32x32x16_bf16 v[80:95], v[48:51], v[156:159], v[80:95]
    s_waitcnt lgkmcnt(8)
    ds_read_b64_tr_b16 v[44:45], v11 offset:4096
    ds_read_b64_tr_b16 v[46:47], v11 offset:4608
    s_add_u32 m0, m0, 1024
    s_nop 0
    buffer_load_dwordx4 v5, s[20:23], s37 offen lds
    v_mfma_f32_32x32x16_bf16 v[96:111], v[52:55], v[156:159], v[96:111]
    s_waitcnt lgkmcnt(8)
    ds_read_b64_tr_b16 v[48:49], v8 offset:24576
    ds_read_b64_tr_b16 v[50:51], v8 offset:25088
    v_mfma_f32_32x32x16_bf16 v[112:127], v[56:59], v[156:159], v[112:127]
    s_waitcnt lgkmcnt(8)
    ds_read_b64_tr_b16 v[52:53], v9 offset:24576
    ds_read_b64_tr_b16 v[54:55], v9 offset:25088
    v_mfma_f32_32x32x16_bf16 v[64:79], v[60:63], v[160:163], v[64:79]
    s_waitcnt lgkmcnt(8)
    ds_read_b64_tr_b16 v[56:57], v10 offset:24576
    ds_read_b64_tr_b16 v[58:59], v10 offset:25088
    v_mfma_f32_32x32x16_bf16 v[80:95], v[36:39], v[160:163], v[80:95]
    s_waitcnt lgkmcnt(8)
    ds_read_b64_tr_b16 v[60:61], v11 offset:24576
    ds_read_b64_tr_b16 v[62:63], v11 offset:25088
    v_mfma_f32_32x32x16_bf16 v[96:111], v[40:43], v[160:163], v[96:111]
    s_waitcnt lgkmcnt(8)
    ds_read_b64_tr_b16 v[36:37], v22 offset:4096
    ds_read_b64_tr_b16 v[38:39], v22 offset:4608
    v_mfma_f32_32x32x16_bf16 v[112:127], v[44:47], v[160:163], v[112:127]
    s_waitcnt lgkmcnt(8)
    ds_read_b64_tr_b16 v[40:41], v23 offset:4096
    ds_read_b64_tr_b16 v[42:43], v23 offset:4608
    v_mfma_f32_32x32x16_bf16 v[64:79], v[48:51], v[164:167], v[64:79]
    s_waitcnt lgkmcnt(8)
    ds_read_b64_tr_b16 v[44:45], v24 offset:4096
    ds_read_b64_tr_b16 v[46:47], v24 offset:4608
    v_mfma_f32_32x32x16_bf16 v[80:95], v[52:55], v[164:167], v[80:95]
    s_waitcnt lgkmcnt(8)
    ds_read_b64_tr_b16 v[48:49], v25 offset:4096
    ds_read_b64_tr_b16 v[50:51], v25 offset:4608
    v_mfma_f32_32x32x16_bf16 v[96:111], v[56:59], v[164:167], v[96:111]
    s_waitcnt lgkmcnt(8)
    ds_read_b64_tr_b16 v[52:53], v22 offset:24576
    ds_read_b64_tr_b16 v[54:55], v22 offset:25088
    v_mfma_f32_32x32x16_bf16 v[112:127], v[60:63], v[164:167], v[112:127]
    s_waitcnt lgkmcnt(8)
    ds_read_b64_tr_b16 v[56:57], v23 offset:24576
    ds_read_b64_tr_b16 v[58:59], v23 offset:25088
    v_mfma_f32_32x32x16_bf16 v[64:79], v[36:39], v[168:171], v[64:79]
    s_waitcnt lgkmcnt(8)
    ds_read_b64_tr_b16 v[60:61], v24 offset:24576
    ds_read_b64_tr_b16 v[62:63], v24 offset:25088
    v_mfma_f32_32x32x16_bf16 v[80:95], v[40:43], v[168:171], v[80:95]
    s_waitcnt lgkmcnt(8)
    ds_read_b64_tr_b16 v[36:37], v25 offset:24576
    ds_read_b64_tr_b16 v[38:39], v25 offset:25088
    v_mfma_f32_32x32x16_bf16 v[96:111], v[44:47], v[168:171], v[96:111]
    s_waitcnt lgkmcnt(8)
    s_waitcnt vmcnt(13)
    s_barrier
    ds_read_b64_tr_b16 v[40:41], v8 offset:12288
    ds_read_b64_tr_b16 v[42:43], v8 offset:12800
    s_add_u32 m0, s61, 0
    s_add_u32 s37, s51, 28672
    buffer_load_dwordx4 v4, s[16:19], s51 offen lds
    v_mfma_f32_32x32x16_bf16 v[112:127], v[48:51], v[168:171], v[112:127]
    s_waitcnt lgkmcnt(8)
    ds_read_b64_tr_b16 v[44:45], v9 offset:12288
    ds_read_b64_tr_b16 v[46:47], v9 offset:12800
    s_add_u32 m0, m0, 1024
    s_nop 0
    buffer_load_dwordx4 v4, s[16:19], s37 offen lds
    v_mfma_f32_32x32x16_bf16 v[64:79], v[52:55], v[172:175], v[64:79]
    s_waitcnt lgkmcnt(8)
    ds_read_b64_tr_b16 v[48:49], v10 offset:12288
    ds_read_b64_tr_b16 v[50:51], v10 offset:12800
    s_add_u32 m0, s61, 2048
    s_add_u32 s37, s51, 28672
    buffer_load_dwordx4 v5, s[20:23], s51 offen lds
    v_mfma_f32_32x32x16_bf16 v[80:95], v[56:59], v[172:175], v[80:95]
    s_waitcnt lgkmcnt(8)
    ds_read_b64_tr_b16 v[52:53], v11 offset:12288
    ds_read_b64_tr_b16 v[54:55], v11 offset:12800
    s_add_u32 m0, m0, 1024
    s_nop 0
    buffer_load_dwordx4 v5, s[20:23], s37 offen lds
    v_mfma_f32_32x32x16_bf16 v[96:111], v[60:63], v[172:175], v[96:111]
    s_waitcnt lgkmcnt(8)
    ds_read_b64_tr_b16 v[56:57], v8 offset:32768
    ds_read_b64_tr_b16 v[58:59], v8 offset:33280
    v_mfma_f32_32x32x16_bf16 v[112:127], v[36:39], v[172:175], v[112:127]
    s_waitcnt lgkmcnt(8)
    ds_read_b64_tr_b16 v[60:61], v9 offset:32768
    ds_read_b64_tr_b16 v[62:63], v9 offset:33280
    v_mfma_f32_32x32x16_bf16 v[64:79], v[40:43], v[176:179], v[64:79]
    s_waitcnt lgkmcnt(8)
    ds_read_b64_tr_b16 v[36:37], v10 offset:32768
    ds_read_b64_tr_b16 v[38:39], v10 offset:33280
    v_mfma_f32_32x32x16_bf16 v[80:95], v[44:47], v[176:179], v[80:95]
    s_waitcnt lgkmcnt(8)
    ds_read_b64_tr_b16 v[40:41], v11 offset:32768
    ds_read_b64_tr_b16 v[42:43], v11 offset:33280
    v_mfma_f32_32x32x16_bf16 v[96:111], v[48:51], v[176:179], v[96:111]
    s_waitcnt lgkmcnt(8)
    ds_read_b64_tr_b16 v[44:45], v22 offset:12288
    ds_read_b64_tr_b16 v[46:47], v22 offset:12800
    v_mfma_f32_32x32x16_bf16 v[112:127], v[52:55], v[176:179], v[112:127]
    s_waitcnt lgkmcnt(8)
    ds_read_b64_tr_b16 v[48:49], v23 offset:12288
    ds_read_b64_tr_b16 v[50:51], v23 offset:12800
    v_mfma_f32_32x32x16_bf16 v[64:79], v[56:59], v[180:183], v[64:79]
    s_waitcnt lgkmcnt(8)
    ds_read_b64_tr_b16 v[52:53], v24 offset:12288
    ds_read_b64_tr_b16 v[54:55], v24 offset:12800
    v_mfma_f32_32x32x16_bf16 v[80:95], v[60:63], v[180:183], v[80:95]
    s_waitcnt lgkmcnt(8)
    ds_read_b64_tr_b16 v[56:57], v25 offset:12288
    ds_read_b64_tr_b16 v[58:59], v25 offset:12800
    v_mfma_f32_32x32x16_bf16 v[96:111], v[36:39], v[180:183], v[96:111]
    s_waitcnt lgkmcnt(8)
    ds_read_b64_tr_b16 v[60:61], v22 offset:32768
    ds_read_b64_tr_b16 v[62:63], v22 offset:33280
    v_mfma_f32_32x32x16_bf16 v[112:127], v[40:43], v[180:183], v[112:127]
    s_waitcnt lgkmcnt(8)
    ds_read_b64_tr_b16 v[36:37], v23 offset:32768
    ds_read_b64_tr_b16 v[38:39], v23 offset:33280
    v_mfma_f32_32x32x16_bf16 v[64:79], v[44:47], v[184:187], v[64:79]
    s_waitcnt lgkmcnt(8)
    ds_read_b64_tr_b16 v[40:41], v24 offset:32768
    ds_read_b64_tr_b16 v[42:43], v24 offset:33280
    v_mfma_f32_32x32x16_bf16 v[80:95], v[48:51], v[184:187], v[80:95]
    s_waitcnt lgkmcnt(8)
    ds_read_b64_tr_b16 v[44:45], v25 offset:32768
    ds_read_b64_tr_b16 v[46:47], v25 offset:33280
    v_mfma_f32_32x32x16_bf16 v[96:111], v[52:55], v[184:187], v[96:111]
    s_waitcnt lgkmcnt(8)
    s_waitcnt vmcnt(8)
    s_barrier
    ds_read_b64_tr_b16 v[48:49], v8 offset:8192
    ds_read_b64_tr_b16 v[50:51], v8 offset:8704
    s_add_u32 m0, s61, 4096
    s_add_u32 s37, s52, 28672
    buffer_load_dwordx4 v4, s[16:19], s52 offen lds
    v_mfma_f32_32x32x16_bf16 v[112:127], v[56:59], v[184:187], v[112:127]
    s_waitcnt lgkmcnt(8)
    ds_read_b64_tr_b16 v[52:53], v9 offset:8192
    ds_read_b64_tr_b16 v[54:55], v9 offset:8704
    s_add_u32 m0, m0, 1024
    s_nop 0
    buffer_load_dwordx4 v4, s[16:19], s37 offen lds
    v_mfma_f32_32x32x16_bf16 v[64:79], v[60:63], v[188:191], v[64:79]
    s_waitcnt lgkmcnt(8)
    ds_read_b64_tr_b16 v[56:57], v10 offset:8192
    ds_read_b64_tr_b16 v[58:59], v10 offset:8704
    s_add_u32 m0, s61, 6144
    s_add_u32 s37, s52, 28672
    buffer_load_dwordx4 v5, s[20:23], s52 offen lds
    v_mfma_f32_32x32x16_bf16 v[80:95], v[36:39], v[188:191], v[80:95]
    s_waitcnt lgkmcnt(8)
    ds_read_b64_tr_b16 v[60:61], v11 offset:8192
    ds_read_b64_tr_b16 v[62:63], v11 offset:8704
    s_add_u32 m0, m0, 1024
    s_nop 0
    buffer_load_dwordx4 v5, s[20:23], s37 offen lds
    v_mfma_f32_32x32x16_bf16 v[96:111], v[40:43], v[188:191], v[96:111]
    s_waitcnt lgkmcnt(8)
    ds_read_b64_tr_b16 v[36:37], v8 offset:28672
    ds_read_b64_tr_b16 v[38:39], v8 offset:29184
    v_mfma_f32_32x32x16_bf16 v[112:127], v[44:47], v[188:191], v[112:127]
    s_waitcnt lgkmcnt(8)
    ds_read_b64_tr_b16 v[40:41], v9 offset:28672
    ds_read_b64_tr_b16 v[42:43], v9 offset:29184
    v_mfma_f32_32x32x16_bf16 v[64:79], v[48:51], v[192:195], v[64:79]
    s_waitcnt lgkmcnt(8)
    ds_read_b64_tr_b16 v[44:45], v10 offset:28672
    ds_read_b64_tr_b16 v[46:47], v10 offset:29184
    v_mfma_f32_32x32x16_bf16 v[80:95], v[52:55], v[192:195], v[80:95]
    s_waitcnt lgkmcnt(8)
    ds_read_b64_tr_b16 v[48:49], v11 offset:28672
    ds_read_b64_tr_b16 v[50:51], v11 offset:29184
    v_mfma_f32_32x32x16_bf16 v[96:111], v[56:59], v[192:195], v[96:111]
    s_waitcnt lgkmcnt(8)
    ds_read_b64_tr_b16 v[52:53], v22 offset:8192
    ds_read_b64_tr_b16 v[54:55], v22 offset:8704
    v_mfma_f32_32x32x16_bf16 v[112:127], v[60:63], v[192:195], v[112:127]
    s_waitcnt lgkmcnt(8)
    ds_read_b64_tr_b16 v[56:57], v23 offset:8192
    ds_read_b64_tr_b16 v[58:59], v23 offset:8704
    v_mfma_f32_32x32x16_bf16 v[64:79], v[36:39], v[196:199], v[64:79]
    s_waitcnt lgkmcnt(8)
    ds_read_b64_tr_b16 v[60:61], v24 offset:8192
    ds_read_b64_tr_b16 v[62:63], v24 offset:8704
    v_mfma_f32_32x32x16_bf16 v[80:95], v[40:43], v[196:199], v[80:95]
    s_waitcnt lgkmcnt(8)
    ds_read_b64_tr_b16 v[36:37], v25 offset:8192
    ds_read_b64_tr_b16 v[38:39], v25 offset:8704
    v_mfma_f32_32x32x16_bf16 v[96:111], v[44:47], v[196:199], v[96:111]
    s_waitcnt lgkmcnt(8)
    ds_read_b64_tr_b16 v[40:41], v22 offset:28672
    ds_read_b64_tr_b16 v[42:43], v22 offset:29184
    v_mfma_f32_32x32x16_bf16 v[112:127], v[48:51], v[196:199], v[112:127]
    s_waitcnt lgkmcnt(8)
    ds_read_b64_tr_b16 v[44:45], v23 offset:28672
    ds_read_b64_tr_b16 v[46:47], v23 offset:29184
    v_mfma_f32_32x32x16_bf16 v[64:79], v[52:55], v[200:203], v[64:79]
    s_waitcnt lgkmcnt(8)
    ds_read_b64_tr_b16 v[48:49], v24 offset:28672
    ds_read_b64_tr_b16 v[50:51], v24 offset:29184
    v_mfma_f32_32x32x16_bf16 v[80:95], v[56:59], v[200:203], v[80:95]
    s_waitcnt lgkmcnt(8)
    ds_read_b64_tr_b16 v[52:53], v25 offset:28672
    ds_read_b64_tr_b16 v[54:55], v25 offset:29184
    v_mfma_f32_32x32x16_bf16 v[96:111], v[60:63], v[200:203], v[96:111]
    s_waitcnt lgkmcnt(8)
    s_waitcnt vmcnt(8)
    s_barrier
    ds_read_b64_tr_b16 v[56:57], v8 offset:16384
    ds_read_b64_tr_b16 v[58:59], v8 offset:16896
    s_add_u32 m0, s61, 12288
    s_lshl_b32 s43, s41, 16
    buffer_load_dwordx4 v6, s[56:59], s43 offen lds
    v_mfma_f32_32x32x16_bf16 v[112:127], v[36:39], v[200:203], v[112:127]
    s_waitcnt lgkmcnt(8)
    ds_read_b64_tr_b16 v[60:61], v9 offset:16384
    ds_read_b64_tr_b16 v[62:63], v9 offset:16896
    s_add_u32 m0, m0, 1024
    s_add_u32 s43, s43, 8192
    buffer_load_dwordx4 v6, s[56:59], s43 offen lds
    s_add_u32 s41, s41, 1
    s_and_b32 s41, s41, 15
    v_mfma_f32_32x32x16_bf16 v[64:79], v[40:43], v[204:207], v[64:79]
    s_waitcnt lgkmcnt(8)
    ds_read_b64_tr_b16 v[36:37], v10 offset:16384
    ds_read_b64_tr_b16 v[38:39], v10 offset:16896
    s_add_u32 m0, s61, 14336
    s_lshl_b32 s43, s41, 16
    buffer_load_dwordx4 v6, s[56:59], s43 offen lds
    v_mfma_f32_32x32x16_bf16 v[80:95], v[44:47], v[204:207], v[80:95]
    s_waitcnt lgkmcnt(8)
    ds_read_b64_tr_b16 v[40:41], v11 offset:16384
    ds_read_b64_tr_b16 v[42:43], v11 offset:16896
    s_add_u32 m0, m0, 1024
    s_add_u32 s43, s43, 8192
    buffer_load_dwordx4 v6, s[56:59], s43 offen lds
    s_add_u32 s41, s41, 1
    s_and_b32 s41, s41, 15
    v_mfma_f32_32x32x16_bf16 v[96:111], v[48:51], v[204:207], v[96:111]
    s_waitcnt lgkmcnt(8)
    ds_read_b64_tr_b16 v[44:45], v8 offset:36864
    ds_read_b64_tr_b16 v[46:47], v8 offset:37376
    v_mfma_f32_32x32x16_bf16 v[112:127], v[52:55], v[204:207], v[112:127]
    s_waitcnt lgkmcnt(8)
    ds_read_b64_tr_b16 v[48:49], v9 offset:36864
    ds_read_b64_tr_b16 v[50:51], v9 offset:37376
    v_mfma_f32_32x32x16_bf16 v[64:79], v[56:59], v[208:211], v[64:79]
    s_waitcnt lgkmcnt(8)
    ds_read_b64_tr_b16 v[52:53], v10 offset:36864
    ds_read_b64_tr_b16 v[54:55], v10 offset:37376
    v_mfma_f32_32x32x16_bf16 v[80:95], v[60:63], v[208:211], v[80:95]
    s_waitcnt lgkmcnt(8)
    ds_read_b64_tr_b16 v[56:57], v11 offset:36864
    ds_read_b64_tr_b16 v[58:59], v11 offset:37376
    v_mfma_f32_32x32x16_bf16 v[96:111], v[36:39], v[208:211], v[96:111]
    s_waitcnt lgkmcnt(8)
    ds_read_b64_tr_b16 v[60:61], v22 offset:16384
    ds_read_b64_tr_b16 v[62:63], v22 offset:16896
    v_mfma_f32_32x32x16_bf16 v[112:127], v[40:43], v[208:211], v[112:127]
    s_waitcnt lgkmcnt(8)
    ds_read_b64_tr_b16 v[36:37], v23 offset:16384
    ds_read_b64_tr_b16 v[38:39], v23 offset:16896
    v_mfma_f32_32x32x16_bf16 v[64:79], v[44:47], v[212:215], v[64:79]
    s_waitcnt lgkmcnt(8)
    ds_read_b64_tr_b16 v[40:41], v24 offset:16384
    ds_read_b64_tr_b16 v[42:43], v24 offset:16896
    v_mfma_f32_32x32x16_bf16 v[80:95], v[48:51], v[212:215], v[80:95]
    s_waitcnt lgkmcnt(8)
    ds_read_b64_tr_b16 v[44:45], v25 offset:16384
    ds_read_b64_tr_b16 v[46:47], v25 offset:16896
    v_mfma_f32_32x32x16_bf16 v[96:111], v[52:55], v[212:215], v[96:111]
    s_waitcnt lgkmcnt(8)
    ds_read_b64_tr_b16 v[48:49], v22 offset:36864
    ds_read_b64_tr_b16 v[50:51], v22 offset:37376
    v_mfma_f32_32x32x16_bf16 v[112:127], v[56:59], v[212:215], v[112:127]
    s_waitcnt lgkmcnt(8)
    ds_read_b64_tr_b16 v[52:53], v23 offset:36864
    ds_read_b64_tr_b16 v[54:55], v23 offset:37376
    v_mfma_f32_32x32x16_bf16 v[64:79], v[60:63], v[216:219], v[64:79]
    s_waitcnt lgkmcnt(8)
    ds_read_b64_tr_b16 v[56:57], v24 offset:36864
    ds_read_b64_tr_b16 v[58:59], v24 offset:37376
    v_mfma_f32_32x32x16_bf16 v[80:95], v[36:39], v[216:219], v[80:95]
    s_waitcnt lgkmcnt(8)
    ds_read_b64_tr_b16 v[60:61], v25 offset:36864
    ds_read_b64_tr_b16 v[62:63], v25 offset:37376
    v_mfma_f32_32x32x16_bf16 v[96:111], v[40:43], v[216:219], v[96:111]
    s_waitcnt lgkmcnt(8)
    s_waitcnt vmcnt(8)
    s_barrier
    ds_read_b64_tr_b16 v[36:37], v8 offset:0
    ds_read_b64_tr_b16 v[38:39], v8 offset:512
    s_add_u32 m0, s61, 8192
    s_lshl_b32 s43, s41, 16
    buffer_load_dwordx4 v6, s[56:59], s43 offen lds
    v_mfma_f32_32x32x16_bf16 v[112:127], v[44:47], v[216:219], v[112:127]
    s_waitcnt lgkmcnt(8)
    ds_read_b64_tr_b16 v[40:41], v9 offset:0
    ds_read_b64_tr_b16 v[42:43], v9 offset:512
    s_add_u32 m0, m0, 1024
    s_add_u32 s43, s43, 8192
    buffer_load_dwordx4 v6, s[56:59], s43 offen lds
    s_add_u32 s41, s41, 1
    s_and_b32 s41, s41, 15
    v_mfma_f32_32x32x16_bf16 v[64:79], v[48:51], v[220:223], v[64:79]
    s_waitcnt lgkmcnt(8)
    ds_read_b64_tr_b16 v[44:45], v10 offset:0
    ds_read_b64_tr_b16 v[46:47], v10 offset:512
    s_add_u32 m0, s61, 10240
    s_lshl_b32 s43, s41, 16
    buffer_load_dwordx4 v6, s[56:59], s43 offen lds
    v_mfma_f32_32x32x16_bf16 v[80:95], v[52:55], v[220:223], v[80:95]
    s_waitcnt lgkmcnt(8)
    ds_read_b64_tr_b16 v[48:49], v11 offset:0
    ds_read_b64_tr_b16 v[50:51], v11 offset:512
    s_add_u32 m0, m0, 1024
    s_add_u32 s43, s43, 8192
    buffer_load_dwordx4 v6, s[56:59], s43 offen lds
    s_add_u32 s41, s41, 1
    s_and_b32 s41, s41, 15
    v_mfma_f32_32x32x16_bf16 v[96:111], v[56:59], v[220:223], v[96:111]
    s_waitcnt lgkmcnt(8)
    ds_read_b64_tr_b16 v[52:53], v8 offset:20480
    ds_read_b64_tr_b16 v[54:55], v8 offset:20992
    v_mfma_f32_32x32x16_bf16 v[112:127], v[60:63], v[220:223], v[112:127]
    s_waitcnt lgkmcnt(8)
    ds_read_b64_tr_b16 v[56:57], v9 offset:20480
    ds_read_b64_tr_b16 v[58:59], v9 offset:20992
    v_mfma_f32_32x32x16_bf16 v[64:79], v[36:39], v[224:227], v[64:79]
    s_waitcnt lgkmcnt(8)
    ds_read_b64_tr_b16 v[60:61], v10 offset:20480
    ds_read_b64_tr_b16 v[62:63], v10 offset:20992
    v_mfma_f32_32x32x16_bf16 v[80:95], v[40:43], v[224:227], v[80:95]
    s_waitcnt lgkmcnt(8)
    ds_read_b64_tr_b16 v[36:37], v11 offset:20480
    ds_read_b64_tr_b16 v[38:39], v11 offset:20992
    v_mfma_f32_32x32x16_bf16 v[96:111], v[44:47], v[224:227], v[96:111]
    s_waitcnt lgkmcnt(8)
    ds_read_b64_tr_b16 v[40:41], v22 offset:0
    ds_read_b64_tr_b16 v[42:43], v22 offset:512
    v_mfma_f32_32x32x16_bf16 v[112:127], v[48:51], v[224:227], v[112:127]
    s_waitcnt lgkmcnt(8)
    ds_read_b64_tr_b16 v[44:45], v23 offset:0
    ds_read_b64_tr_b16 v[46:47], v23 offset:512
    v_mfma_f32_32x32x16_bf16 v[64:79], v[52:55], v[228:231], v[64:79]
    s_waitcnt lgkmcnt(8)
    ds_read_b64_tr_b16 v[48:49], v24 offset:0
    ds_read_b64_tr_b16 v[50:51], v24 offset:512
    v_mfma_f32_32x32x16_bf16 v[80:95], v[56:59], v[228:231], v[80:95]
    s_waitcnt lgkmcnt(8)
    ds_read_b64_tr_b16 v[52:53], v25 offset:0
    ds_read_b64_tr_b16 v[54:55], v25 offset:512
    v_mfma_f32_32x32x16_bf16 v[96:111], v[60:63], v[228:231], v[96:111]
    s_waitcnt lgkmcnt(8)
    ds_read_b64_tr_b16 v[56:57], v22 offset:20480
    ds_read_b64_tr_b16 v[58:59], v22 offset:20992
    v_mfma_f32_32x32x16_bf16 v[112:127], v[36:39], v[228:231], v[112:127]
    s_waitcnt lgkmcnt(8)
    ds_read_b64_tr_b16 v[60:61], v23 offset:20480
    ds_read_b64_tr_b16 v[62:63], v23 offset:20992
    v_mfma_f32_32x32x16_bf16 v[64:79], v[40:43], v[232:235], v[64:79]
    s_waitcnt lgkmcnt(8)
    ds_read_b64_tr_b16 v[36:37], v24 offset:20480
    ds_read_b64_tr_b16 v[38:39], v24 offset:20992
    v_mfma_f32_32x32x16_bf16 v[80:95], v[44:47], v[232:235], v[80:95]
    s_waitcnt lgkmcnt(8)
    ds_read_b64_tr_b16 v[40:41], v25 offset:20480
    ds_read_b64_tr_b16 v[42:43], v25 offset:20992
    v_mfma_f32_32x32x16_bf16 v[96:111], v[48:51], v[232:235], v[96:111]
    s_waitcnt lgkmcnt(8)
    s_waitcnt vmcnt(8)
    s_barrier
    ds_read_b64_tr_b16 v[44:45], v8 offset:4096
    ds_read_b64_tr_b16 v[46:47], v8 offset:4608
    buffer_load_dword v20, v18, s[28:31], 0 offen sc1
    s_mov_b32 s41, s63
    v_mfma_f32_32x32x16_bf16 v[112:127], v[52:55], v[232:235], v[112:127]
    s_waitcnt lgkmcnt(8)
    ds_read_b64_tr_b16 v[48:49], v9 offset:4096
    ds_read_b64_tr_b16 v[50:51], v9 offset:4608
    v_mfma_f32_32x32x16_bf16 v[64:79], v[56:59], v[236:239], v[64:79]
    s_waitcnt lgkmcnt(8)
    ds_read_b64_tr_b16 v[52:53], v10 offset:4096
    ds_read_b64_tr_b16 v[54:55], v10 offset:4608
    v_mfma_f32_32x32x16_bf16 v[80:95], v[60:63], v[236:239], v[80:95]
    s_waitcnt lgkmcnt(8)
    ds_read_b64_tr_b16 v[56:57], v11 offset:4096
    ds_read_b64_tr_b16 v[58:59], v11 offset:4608
    v_mfma_f32_32x32x16_bf16 v[96:111], v[36:39], v[236:239], v[96:111]
    s_waitcnt lgkmcnt(8)
    ds_read_b64_tr_b16 v[60:61], v8 offset:24576
    ds_read_b64_tr_b16 v[62:63], v8 offset:25088
    v_mfma_f32_32x32x16_bf16 v[112:127], v[40:43], v[236:239], v[112:127]
    s_waitcnt lgkmcnt(8)
    ds_read_b64_tr_b16 v[36:37], v9 offset:24576
    ds_read_b64_tr_b16 v[38:39], v9 offset:25088
    v_mfma_f32_32x32x16_bf16 v[64:79], v[44:47], v[240:243], v[64:79]
    s_waitcnt lgkmcnt(8)
    ds_read_b64_tr_b16 v[40:41], v10 offset:24576
    ds_read_b64_tr_b16 v[42:43], v10 offset:25088
    v_mfma_f32_32x32x16_bf16 v[80:95], v[48:51], v[240:243], v[80:95]
    s_waitcnt lgkmcnt(8)
    ds_read_b64_tr_b16 v[44:45], v11 offset:24576
    ds_read_b64_tr_b16 v[46:47], v11 offset:25088
    v_mfma_f32_32x32x16_bf16 v[96:111], v[52:55], v[240:243], v[96:111]
    s_waitcnt lgkmcnt(8)
    ds_read_b64_tr_b16 v[48:49], v22 offset:4096
    ds_read_b64_tr_b16 v[50:51], v22 offset:4608
    v_mfma_f32_32x32x16_bf16 v[112:127], v[56:59], v[240:243], v[112:127]
    s_waitcnt lgkmcnt(8)
    ds_read_b64_tr_b16 v[52:53], v23 offset:4096
    ds_read_b64_tr_b16 v[54:55], v23 offset:4608
    v_mfma_f32_32x32x16_bf16 v[64:79], v[60:63], v[244:247], v[64:79]
    s_waitcnt lgkmcnt(8)
    ds_read_b64_tr_b16 v[56:57], v24 offset:4096
    ds_read_b64_tr_b16 v[58:59], v24 offset:4608
    v_mfma_f32_32x32x16_bf16 v[80:95], v[36:39], v[244:247], v[80:95]
    s_waitcnt lgkmcnt(8)
    ds_read_b64_tr_b16 v[60:61], v25 offset:4096
    ds_read_b64_tr_b16 v[62:63], v25 offset:4608
    s_setprio 3
    s_waitcnt vmcnt(0)
    v_cmp_ne_u32 s[6:7], s33, v20
    s_nop 3
    s_cmp_eq_u64 s[6:7], 0
    s_cbranch_scc1 L_g_pollha_done
L_g_pollha:
    buffer_load_dword v20, v18, s[28:31], 0 offen sc1
    s_waitcnt vmcnt(0)
    v_xor_b32 v20, s33, v20
    v_cmp_ne_u32 s[6:7], 0, v20
    s_nop 3
    s_cmp_eq_u64 s[6:7], 0
    s_cbranch_scc1 L_g_pollha_done
    s_sleep 4
    s_sub_u32 s3, s3, 1
    s_cbranch_scc0 L_g_pollha
    s_mov_b32 s3, 0
L_g_pollha_done:
    s_setprio 0
    s_lshl_b32 s39, s41, 12
    s_add_u32 s39, s39, s42
    buffer_load_dwordx4 v[128:131], v15, s[28:31], s39 offen sc1
    v_mfma_f32_32x32x16_bf16 v[96:111], v[40:43], v[244:247], v[96:111]
    s_waitcnt lgkmcnt(8)
    ds_read_b64_tr_b16 v[36:37], v22 offset:24576
    ds_read_b64_tr_b16 v[38:39], v22 offset:25088
    s_add_u32 s39, s39, s54
    buffer_load_dwordx4 v[132:135], v15, s[28:31], s39 offen sc1
    s_add_u32 s41, s41, 1
    s_and_b32 s41, s41, 15
    v_mfma_f32_32x32x16_bf16 v[112:127], v[44:47], v[244:247], v[112:127]
    s_waitcnt lgkmcnt(8)
    ds_read_b64_tr_b16 v[40:41], v23 offset:24576
    ds_read_b64_tr_b16 v[42:43], v23 offset:25088
    s_lshl_b32 s39, s41, 12
    s_add_u32 s39, s39, s42
    buffer_load_dwordx4 v[136:139], v15, s[28:31], s39 offen sc1
    v_mfma_f32_32x32x16_bf16 v[64:79], v[48:51], v[248:251], v[64:79]
    s_waitcnt lgkmcnt(8)
    ds_read_b64_tr_b16 v[44:45], v24 offset:24576
    ds_read_b64_tr_b16 v[46:47], v24 offset:25088
    s_add_u32 s39, s39, s54
    buffer_load_dwordx4 v[140:143], v15, s[28:31], s39 offen sc1
    s_add_u32 s41, s41, 1
    s_and_b32 s41, s41, 15
    v_mfma_f32_32x32x16_bf16 v[80:95], v[52:55], v[248:251], v[80:95]
    s_waitcnt lgkmcnt(8)
    ds_read_b64_tr_b16 v[48:49], v25 offset:24576
    ds_read_b64_tr_b16 v[50:51], v25 offset:25088
    s_lshl_b32 s39, s41, 12
    s_add_u32 s39, s39, s42
    buffer_load_dwordx4 v[144:147], v15, s[28:31], s39 offen sc1
    v_mfma_f32_32x32x16_bf16 v[96:111], v[56:59], v[248:251], v[96:111]
    s_waitcnt lgkmcnt(8)
    s_add_u32 s39, s39, s54
    buffer_load_dwordx4 v[148:151], v15, s[28:31], s39 offen sc1
    s_add_u32 s41, s41, 1
    s_and_b32 s41, s41, 15
    v_mfma_f32_32x32x16_bf16 v[112:127], v[60:63], v[248:251], v[112:127]
    s_waitcnt lgkmcnt(6)
    s_lshl_b32 s39, s41, 12
    s_add_u32 s39, s39, s42
    buffer_load_dwordx4 v[152:155], v15, s[28:31], s39 offen sc1
    v_mfma_f32_32x32x16_bf16 v[64:79], v[36:39], v[252:255], v[64:79]
    s_waitcnt lgkmcnt(4)
    s_add_u32 s39, s39, s54
    buffer_load_dwordx4 v[156:159], v15, s[28:31], s39 offen sc1
    s_add_u32 s41, s41, 1
    s_and_b32 s41, s41, 15
    v_mfma_f32_32x32x16_bf16 v[80:95], v[40:43], v[252:255], v[80:95]
    s_waitcnt lgkmcnt(2)
    v_mfma_f32_32x32x16_bf16 v[96:111], v[44:47], v[252:255], v[96:111]
    s_waitcnt lgkmcnt(0)
    v_mfma_f32_32x32x16_bf16 v[112:127], v[48:51], v[252:255], v[112:127]
    buffer_load_dwordx2 v[44:45], v14, s[8:11], 0 offen offset:0
    buffer_load_dwordx2 v[46:47], v14, s[8:11], 0 offen offset:16
    buffer_load_dwordx2 v[48:49], v14, s[8:11], 0 offen offset:32
    buffer_load_dwordx2 v[50:51], v14, s[8:11], 0 offen offset:48
    s_barrier
    s_setprio 3
    s_nop 7
    v_exp_f32 v28, v64
    v_exp_f32 v29, v65
    v_exp_f32 v30, v66
    v_exp_f32 v31, v67
    v_exp_f32 v32, v68
    v_exp_f32 v33, v69
    v_exp_f32 v34, v70
    v_exp_f32 v35, v71
    v_mul_f32 v64, v64, v72
    v_mul_f32 v65, v65, v73
    v_mul_f32 v66, v66, v74
    v_mul_f32 v67, v67, v75
    v_mul_f32 v68, v68, v76
    v_mul_f32 v69, v69, v77
    v_mul_f32 v70, v70, v78
    v_mul_f32 v71, v71, v79
    v_fma_f32 v28, v28, s44, s44
    v_fma_f32 v29, v29, s44, s44
    v_fma_f32 v30, v30, s44, s44
    v_fma_f32 v31, v31, s44, s44
    v_fma_f32 v32, v32, s44, s44
    v_fma_f32 v33, v33, s44, s44
    v_fma_f32 v34, v34, s44, s44
    v_fma_f32 v35, v35, s44, s44
    v_rcp_f32 v28, v28
    v_rcp_f32 v29, v29
    v_rcp_f32 v30, v30
    v_rcp_f32 v31, v31
    v_rcp_f32 v32, v32
    v_rcp_f32 v33, v33
    v_rcp_f32 v34, v34
    v_rcp_f32 v35, v35
    v_mul_f32 v64, v64, v28
    v_mul_f32 v65, v65, v29
    v_mul_f32 v66, v66, v30
    v_mul_f32 v67, v67, v31
    v_mul_f32 v68, v68, v32
    v_mul_f32 v69, v69, v33
    v_mul_f32 v70, v70, v34
    v_mul_f32 v71, v71, v35
    v_cvt_pk_bf16_f32 v72, v64, v65
    v_cvt_pk_bf16_f32 v73, v66, v67
    v_cvt_pk_bf16_f32 v74, v68, v69
    v_cvt_pk_bf16_f32 v75, v70, v71
    buffer_store_dwordx4 v[72:75], v15, s[28:31], s60 offen offset:0 sc1
    v_exp_f32 v28, v80
    v_exp_f32 v29, v81
    v_exp_f32 v30, v82
    v_exp_f32 v31, v83
    v_exp_f32 v32, v84
    v_exp_f32 v33, v85
    v_exp_f32 v34, v86
    v_exp_f32 v35, v87
    v_mul_f32 v80, v80, v88
    v_mul_f32 v81, v81, v89
    v_mul_f32 v82, v82, v90
    v_mul_f32 v83, v83, v91
    v_mul_f32 v84, v84, v92
    v_mul_f32 v85, v85, v93
    v_mul_f32 v86, v86, v94
    v_mul_f32 v87, v87, v95
    v_fma_f32 v28, v28, s44, s44
    v_fma_f32 v29, v29, s44, s44
    v_fma_f32 v30, v30, s44, s44
    v_fma_f32 v31, v31, s44, s44
    v_fma_f32 v32, v32, s44, s44
    v_fma_f32 v33, v33, s44, s44
    v_fma_f32 v34, v34, s44, s44
    v_fma_f32 v35, v35, s44, s44
    v_rcp_f32 v28, v28
    v_rcp_f32 v29, v29
    v_rcp_f32 v30, v30
    v_rcp_f32 v31, v31
    v_rcp_f32 v32, v32
    v_rcp_f32 v33, v33
    v_rcp_f32 v34, v34
    v_rcp_f32 v35, v35
    v_mul_f32 v80, v80, v28
    v_mul_f32 v81, v81, v29
    v_mul_f32 v82, v82, v30
    v_mul_f32 v83, v83, v31
    v_mul_f32 v84, v84, v32
    v_mul_f32 v85, v85, v33
    v_mul_f32 v86, v86, v34
    v_mul_f32 v87, v87, v35
    v_cvt_pk_bf16_f32 v88, v80, v81
    v_cvt_pk_bf16_f32 v89, v82, v83
    v_cvt_pk_bf16_f32 v90, v84, v85
    v_cvt_pk_bf16_f32 v91, v86, v87
    buffer_store_dwordx4 v[88:91], v15, s[28:31], s60 offen offset:1024 sc1
    v_exp_f32 v28, v96
    v_exp_f32 v29, v97
    v_exp_f32 v30, v98
    v_exp_f32 v31, v99
    v_exp_f32 v32, v100
    v_exp_f32 v33, v101
    v_exp_f32 v34, v102
    v_exp_f32 v35, v103
    v_mul_f32 v96, v96, v104
    v_mul_f32 v97, v97, v105
    v_mul_f32 v98, v98, v106
    v_mul_f32 v99, v99, v107
    v_mul_f32 v100, v100, v108
    v_mul_f32 v101, v101, v109
    v_mul_f32 v102, v102, v110
    v_mul_f32 v103, v103, v111
    v_fma_f32 v28, v28, s44, s44
    v_fma_f32 v29, v29, s44, s44
    v_fma_f32 v30, v30, s44, s44
    v_fma_f32 v31, v31, s44, s44
    v_fma_f32 v32, v32, s44, s44
    v_fma_f32 v33, v33, s44, s44
    v_fma_f32 v34, v34, s44, s44
    v_fma_f32 v35, v35, s44, s44
    v_rcp_f32 v28, v28
    v_rcp_f32 v29, v29
    v_rcp_f32 v30, v30
    v_rcp_f32 v31, v31
    v_rcp_f32 v32, v32
    v_rcp_f32 v33, v33
    v_rcp_f32 v34, v34
    v_rcp_f32 v35, v35
    v_mul_f32 v96, v96, v28
    v_mul_f32 v97, v97, v29
    v_mul_f32 v98, v98, v30
    v_mul_f32 v99, v99, v31
    v_mul_f32 v100, v100, v32
    v_mul_f32 v101, v101, v33
    v_mul_f32 v102, v102, v34
    v_mul_f32 v103, v103, v35
    v_cvt_pk_bf16_f32 v104, v96, v97
    v_cvt_pk_bf16_f32 v105, v98, v99
    v_cvt_pk_bf16_f32 v106, v100, v101
    v_cvt_pk_bf16_f32 v107, v102, v103
    buffer_store_dwordx4 v[104:107], v15, s[28:31], s60 offen offset:2048 sc1
    v_exp_f32 v28, v112
    v_exp_f32 v29, v113
    v_exp_f32 v30, v114
    v_exp_f32 v31, v115
    v_exp_f32 v32, v116
    v_exp_f32 v33, v117
    v_exp_f32 v34, v118
    v_exp_f32 v35, v119
    v_mul_f32 v112, v112, v120
    v_mul_f32 v113, v113, v121
    v_mul_f32 v114, v114, v122
    v_mul_f32 v115, v115, v123
    v_mul_f32 v116, v116, v124
    v_mul_f32 v117, v117, v125
    v_mul_f32 v118, v118, v126
    v_mul_f32 v119, v119, v127
    v_fma_f32 v28, v28, s44, s44
    v_fma_f32 v29, v29, s44, s44
    v_fma_f32 v30, v30, s44, s44
    v_fma_f32 v31, v31, s44, s44
    v_fma_f32 v32, v32, s44, s44
    v_fma_f32 v33, v33, s44, s44
    v_fma_f32 v34, v34, s44, s44
    v_fma_f32 v35, v35, s44, s44
    v_rcp_f32 v28, v28
    v_rcp_f32 v29, v29
    v_rcp_f32 v30, v30
    v_rcp_f32 v31, v31
    v_rcp_f32 v32, v32
    v_rcp_f32 v33, v33
    v_rcp_f32 v34, v34
    v_rcp_f32 v35, v35
    v_mul_f32 v112, v112, v28
    v_mul_f32 v113, v113, v29
    v_mul_f32 v114, v114, v30
    v_mul_f32 v115, v115, v31
    v_mul_f32 v116, v116, v32
    v_mul_f32 v117, v117, v33
    v_mul_f32 v118, v118, v34
    v_mul_f32 v119, v119, v35
    v_cvt_pk_bf16_f32 v120, v112, v113
    v_cvt_pk_bf16_f32 v121, v114, v115
    v_cvt_pk_bf16_f32 v122, v116, v117
    v_cvt_pk_bf16_f32 v123, v118, v119
    buffer_store_dwordx4 v[120:123], v15, s[28:31], s60 offen offset:3072 sc1
    s_setprio 0
    s_nop 0
    s_branch L_g_m2end
L_g_m2b:
    v_mfma_f32_32x32x16_bf16 v[96:111], v[48:51], v[248:251], v[96:111]
    s_waitcnt lgkmcnt(8)
    s_waitcnt vmcnt(8)
    s_barrier
    ds_read_b64_tr_b16 v[44:45], v8 offset:16384
    ds_read_b64_tr_b16 v[46:47], v8 offset:16896
    s_add_u32 m0, s61, 12288
    s_add_u32 s37, s48, 28672
    buffer_load_dwordx4 v4, s[16:19], s48 offen lds
    v_mfma_f32_32x32x16_bf16 v[112:127], v[52:55], v[248:251], v[112:127]
    s_waitcnt lgkmcnt(8)
    ds_read_b64_tr_b16 v[48:49], v9 offset:16384
    ds_read_b64_tr_b16 v[50:51], v9 offset:16896
    s_add_u32 m0, m0, 1024
    s_nop 0
    buffer_load_dwordx4 v4, s[16:19], s37 offen lds
    v_mfma_f32_32x32x16_bf16 v[64:79], v[56:59], v[252:255], v[64:79]
    s_waitcnt lgkmcnt(8)
    ds_read_b64_tr_b16 v[52:53], v8 offset:36864
    ds_read_b64_tr_b16 v[54:55], v8 offset:37376
    s_add_u32 m0, s61, 14336
    s_add_u32 s37, s48, 28672
    buffer_load_dwordx4 v5, s[20:23], s48 offen lds
    v_mfma_f32_32x32x16_bf16 v[80:95], v[60:63], v[252:255], v[80:95]
    s_waitcnt lgkmcnt(8)
    ds_read_b64_tr_b16 v[56:57], v9 offset:36864
    ds_read_b64_tr_b16 v[58:59], v9 offset:37376
    s_add_u32 m0, m0, 1024
    s_nop 0
    buffer_load_dwordx4 v5, s[20:23], s37 offen lds
    v_mfma_f32_32x32x16_bf16 v[96:111], v[36:39], v[252:255], v[96:111]
    s_waitcnt lgkmcnt(8)
    ds_read_b64_tr_b16 v[60:61], v22 offset:16384
    ds_read_b64_tr_b16 v[62:63], v22 offset:16896
    v_mfma_f32_32x32x16_bf16 v[112:127], v[40:43], v[252:255], v[112:127]
    s_waitcnt lgkmcnt(8)
    ds_read_b64_tr_b16 v[36:37], v23 offset:16384
    ds_read_b64_tr_b16 v[38:39], v23 offset:16896
    s_setprio 3
    s_nop 7
    v_exp_f32 v28, v64
    v_exp_f32 v29, v65
    v_exp_f32 v30, v66
    v_exp_f32 v31, v67
    v_exp_f32 v32, v68
    v_exp_f32 v33, v69
    v_exp_f32 v34, v70
    v_exp_f32 v35, v71
    v_mul_f32 v64, v64, v72
    v_mul_f32 v65, v65, v73
    v_mul_f32 v66, v66, v74
    v_mul_f32 v67, v67, v75
    v_mul_f32 v68, v68, v76
    v_mul_f32 v69, v69, v77
    v_mul_f32 v70, v70, v78
    v_mul_f32 v71, v71, v79
    v_fma_f32 v28, v28, s44, s44
    v_fma_f32 v29, v29, s44, s44
    v_fma_f32 v30, v30, s44, s44
    v_fma_f32 v31, v31, s44, s44
    v_fma_f32 v32, v32, s44, s44
    v_fma_f32 v33, v33, s44, s44
    v_fma_f32 v34, v34, s44, s44
    v_fma_f32 v35, v35, s44, s44
    v_rcp_f32 v28, v28
    v_rcp_f32 v29, v29
    v_rcp_f32 v30, v30
    v_rcp_f32 v31, v31
    v_rcp_f32 v32, v32
    v_rcp_f32 v33, v33
    v_rcp_f32 v34, v34
    v_rcp_f32 v35, v35
    v_mul_f32 v64, v64, v28
    v_mul_f32 v65, v65, v29
    v_mul_f32 v66, v66, v30
    v_mul_f32 v67, v67, v31
    v_mul_f32 v68, v68, v32
    v_mul_f32 v69, v69, v33
    v_mul_f32 v70, v70, v34
    v_mul_f32 v71, v71, v35
    v_cvt_pk_bf16_f32 v72, v64, v65
    v_cvt_pk_bf16_f32 v73, v66, v67
    v_cvt_pk_bf16_f32 v74, v68, v69
    v_cvt_pk_bf16_f32 v75, v70, v71
    buffer_store_dwordx4 v[72:75], v15, s[28:31], s64 offen offset:0 sc1
    v_exp_f32 v28, v80
    v_exp_f32 v29, v81
    v_exp_f32 v30, v82
    v_exp_f32 v31, v83
    v_exp_f32 v32, v84
    v_exp_f32 v33, v85
    v_exp_f32 v34, v86
    v_exp_f32 v35, v87
    v_mul_f32 v80, v80, v88
    v_mul_f32 v81, v81, v89
    v_mul_f32 v82, v82, v90
    v_mul_f32 v83, v83, v91
    v_mul_f32 v84, v84, v92
    v_mul_f32 v85, v85, v93
    v_mul_f32 v86, v86, v94
    v_mul_f32 v87, v87, v95
    v_fma_f32 v28, v28, s44, s44
    v_fma_f32 v29, v29, s44, s44
    v_fma_f32 v30, v30, s44, s44
    v_fma_f32 v31, v31, s44, s44
    v_fma_f32 v32, v32, s44, s44
    v_fma_f32 v33, v33, s44, s44
    v_fma_f32 v34, v34, s44, s44
    v_fma_f32 v35, v35, s44, s44
    v_rcp_f32 v28, v28
    v_rcp_f32 v29, v29
    v_rcp_f32 v30, v30
    v_rcp_f32 v31, v31
    v_rcp_f32 v32, v32
    v_rcp_f32 v33, v33
    v_rcp_f32 v34, v34
    v_rcp_f32 v35, v35
    v_mul_f32 v80, v80, v28
    v_mul_f32 v81, v81, v29
    v_mul_f32 v82, v82, v30
    v_mul_f32 v83, v83, v31
    v_mul_f32 v84, v84, v32
    v_mul_f32 v85, v85, v33
    v_mul_f32 v86, v86, v34
    v_mul_f32 v87, v87, v35
    v_cvt_pk_bf16_f32 v88, v80, v81
    v_cvt_pk_bf16_f32 v89, v82, v83
    v_cvt_pk_bf16_f32 v90, v84, v85
    v_cvt_pk_bf16_f32 v91, v86, v87
    buffer_store_dwordx4 v[88:91], v15, s[28:31], s64 offen offset:1024 sc1
    v_exp_f32 v28, v96
    v_exp_f32 v29, v97
    v_exp_f32 v30, v98
    v_exp_f32 v31, v99
    v_exp_f32 v32, v100
    v_exp_f32 v33, v101
    v_exp_f32 v34, v102
    v_exp_f32 v35, v103
    v_mul_f32 v96, v96, v104
    v_mul_f32 v97, v97, v105
    v_mul_f32 v98, v98, v106
    v_mul_f32 v99, v99, v107
    v_mul_f32 v100, v100, v108
    v_mul_f32 v101, v101, v109
    v_mul_f32 v102, v102, v110
    v_mul_f32 v103, v103, v111
    v_fma_f32 v28, v28, s44, s44
    v_fma_f32 v29, v29, s44, s44
    v_fma_f32 v30, v30, s44, s44
    v_fma_f32 v31, v31, s44, s44
    v_fma_f32 v32, v32, s44, s44
    v_fma_f32 v33, v33, s44, s44
    v_fma_f32 v34, v34, s44, s44
    v_fma_f32 v35, v35, s44, s44
    v_rcp_f32 v28, v28
    v_rcp_f32 v29, v29
    v_rcp_f32 v30, v30
    v_rcp_f32 v31, v31
    v_rcp_f32 v32, v32
    v_rcp_f32 v33, v33
    v_rcp_f32 v34, v34
    v_rcp_f32 v35, v35
    v_mul_f32 v96, v96, v28
    v_mul_f32 v97, v97, v29
    v_mul_f32 v98, v98, v30
    v_mul_f32 v99, v99, v31
    v_mul_f32 v100, v100, v32
    v_mul_f32 v101, v101, v33
    v_mul_f32 v102, v102, v34
    v_mul_f32 v103, v103, v35
    v_cvt_pk_bf16_f32 v104, v96, v97
    v_cvt_pk_bf16_f32 v105, v98, v99
    v_cvt_pk_bf16_f32 v106, v100, v101
    v_cvt_pk_bf16_f32 v107, v102, v103
    buffer_store_dwordx4 v[104:107], v15, s[28:31], s64 offen offset:2048 sc1
    v_exp_f32 v28, v112
    v_exp_f32 v29, v113
    v_exp_f32 v30, v114
    v_exp_f32 v31, v115
    v_exp_f32 v32, v116
    v_exp_f32 v33, v117
    v_exp_f32 v34, v118
    v_exp_f32 v35, v119
    v_mul_f32 v112, v112, v120
    v_mul_f32 v113, v113, v121
    v_mul_f32 v114, v114, v122
    v_mul_f32 v115, v115, v123
    v_mul_f32 v116, v116, v124
    v_mul_f32 v117, v117, v125
    v_mul_f32 v118, v118, v126
    v_mul_f32 v119, v119, v127
    v_fma_f32 v28, v28, s44, s44
    v_fma_f32 v29, v29, s44, s44
    v_fma_f32 v30, v30, s44, s44
    v_fma_f32 v31, v31, s44, s44
    v_fma_f32 v32, v32, s44, s44
    v_fma_f32 v33, v33, s44, s44
    v_fma_f32 v34, v34, s44, s44
    v_fma_f32 v35, v35, s44, s44
    v_rcp_f32 v28, v28
    v_rcp_f32 v29, v29
    v_rcp_f32 v30, v30
    v_rcp_f32 v31, v31
    v_rcp_f32 v32, v32
    v_rcp_f32 v33, v33
    v_rcp_f32 v34, v34
    v_rcp_f32 v35, v35
    v_mul_f32 v112, v112, v28
    v_mul_f32 v113, v113, v29
    v_mul_f32 v114, v114, v30
    v_mul_f32 v115, v115, v31
    v_mul_f32 v116, v116, v32
    v_mul_f32 v117, v117, v33
    v_mul_f32 v118, v118, v34
    v_mul_f32 v119, v119, v35
    v_cvt_pk_bf16_f32 v120, v112, v113
    v_cvt_pk_bf16_f32 v121, v114, v115
    v_cvt_pk_bf16_f32 v122, v116, v117
    v_cvt_pk_bf16_f32 v123, v118, v119
    buffer_store_dwordx4 v[120:123], v15, s[28:31], s64 offen offset:3072 sc1
    s_setprio 0
    s_nop 0
    v_mfma_f32_32x32x16_bf16 v[64:79], v[44:47], v[128:131], 0
    s_waitcnt lgkmcnt(8)
    ds_read_b64_tr_b16 v[40:41], v22 offset:36864
    ds_read_b64_tr_b16 v[42:43], v22 offset:37376
    v_mfma_f32_32x32x16_bf16 v[80:95], v[48:51], v[128:131], 0
    s_waitcnt lgkmcnt(8)
    ds_read_b64_tr_b16 v[44:45], v23 offset:36864
    ds_read_b64_tr_b16 v[46:47], v23 offset:37376
    v_mfma_f32_32x32x16_bf16 v[64:79], v[52:55], v[132:135], v[64:79]
    s_waitcnt lgkmcnt(8)
    s_waitcnt vmcnt(0)
    s_mov_b64 exec, 1
    buffer_store_dword v26, v27, s[28:31], s67 offen sc1
    s_mov_b64 exec, -1
    s_add_u32 s67, s67, 131072
    s_barrier
    ds_read_b64_tr_b16 v[48:49], v8 offset:0
    ds_read_b64_tr_b16 v[50:51], v8 offset:512
    s_add_u32 m0, s61, 8192
    s_add_u32 s37, s49, 28672
    buffer_load_dwordx4 v4, s[16:19], s49 offen lds
    v_mfma_f32_32x32x16_bf16 v[80:95], v[56:59], v[132:135], v[80:95]
    s_waitcnt lgkmcnt(8)
    ds_read_b64_tr_b16 v[52:53], v9 offset:0
    ds_read_b64_tr_b16 v[54:55], v9 offset:512
    s_add_u32 m0, m0, 1024
    s_nop 0
    buffer_load_dwordx4 v4, s[16:19], s37 offen lds
    v_mfma_f32_32x32x16_bf16 v[64:79], v[60:63], v[136:139], v[64:79]
    s_waitcnt lgkmcnt(8)
    ds_read_b64_tr_b16 v[56:57], v8 offset:20480
    ds_read_b64_tr_b16 v[58:59], v8 offset:20992
    s_add_u32 m0, s61, 10240
    s_add_u32 s37, s49, 28672
    buffer_load_dwordx4 v5, s[20:23], s49 offen lds
    v_mfma_f32_32x32x16_bf16 v[80:95], v[36:39], v[136:139], v[80:95]
    s_waitcnt lgkmcnt(8)
    ds_read_b64_tr_b16 v[60:61], v9 offset:20480
    ds_read_b64_tr_b16 v[62:63], v9 offset:20992
    s_add_u32 m0, m0, 1024
    s_nop 0
    buffer_load_dwordx4 v5, s[20:23], s37 offen lds
    v_mfma_f32_32x32x16_bf16 v[64:79], v[40:43], v[140:143], v[64:79]
    s_waitcnt lgkmcnt(8)
    ds_read_b64_tr_b16 v[36:37], v22 offset:0
    ds_read_b64_tr_b16 v[38:39], v22 offset:512
    v_mfma_f32_32x32x16_bf16 v[80:95], v[44:47], v[140:143], v[80:95]
    s_waitcnt lgkmcnt(8)
    ds_read_b64_tr_b16 v[40:41], v23 offset:0
    ds_read_b64_tr_b16 v[42:43], v23 offset:512
    v_mfma_f32_32x32x16_bf16 v[64:79], v[48:51], v[144:147], v[64:79]
    s_waitcnt lgkmcnt(8)
    ds_read_b64_tr_b16 v[44:45], v22 offset:20480
    ds_read_b64_tr_b16 v[46:47], v22 offset:20992
    v_mfma_f32_32x32x16_bf16 v[80:95], v[52:55], v[144:147], v[80:95]
    s_waitcnt lgkmcnt(8)
    ds_read_b64_tr_b16 v[48:49], v23 offset:20480
    ds_read_b64_tr_b16 v[50:51], v23 offset:20992
    v_mfma_f32_32x32x16_bf16 v[64:79], v[56:59], v[148:151], v[64:79]
    s_waitcnt lgkmcnt(8)
    s_waitcnt vmcnt(13)
    s_barrier
    ds_read_b64_tr_b16 v[52:53], v8 offset:4096
    ds_read_b64_tr_b16 v[54:55], v8 offset:4608
    s_add_u32 m0, s61, 16384
    s_add_u32 s37, s50, 28672
    buffer_load_dwordx4 v4, s[16:19], s50 offen lds
    v_mfma_f32_32x32x16_bf16 v[80:95], v[60:63], v[148:151], v[80:95]
    s_waitcnt lgkmcnt(8)
    ds_read_b64_tr_b16 v[56:57], v9 offset:4096
    ds_read_b64_tr_b16 v[58:59], v9 offset:4608
    s_add_u32 m0, m0, 1024
    s_nop 0
    buffer_load_dwordx4 v4, s[16:19], s37 offen lds
    v_mfma_f32_32x32x16_bf16 v[64:79], v[36:39], v[152:155], v[64:79]
    s_waitcnt lgkmcnt(8)
    ds_read_b64_tr_b16 v[60:61], v8 offset:24576
    ds_read_b64_tr_b16 v[62:63], v8 offset:25088
    s_add_u32 m0, s61, 18432
    s_add_u32 s37, s50, 28672
    buffer_load_dwordx4 v5, s[20:23], s50 offen lds
    v_mfma_f32_32x32x16_bf16 v[80:95], v[40:43], v[152:155], v[80:95]
    s_waitcnt lgkmcnt(8)
    ds_read_b64_tr_b16 v[36:37], v9 offset:24576
    ds_read_b64_tr_b16 v[38:39], v9 offset:25088
    s_add_u32 m0, m0, 1024
    s_nop 0
    buffer_load_dwordx4 v5, s[20:23], s37 offen lds
    v_mfma_f32_32x32x16_bf16 v[64:79], v[44:47], v[156:159], v[64:79]
    s_waitcnt lgkmcnt(8)
    ds_read_b64_tr_b16 v[40:41], v22 offset:4096
    ds_read_b64_tr_b16 v[42:43], v22 offset:4608
    v_mfma_f32_32x32x16_bf16 v[80:95], v[48:51], v[156:159], v[80:95]
    s_waitcnt lgkmcnt(8)
    ds_read_b64_tr_b16 v[44:45], v23 offset:4096
    ds_read_b64_tr_b16 v[46:47], v23 offset:4608
    v_mfma_f32_32x32x16_bf16 v[64:79], v[52:55], v[160:163], v[64:79]
    s_waitcnt lgkmcnt(8)
    ds_read_b64_tr_b16 v[48:49], v22 offset:24576
    ds_read_b64_tr_b16 v[50:51], v22 offset:25088
    v_mfma_f32_32x32x16_bf16 v[80:95], v[56:59], v[160:163], v[80:95]
    s_waitcnt lgkmcnt(8)
    ds_read_b64_tr_b16 v[52:53], v23 offset:24576
    ds_read_b64_tr_b16 v[54:55], v23 offset:25088
    v_mfma_f32_32x32x16_bf16 v[64:79], v[60:63], v[164:167], v[64:79]
    s_waitcnt lgkmcnt(8)
    s_waitcnt vmcnt(13)
    s_barrier
    ds_read_b64_tr_b16 v[56:57], v8 offset:12288
    ds_read_b64_tr_b16 v[58:59], v8 offset:12800
    s_add_u32 m0, s61, 0
    s_add_u32 s37, s51, 28672
    buffer_load_dwordx4 v4, s[16:19], s51 offen lds
    v_mfma_f32_32x32x16_bf16 v[80:95], v[36:39], v[164:167], v[80:95]
    s_waitcnt lgkmcnt(8)
    ds_read_b64_tr_b16 v[60:61], v9 offset:12288
    ds_read_b64_tr_b16 v[62:63], v9 offset:12800
    s_add_u32 m0, m0, 1024
    s_nop 0
    buffer_load_dwordx4 v4, s[16:19], s37 offen lds
    v_mfma_f32_32x32x16_bf16 v[64:79], v[40:43], v[168:171], v[64:79]
    s_waitcnt lgkmcnt(8)
    ds_read_b64_tr_b16 v[36:37], v8 offset:32768
    ds_read_b64_tr_b16 v[38:39], v8 offset:33280
    s_add_u32 m0, s61, 2048
    s_add_u32 s37, s51, 28672
    buffer_load_dwordx4 v5, s[20:23], s51 offen lds
    v_mfma_f32_32x32x16_bf16 v[80:95], v[44:47], v[168:171], v[80:95]
    s_waitcnt lgkmcnt(8)
    ds_read_b64_tr_b16 v[40:41], v9 offset:32768
    ds_read_b64_tr_b16 v[42:43], v9 offset:33280
    s_add_u32 m0, m0, 1024
    s_nop 0
    buffer_load_dwordx4 v5, s[20:23], s37 offen lds
    v_mfma_f32_32x32x16_bf16 v[64:79], v[48:51], v[172:175], v[64:79]
    s_waitcnt lgkmcnt(8)
    ds_read_b64_tr_b16 v[44:45], v22 offset:12288
    ds_read_b64_tr_b16 v[46:47], v22 offset:12800
    v_mfma_f32_32x32x16_bf16 v[80:95], v[52:55], v[172:175], v[80:95]
    s_waitcnt lgkmcnt(8)
    ds_read_b64_tr_b16 v[48:49], v23 offset:12288
    ds_read_b64_tr_b16 v[50:51], v23 offset:12800
    v_mfma_f32_32x32x16_bf16 v[64:79], v[56:59], v[176:179], v[64:79]
    s_waitcnt lgkmcnt(8)
    ds_read_b64_tr_b16 v[52:53], v22 offset:32768
    ds_read_b64_tr_b16 v[54:55], v22 offset:33280
    v_mfma_f32_32x32x16_bf16 v[80:95], v[60:63], v[176:179], v[80:95]
    s_waitcnt lgkmcnt(8)
    ds_read_b64_tr_b16 v[56:57], v23 offset:32768
    ds_read_b64_tr_b16 v[58:59], v23 offset:33280
    v_mfma_f32_32x32x16_bf16 v[64:79], v[36:39], v[180:183], v[64:79]
    s_waitcnt lgkmcnt(8)
    s_waitcnt vmcnt(8)
    s_barrier
    ds_read_b64_tr_b16 v[60:61], v8 offset:8192
    ds_read_b64_tr_b16 v[62:63], v8 offset:8704
    s_add_u32 m0, s61, 4096
    s_add_u32 s37, s52, 28672
    buffer_load_dwordx4 v4, s[16:19], s52 offen lds
    v_mfma_f32_32x32x16_bf16 v[80:95], v[40:43], v[180:183], v[80:95]
    s_waitcnt lgkmcnt(8)
    ds_read_b64_tr_b16 v[36:37], v9 offset:8192
    ds_read_b64_tr_b16 v[38:39], v9 offset:8704
    s_add_u32 m0, m0, 1024
    s_nop 0
    buffer_load_dwordx4 v4, s[16:19], s37 offen lds
    v_mfma_f32_32x32x16_bf16 v[64:79], v[44:47], v[184:187], v[64:79]
    s_waitcnt lgkmcnt(8)
    ds_read_b64_tr_b16 v[40:41], v8 offset:28672
    ds_read_b64_tr_b16 v[42:43], v8 offset:29184
    s_add_u32 m0, s61, 6144
    s_add_u32 s37, s52, 28672
    buffer_load_dwordx4 v5, s[20:23], s52 offen lds
    v_mfma_f32_32x32x16_bf16 v[80:95], v[48:51], v[184:187], v[80:95]
    s_waitcnt lgkmcnt(8)
    ds_read_b64_tr_b16 v[44:45], v9 offset:28672
    ds_read_b64_tr_b16 v[46:47], v9 offset:29184
    s_add_u32 m0, m0, 1024
    s_nop 0
    buffer_load_dwordx4 v5, s[20:23], s37 offen lds
    v_mfma_f32_32x32x16_bf16 v[64:79], v[52:55], v[188:191], v[64:79]
    s_waitcnt lgkmcnt(8)
    ds_read_b64_tr_b16 v[48:49], v22 offset:8192
    ds_read_b64_tr_b16 v[50:51], v22 offset:8704
    v_mfma_f32_32x32x16_bf16 v[80:95], v[56:59], v[188:191], v[80:95]
    s_waitcnt lgkmcnt(8)
    ds_read_b64_tr_b16 v[52:53], v23 offset:8192
    ds_read_b64_tr_b16 v[54:55], v23 offset:8704
    v_mfma_f32_32x32x16_bf16 v[64:79], v[60:63], v[192:195], v[64:79]
    s_waitcnt lgkmcnt(8)
    ds_read_b64_tr_b16 v[56:57], v22 offset:28672
    ds_read_b64_tr_b16 v[58:59], v22 offset:29184
    v_mfma_f32_32x32x16_bf16 v[80:95], v[36:39], v[192:195], v[80:95]
    s_waitcnt lgkmcnt(8)
    ds_read_b64_tr_b16 v[60:61], v23 offset:28672
    ds_read_b64_tr_b16 v[62:63], v23 offset:29184
    v_mfma_f32_32x32x16_bf16 v[64:79], v[40:43], v[196:199], v[64:79]
    s_waitcnt lgkmcnt(8)
    s_waitcnt vmcnt(8)
    s_barrier
    ds_read_b64_tr_b16 v[36:37], v8 offset:16384
    ds_read_b64_tr_b16 v[38:39], v8 offset:16896
    s_add_u32 m0, s61, 12288
    s_lshl_b32 s43, s41, 16
    buffer_load_dwordx4 v6, s[56:59], s43 offen lds
    v_mfma_f32_32x32x16_bf16 v[80:95], v[44:47], v[196:199], v[80:95]
    s_waitcnt lgkmcnt(8)
    ds_read_b64_tr_b16 v[40:41], v9 offset:16384
    ds_read_b64_tr_b16 v[42:43], v9 offset:16896
    s_add_u32 m0, m0, 1024
    s_add_u32 s43, s43, 8192
    buffer_load_dwordx4 v6, s[56:59], s43 offen lds
    s_add_u32 s41, s41, 1
    s_and_b32 s41, s41, 15
    v_mfma_f32_32x32x16_bf16 v[64:79], v[48:51], v[200:203], v[64:79]
    s_waitcnt lgkmcnt(8)
    ds_read_b64_tr_b16 v[44:45], v8 offset:36864
    ds_read_b64_tr_b16 v[46:47], v8 offset:37376
    s_add_u32 m0, s61, 14336
    s_lshl_b32 s43, s41, 16
    buffer_load_dwordx4 v6, s[56:59], s43 offen lds
    v_mfma_f32_32x32x16_bf16 v[80:95], v[52:55], v[200:203], v[80:95]
    s_waitcnt lgkmcnt(8)
    ds_read_b64_tr_b16 v[48:49], v9 offset:36864
    ds_read_b64_tr_b16 v[50:51], v9 offset:37376
    s_add_u32 m0, m0, 1024
    s_add_u32 s43, s43, 8192
    buffer_load_dwordx4 v6, s[56:59], s43 offen lds
    s_add_u32 s41, s41, 1
    s_and_b32 s41, s41, 15
    v_mfma_f32_32x32x16_bf16 v[64:79], v[56:59], v[204:207], v[64:79]
    s_waitcnt lgkmcnt(8)
    ds_read_b64_tr_b16 v[52:53], v22 offset:16384
    ds_read_b64_tr_b16 v[54:55], v22 offset:16896
    v_mfma_f32_32x32x16_bf16 v[80:95], v[60:63], v[204:207], v[80:95]
    s_waitcnt lgkmcnt(8)
    ds_read_b64_tr_b16 v[56:57], v23 offset:16384
    ds_read_b64_tr_b16 v[58:59], v23 offset:16896
    v_mfma_f32_32x32x16_bf16 v[64:79], v[36:39], v[208:211], v[64:79]
    s_waitcnt lgkmcnt(8)
    ds_read_b64_tr_b16 v[60:61], v22 offset:36864
    ds_read_b64_tr_b16 v[62:63], v22 offset:37376
    v_mfma_f32_32x32x16_bf16 v[80:95], v[40:43], v[208:211], v[80:95]
    s_waitcnt lgkmcnt(8)
    ds_read_b64_tr_b16 v[36:37], v23 offset:36864
    ds_read_b64_tr_b16 v[38:39], v23 offset:37376
    v_mfma_f32_32x32x16_bf16 v[64:79], v[44:47], v[212:215], v[64:79]
    s_waitcnt lgkmcnt(8)
    s_waitcnt vmcnt(8)
    s_barrier
    ds_read_b64_tr_b16 v[40:41], v8 offset:0
    ds_read_b64_tr_b16 v[42:43], v8 offset:512
    s_add_u32 m0, s61, 8192
    s_lshl_b32 s43, s41, 16
    buffer_load_dwordx4 v6, s[56:59], s43 offen lds
    v_mfma_f32_32x32x16_bf16 v[80:95], v[48:51], v[212:215], v[80:95]
    s_waitcnt lgkmcnt(8)
    ds_read_b64_tr_b16 v[44:45], v9 offset:0
    ds_read_b64_tr_b16 v[46:47], v9 offset:512
    s_add_u32 m0, m0, 1024
    s_add_u32 s43, s43, 8192
    buffer_load_dwordx4 v6, s[56:59], s43 offen lds
    s_add_u32 s41, s41, 1
    s_and_b32 s41, s41, 15
    v_mfma_f32_32x32x16_bf16 v[64:79], v[52:55], v[216:219], v[64:79]
    s_waitcnt lgkmcnt(8)
    ds_read_b64_tr_b16 v[48:49], v8 offset:20480
    ds_read_b64_tr_b16 v[50:51], v8 offset:20992
    s_add_u32 m0, s61, 10240
    s_lshl_b32 s43, s41, 16
    buffer_load_dwordx4 v6, s[56:59], s43 offen lds
    v_mfma_f32_32x32x16_bf16 v[80:95], v[56:59], v[216:219], v[80:95]
    s_waitcnt lgkmcnt(8)
    ds_read_b64_tr_b16 v[52:53], v9 offset:20480
    ds_read_b64_tr_b16 v[54:55], v9 offset:20992
    s_add_u32 m0, m0, 1024
    s_add_u32 s43, s43, 8192
    buffer_load_dwordx4 v6, s[56:59], s43 offen lds
    s_add_u32 s41, s41, 1
    s_and_b32 s41, s41, 15
    v_mfma_f32_32x32x16_bf16 v[64:79], v[60:63], v[220:223], v[64:79]
    s_waitcnt lgkmcnt(8)
    ds_read_b64_tr_b16 v[56:57], v22 offset:0
    ds_read_b64_tr_b16 v[58:59], v22 offset:512
    v_mfma_f32_32x32x16_bf16 v[80:95], v[36:39], v[220:223], v[80:95]
    s_waitcnt lgkmcnt(8)
    ds_read_b64_tr_b16 v[60:61], v23 offset:0
    ds_read_b64_tr_b16 v[62:63], v23 offset:512
    v_mfma_f32_32x32x16_bf16 v[64:79], v[40:43], v[224:227], v[64:79]
    s_waitcnt lgkmcnt(8)
    ds_read_b64_tr_b16 v[36:37], v22 offset:20480
    ds_read_b64_tr_b16 v[38:39], v22 offset:20992
    v_mfma_f32_32x32x16_bf16 v[80:95], v[44:47], v[224:227], v[80:95]
    s_waitcnt lgkmcnt(8)
    ds_read_b64_tr_b16 v[40:41], v23 offset:20480
    ds_read_b64_tr_b16 v[42:43], v23 offset:20992
    v_mfma_f32_32x32x16_bf16 v[64:79], v[48:51], v[228:231], v[64:79]
    s_waitcnt lgkmcnt(8)
    s_waitcnt vmcnt(8)
    s_barrier
    ds_read_b64_tr_b16 v[44:45], v8 offset:4096
    ds_read_b64_tr_b16 v[46:47], v8 offset:4608
    buffer_load_dword v20, v18, s[28:31], 0 offen sc1
    s_mov_b32 s41, s63
    v_mfma_f32_32x32x16_bf16 v[80:95], v[52:55], v[228:231], v[80:95]
    s_waitcnt lgkmcnt(8)
    ds_read_b64_tr_b16 v[48:49], v9 offset:4096
    ds_read_b64_tr_b16 v[50:51], v9 offset:4608
    v_mfma_f32_32x32x16_bf16 v[64:79], v[56:59], v[232:235], v[64:79]
    s_waitcnt lgkmcnt(8)
    ds_read_b64_tr_b16 v[52:53], v8 offset:24576
    ds_read_b64_tr_b16 v[54:55], v8 offset:25088
    v_mfma_f32_32x32x16_bf16 v[80:95], v[60:63], v[232:235], v[80:95]
    s_waitcnt lgkmcnt(8)
    ds_read_b64_tr_b16 v[56:57], v9 offset:24576
    ds_read_b64_tr_b16 v[58:59], v9 offset:25088
    s_setprio 3
    s_waitcnt vmcnt(0)
    v_cmp_ne_u32 s[6:7], s33, v20
    s_nop 3
    s_cmp_eq_u64 s[6:7], 0
    s_cbranch_scc1 L_g_pollhb_done
L_g_pollhb:
    buffer_load_dword v20, v18, s[28:31], 0 offen sc1
    s_waitcnt vmcnt(0)
    v_xor_b32 v20, s33, v20
    v_cmp_ne_u32 s[6:7], 0, v20
    s_nop 3
    s_cmp_eq_u64 s[6:7], 0
    s_cbranch_scc1 L_g_pollhb_done
    s_sleep 4
    s_sub_u32 s3, s3, 1
    s_cbranch_scc0 L_g_pollhb
    s_mov_b32 s3, 0
L_g_pollhb_done:
    s_setprio 0
    s_lshl_b32 s39, s41, 12
    s_add_u32 s39, s39, s42
    buffer_load_dwordx4 v[128:131], v15, s[28:31], s39 offen sc1
    v_mfma_f32_32x32x16_bf16 v[64:79], v[36:39], v[236:239], v[64:79]
    s_waitcnt lgkmcnt(8)
    ds_read_b64_tr_b16 v[60:61], v22 offset:4096
    ds_read_b64_tr_b16 v[62:63], v22 offset:4608
    s_add_u32 s39, s39, s54
    buffer_load_dwordx4 v[132:135], v15, s[28:31], s39 offen sc1
    s_add_u32 s41, s41, 1
    s_and_b32 s41, s41, 15
    v_mfma_f32_32x32x16_bf16 v[80:95], v[40:43], v[236:239], v[80:95]
    s_waitcnt lgkmcnt(8)
    ds_read_b64_tr_b16 v[36:37], v23 offset:4096
    ds_read_b64_tr_b16 v[38:39], v23 offset:4608
    s_lshl_b32 s39, s41, 12
    s_add_u32 s39, s39, s42
    buffer_load_dwordx4 v[136:139], v15, s[28:31], s39 offen sc1
    v_mfma_f32_32x32x16_bf16 v[64:79], v[44:47], v[240:243], v[64:79]
    s_waitcnt lgkmcnt(8)
    ds_read_b64_tr_b16 v[40:41], v22 offset:24576
    ds_read_b64_tr_b16 v[42:43], v22 offset:25088
    s_add_u32 s39, s39, s54
    buffer_load_dwordx4 v[140:143], v15, s[28:31], s39 offen sc1
    s_add_u32 s41, s41, 1
    s_and_b32 s41, s41, 15
    v_mfma_f32_32x32x16_bf16 v[80:95], v[48:51], v[240:243], v[80:95]
    s_waitcnt lgkmcnt(8)
    ds_read_b64_tr_b16 v[44:45], v23 offset:24576
    ds_read_b64_tr_b16 v[46:47], v23 offset:25088
    s_lshl_b32 s39, s41, 12
    s_add_u32 s39, s39, s42
    buffer_load_dwordx4 v[144:147], v15, s[28:31], s39 offen sc1
    v_mfma_f32_32x32x16_bf16 v[64:79], v[52:55], v[244:247], v[64:79]
    s_waitcnt lgkmcnt(8)
    s_add_u32 s39, s39, s54
    buffer_load_dwordx4 v[148:151], v15, s[28:31], s39 offen sc1
    s_add_u32 s41, s41, 1
    s_and_b32 s41, s41, 15
    v_mfma_f32_32x32x16_bf16 v[80:95], v[56:59], v[244:247], v[80:95]
    s_waitcnt lgkmcnt(6)
    s_lshl_b32 s39, s41, 12
    s_add_u32 s39, s39, s42
    buffer_load_dwordx4 v[152:155], v15, s[28:31], s39 offen sc1
    v_mfma_f32_32x32x16_bf16 v[64:79], v[60:63], v[248:251], v[64:79]
    s_waitcnt lgkmcnt(4)
    s_add_u32 s39, s39, s54
    buffer_load_dwordx4 v[156:159], v15, s[28:31], s39 offen sc1
    s_add_u32 s41, s41, 1
    s_and_b32 s41, s41, 15
    v_mfma_f32_32x32x16_bf16 v[80:95], v[36:39], v[248:251], v[80:95]
    s_waitcnt lgkmcnt(2)
    v_mfma_f32_32x32x16_bf16 v[64:79], v[40:43], v[252:255], v[64:79]
    s_waitcnt lgkmcnt(0)
    v_mfma_f32_32x32x16_bf16 v[80:95], v[44:47], v[252:255], v[80:95]
    buffer_load_dwordx2 v[44:45], v14, s[8:11], 0 offen offset:0
    buffer_load_dwordx2 v[46:47], v14, s[8:11], 0 offen offset:16
    buffer_load_dwordx2 v[48:49], v14, s[8:11], 0 offen offset:32
    buffer_load_dwordx2 v[50:51], v14, s[8:11], 0 offen offset:48
    s_barrier
    s_setprio 3
    s_nop 7
    v_exp_f32 v28, v64
    v_exp_f32 v29, v65
    v_exp_f32 v30, v66
    v_exp_f32 v31, v67
    v_exp_f32 v32, v68
    v_exp_f32 v33, v69
    v_exp_f32 v34, v70
    v_exp_f32 v35, v71
    v_mul_f32 v64, v64, v72
    v_mul_f32 v65, v65, v73
    v_mul_f32 v66, v66, v74
    v_mul_f32 v67, v67, v75
    v_mul_f32 v68, v68, v76
    v_mul_f32 v69, v69, v77
    v_mul_f32 v70, v70, v78
    v_mul_f32 v71, v71, v79
    v_fma_f32 v28, v28, s44, s44
    v_fma_f32 v29, v29, s44, s44
    v_fma_f32 v30, v30, s44, s44
    v_fma_f32 v31, v31, s44, s44
    v_fma_f32 v32, v32, s44, s44
    v_fma_f32 v33, v33, s44, s44
    v_fma_f32 v34, v34, s44, s44
    v_fma_f32 v35, v35, s44, s44
    v_rcp_f32 v28, v28
    v_rcp_f32 v29, v29
    v_rcp_f32 v30, v30
    v_rcp_f32 v31, v31
    v_rcp_f32 v32, v32
    v_rcp_f32 v33, v33
    v_rcp_f32 v34, v34
    v_rcp_f32 v35, v35
    v_mul_f32 v64, v64, v28
    v_mul_f32 v65, v65, v29
    v_mul_f32 v66, v66, v30
    v_mul_f32 v67, v67, v31
    v_mul_f32 v68, v68, v32
    v_mul_f32 v69, v69, v33
    v_mul_f32 v70, v70, v34
    v_mul_f32 v71, v71, v35
    v_cvt_pk_bf16_f32 v72, v64, v65
    v_cvt_pk_bf16_f32 v73, v66, v67
    v_cvt_pk_bf16_f32 v74, v68, v69
    v_cvt_pk_bf16_f32 v75, v70, v71
    buffer_store_dwordx4 v[72:75], v15, s[28:31], s60 offen offset:0 sc1
    v_exp_f32 v28, v80
    v_exp_f32 v29, v81
    v_exp_f32 v30, v82
    v_exp_f32 v31, v83
    v_exp_f32 v32, v84
    v_exp_f32 v33, v85
    v_exp_f32 v34, v86
    v_exp_f32 v35, v87
    v_mul_f32 v80, v80, v88
    v_mul_f32 v81, v81, v89
    v_mul_f32 v82, v82, v90
    v_mul_f32 v83, v83, v91
    v_mul_f32 v84, v84, v92
    v_mul_f32 v85, v85, v93
    v_mul_f32 v86, v86, v94
    v_mul_f32 v87, v87, v95
    v_fma_f32 v28, v28, s44, s44
    v_fma_f32 v29, v29, s44, s44
    v_fma_f32 v30, v30, s44, s44
    v_fma_f32 v31, v31, s44, s44
    v_fma_f32 v32, v32, s44, s44
    v_fma_f32 v33, v33, s44, s44
    v_fma_f32 v34, v34, s44, s44
    v_fma_f32 v35, v35, s44, s44
    v_rcp_f32 v28, v28
    v_rcp_f32 v29, v29
    v_rcp_f32 v30, v30
    v_rcp_f32 v31, v31
    v_rcp_f32 v32, v32
    v_rcp_f32 v33, v33
    v_rcp_f32 v34, v34
    v_rcp_f32 v35, v35
    v_mul_f32 v80, v80, v28
    v_mul_f32 v81, v81, v29
    v_mul_f32 v82, v82, v30
    v_mul_f32 v83, v83, v31
    v_mul_f32 v84, v84, v32
    v_mul_f32 v85, v85, v33
    v_mul_f32 v86, v86, v34
    v_mul_f32 v87, v87, v35
    v_cvt_pk_bf16_f32 v88, v80, v81
    v_cvt_pk_bf16_f32 v89, v82, v83
    v_cvt_pk_bf16_f32 v90, v84, v85
    v_cvt_pk_bf16_f32 v91, v86, v87
    buffer_store_dwordx4 v[88:91], v15, s[28:31], s60 offen offset:1024 sc1
    s_setprio 0
    s_nop 0
    s_mov_b32 s37, 0x20000000
    buffer_store_dword v27, v27, s[28:31], s37 offen
    s_mov_b32 s37, 0x20000000
    buffer_store_dword v27, v27, s[28:31], s37 offen
L_g_m2end:
    ds_read_b64_tr_b16 v[200:201], v7 offset:12288
    ds_read_b64_tr_b16 v[202:203], v7 offset:13312
    ds_read_b64_tr_b16 v[204:205], v13 offset:12288
    ds_read_b64_tr_b16 v[206:207], v13 offset:13312
    s_waitcnt vmcnt(14)
    ds_read_b64_tr_b16 v[208:209], v7 offset:14336
    ds_read_b64_tr_b16 v[210:211], v7 offset:15360
    ds_read_b64_tr_b16 v[212:213], v13 offset:14336
    ds_read_b64_tr_b16 v[214:215], v13 offset:15360
    s_waitcnt lgkmcnt(4)
    v_mfma_f32_32x32x16_bf16 v[64:79], v[200:203], v[128:131], 0
    s_add_u32 m0, s61, 16384
    s_lshl_b32 s43, s41, 16
    buffer_load_dwordx4 v6, s[56:59], s43 offen lds
    v_mfma_f32_32x32x16_bf16 v[80:95], v[200:203], v[132:135], 0
    s_add_u32 m0, m0, 1024
    s_add_u32 s43, s43, 8192
    buffer_load_dwordx4 v6, s[56:59], s43 offen lds
    v_mfma_f32_32x32x16_bf16 v[96:111], v[204:207], v[128:131], 0
    s_lshl_b32 s39, s41, 12
    s_add_u32 s39, s39, s42
    buffer_load_dwordx4 v[160:163], v15, s[28:31], s39 offen sc1
    v_mfma_f32_32x32x16_bf16 v[112:127], v[204:207], v[132:135], 0
    s_add_u32 s39, s39, s54
    buffer_load_dwordx4 v[164:167], v15, s[28:31], s39 offen sc1
    s_add_u32 s41, s41, 1
    s_and_b32 s41, s41, 15
    s_waitcnt vmcnt(4)
    s_mov_b64 exec, 1
    buffer_store_dword v26, v27, s[28:31], s67 offen sc1
    s_mov_b64 exec, -1
    s_waitcnt vmcnt(17)
    ds_read_b64_tr_b16 v[200:201], v7 offset:8192
    ds_read_b64_tr_b16 v[202:203], v7 offset:9216
    ds_read_b64_tr_b16 v[204:205], v13 offset:8192
    ds_read_b64_tr_b16 v[206:207], v13 offset:9216
    s_waitcnt lgkmcnt(4)
    v_mfma_f32_32x32x16_bf16 v[64:79], v[208:211], v[136:139], v[64:79]
    s_add_u32 m0, s61, 18432
    s_lshl_b32 s43, s41, 16
    buffer_load_dwordx4 v6, s[56:59], s43 offen lds
    v_mfma_f32_32x32x16_bf16 v[80:95], v[208:211], v[140:143], v[80:95]
    s_add_u32 m0, m0, 1024
    s_add_u32 s43, s43, 8192
    buffer_load_dwordx4 v6, s[56:59], s43 offen lds
    v_mfma_f32_32x32x16_bf16 v[96:111], v[212:215], v[136:139], v[96:111]
    s_lshl_b32 s39, s41, 12
    s_add_u32 s39, s39, s42
    buffer_load_dwordx4 v[168:171], v15, s[28:31], s39 offen sc1
    v_mfma_f32_32x32x16_bf16 v[112:127], v[212:215], v[140:143], v[112:127]
    s_add_u32 s39, s39, s54
    buffer_load_dwordx4 v[172:175], v15, s[28:31], s39 offen sc1
    s_add_u32 s41, s41, 1
    s_and_b32 s41, s41, 15
    s_waitcnt vmcnt(19)
    ds_read_b64_tr_b16 v[208:209], v7 offset:10240
    ds_read_b64_tr_b16 v[210:211], v7 offset:11264
    ds_read_b64_tr_b16 v[212:213], v13 offset:10240
    ds_read_b64_tr_b16 v[214:215], v13 offset:11264
    s_waitcnt lgkmcnt(4)
    v_mfma_f32_32x32x16_bf16 v[64:79], v[200:203], v[144:147], v[64:79]
    s_add_u32 m0, s61, 0
    s_lshl_b32 s43, s41, 16
    buffer_load_dwordx4 v6, s[56:59], s43 offen lds
    v_mfma_f32_32x32x16_bf16 v[80:95], v[200:203], v[148:151], v[80:95]
    s_add_u32 m0, m0, 1024
    s_add_u32 s43, s43, 8192
    buffer_load_dwordx4 v6, s[56:59], s43 offen lds
    v_mfma_f32_32x32x16_bf16 v[96:111], v[204:207], v[144:147], v[96:111]
    s_lshl_b32 s39, s41, 12
    s_add_u32 s39, s39, s42
    buffer_load_dwordx4 v[176:179], v15, s[28:31], s39 offen sc1
    v_mfma_f32_32x32x16_bf16 v[112:127], v[204:207], v[148:151], v[112:127]
    s_add_u32 s39, s39, s54
    buffer_load_dwordx4 v[180:183], v15, s[28:31], s39 offen sc1
    s_add_u32 s41, s41, 1
    s_and_b32 s41, s41, 15
    s_waitcnt vmcnt(11)
    ds_read_b64_tr_b16 v[200:201], v7 offset:16384
    ds_read_b64_tr_b16 v[202:203], v7 offset:17408
    ds_read_b64_tr_b16 v[204:205], v13 offset:16384
    ds_read_b64_tr_b16 v[206:207], v13 offset:17408
    s_waitcnt lgkmcnt(4)
    v_mfma_f32_32x32x16_bf16 v[64:79], v[208:211], v[152:155], v[64:79]
    s_add_u32 m0, s61, 2048
    s_lshl_b32 s43, s41, 16
    buffer_load_dwordx4 v6, s[56:59], s43 offen lds
    v_mfma_f32_32x32x16_bf16 v[80:95], v[208:211], v[156:159], v[80:95]
    s_add_u32 m0, m0, 1024
    s_add_u32 s43, s43, 8192
    buffer_load_dwordx4 v6, s[56:59], s43 offen lds
    v_mfma_f32_32x32x16_bf16 v[96:111], v[212:215], v[152:155], v[96:111]
    s_lshl_b32 s39, s41, 12
    s_add_u32 s39, s39, s42
    buffer_load_dwordx4 v[184:187], v15, s[28:31], s39 offen sc1
    v_mfma_f32_32x32x16_bf16 v[112:127], v[212:215], v[156:159], v[112:127]
    s_add_u32 s39, s39, s54
    buffer_load_dwordx4 v[188:191], v15, s[28:31], s39 offen sc1
    s_add_u32 s41, s41, 1
    s_and_b32 s41, s41, 15
    s_waitcnt vmcnt(10)
    ds_read_b64_tr_b16 v[208:209], v7 offset:18432
    ds_read_b64_tr_b16 v[210:211], v7 offset:19456
    ds_read_b64_tr_b16 v[212:213], v13 offset:18432
    ds_read_b64_tr_b16 v[214:215], v13 offset:19456
    s_waitcnt lgkmcnt(4)
    v_mfma_f32_32x32x16_bf16 v[64:79], v[200:203], v[160:163], v[64:79]
    s_add_u32 m0, s61, 4096
    s_lshl_b32 s43, s41, 16
    buffer_load_dwordx4 v6, s[56:59], s43 offen lds
    v_mfma_f32_32x32x16_bf16 v[80:95], v[200:203], v[164:167], v[80:95]
    s_add_u32 m0, m0, 1024
    s_add_u32 s43, s43, 8192
    buffer_load_dwordx4 v6, s[56:59], s43 offen lds
    v_mfma_f32_32x32x16_bf16 v[96:111], v[204:207], v[160:163], v[96:111]
    s_lshl_b32 s39, s41, 12
    s_add_u32 s39, s39, s42
    buffer_load_dwordx4 v[192:195], v15, s[28:31], s39 offen sc1
    v_mfma_f32_32x32x16_bf16 v[112:127], v[204:207], v[164:167], v[112:127]
    s_add_u32 s39, s39, s54
    buffer_load_dwordx4 v[196:199], v15, s[28:31], s39 offen sc1
    s_add_u32 s41, s41, 1
    s_and_b32 s41, s41, 15
    s_waitcnt vmcnt(10)
    ds_read_b64_tr_b16 v[200:201], v7 offset:0
    ds_read_b64_tr_b16 v[202:203], v7 offset:1024
    ds_read_b64_tr_b16 v[204:205], v13 offset:0
    ds_read_b64_tr_b16 v[206:207], v13 offset:1024
    s_waitcnt lgkmcnt(4)
    v_mfma_f32_32x32x16_bf16 v[64:79], v[208:211], v[168:171], v[64:79]
    s_add_u32 m0, s61, 6144
    s_lshl_b32 s43, s41, 16
    buffer_load_dwordx4 v6, s[56:59], s43 offen lds
    v_mfma_f32_32x32x16_bf16 v[80:95], v[208:211], v[172:175], v[80:95]
    s_add_u32 m0, m0, 1024
    s_add_u32 s43, s43, 8192
    buffer_load_dwordx4 v6, s[56:59], s43 offen lds
    v_mfma_f32_32x32x16_bf16 v[96:111], v[212:215], v[168:171], v[96:111]
    s_lshl_b32 s39, s41, 12
    s_add_u32 s39, s39, s42
    buffer_load_dwordx4 v[128:131], v15, s[28:31], s39 offen sc1
    v_mfma_f32_32x32x16_bf16 v[112:127], v[212:215], v[172:175], v[112:127]
    s_add_u32 s39, s39, s54
    buffer_load_dwordx4 v[132:135], v15, s[28:31], s39 offen sc1
    s_add_u32 s41, s41, 1
    s_and_b32 s41, s41, 15
    s_waitcnt vmcnt(10)
    ds_read_b64_tr_b16 v[208:209], v7 offset:2048
    ds_read_b64_tr_b16 v[210:211], v7 offset:3072
    ds_read_b64_tr_b16 v[212:213], v13 offset:2048
    ds_read_b64_tr_b16 v[214:215], v13 offset:3072
    s_waitcnt lgkmcnt(4)
    v_mfma_f32_32x32x16_bf16 v[64:79], v[200:203], v[176:179], v[64:79]
    s_add_u32 m0, s61, 12288
    s_lshl_b32 s43, s41, 16
    buffer_load_dwordx4 v6, s[56:59], s43 offen lds
    v_mfma_f32_32x32x16_bf16 v[80:95], v[200:203], v[180:183], v[80:95]
    s_add_u32 m0, m0, 1024
    s_add_u32 s43, s43, 8192
    buffer_load_dwordx4 v6, s[56:59], s43 offen lds
    v_mfma_f32_32x32x16_bf16 v[96:111], v[204:207], v[176:179], v[96:111]
    s_lshl_b32 s39, s41, 12
    s_add_u32 s39, s39, s42
    buffer_load_dwordx4 v[136:139], v15, s[28:31], s39 offen sc1
    v_mfma_f32_32x32x16_bf16 v[112:127], v[204:207], v[180:183], v[112:127]
    s_add_u32 s39, s39, s54
    buffer_load_dwordx4 v[140:143], v15, s[28:31], s39 offen sc1
    s_add_u32 s41, s41, 1
    s_and_b32 s41, s41, 15
    s_waitcnt vmcnt(10)
    ds_read_b64_tr_b16 v[200:201], v7 offset:4096
    ds_read_b64_tr_b16 v[202:203], v7 offset:5120
    ds_read_b64_tr_b16 v[204:205], v13 offset:4096
    ds_read_b64_tr_b16 v[206:207], v13 offset:5120
    s_waitcnt lgkmcnt(4)
    v_mfma_f32_32x32x16_bf16 v[64:79], v[208:211], v[184:187], v[64:79]
    s_add_u32 m0, s61, 14336
    s_lshl_b32 s43, s41, 16
    buffer_load_dwordx4 v6, s[56:59], s43 offen lds
    v_mfma_f32_32x32x16_bf16 v[80:95], v[208:211], v[188:191], v[80:95]
    s_add_u32 m0, m0, 1024
    s_add_u32 s43, s43, 8192
    buffer_load_dwordx4 v6, s[56:59], s43 offen lds
    v_mfma_f32_32x32x16_bf16 v[96:111], v[212:215], v[184:187], v[96:111]
    s_lshl_b32 s39, s41, 12
    s_add_u32 s39, s39, s42
    buffer_load_dwordx4 v[144:147], v15, s[28:31], s39 offen sc1
    v_mfma_f32_32x32x16_bf16 v[112:127], v[212:215], v[188:191], v[112:127]
    s_add_u32 s39, s39, s54
    buffer_load_dwordx4 v[148:151], v15, s[28:31], s39 offen sc1
    s_add_u32 s41, s41, 1
    s_and_b32 s41, s41, 15
    s_waitcnt vmcnt(10)
    ds_read_b64_tr_b16 v[208:209], v7 offset:6144
    ds_read_b64_tr_b16 v[210:211], v7 offset:7168
    ds_read_b64_tr_b16 v[212:213], v13 offset:6144
    ds_read_b64_tr_b16 v[214:215], v13 offset:7168
    s_waitcnt lgkmcnt(4)
    v_mfma_f32_32x32x16_bf16 v[64:79], v[200:203], v[192:195], v[64:79]
    s_add_u32 m0, s61, 8192
    s_lshl_b32 s43, s41, 16
    buffer_load_dwordx4 v6, s[56:59], s43 offen lds
    v_mfma_f32_32x32x16_bf16 v[80:95], v[200:203], v[196:199], v[80:95]
    s_add_u32 m0, m0, 1024
    s_add_u32 s43, s43, 8192
    buffer_load_dwordx4 v6, s[56:59], s43 offen lds
    v_mfma_f32_32x32x16_bf16 v[96:111], v[204:207], v[192:195], v[96:111]
    s_lshl_b32 s39, s41, 12
    s_add_u32 s39, s39, s42
    buffer_load_dwordx4 v[152:155], v15, s[28:31], s39 offen sc1
    v_mfma_f32_32x32x16_bf16 v[112:127], v[204:207], v[196:199], v[112:127]
    s_add_u32 s39, s39, s54
    buffer_load_dwordx4 v[156:159], v15, s[28:31], s39 offen sc1
    s_add_u32 s41, s41, 1
    s_and_b32 s41, s41, 15
    s_waitcnt vmcnt(10)
    ds_read_b64_tr_b16 v[200:201], v7 offset:12288
    ds_read_b64_tr_b16 v[202:203], v7 offset:13312
    ds_read_b64_tr_b16 v[204:205], v13 offset:12288
    ds_read_b64_tr_b16 v[206:207], v13 offset:13312
    s_waitcnt lgkmcnt(4)
    v_mfma_f32_32x32x16_bf16 v[64:79], v[208:211], v[128:131], v[64:79]
    s_add_u32 m0, s61, 10240
    s_lshl_b32 s43, s41, 16
    buffer_load_dwordx4 v6, s[56:59], s43 offen lds
    v_mfma_f32_32x32x16_bf16 v[80:95], v[208:211], v[132:135], v[80:95]
    s_add_u32 m0, m0, 1024
    s_add_u32 s43, s43, 8192
    buffer_load_dwordx4 v6, s[56:59], s43 offen lds
    v_mfma_f32_32x32x16_bf16 v[96:111], v[212:215], v[128:131], v[96:111]
    s_lshl_b32 s39, s41, 12
    s_add_u32 s39, s39, s42
    buffer_load_dwordx4 v[160:163], v15, s[28:31], s39 offen sc1
    v_mfma_f32_32x32x16_bf16 v[112:127], v[212:215], v[132:135], v[112:127]
    s_add_u32 s39, s39, s54
    buffer_load_dwordx4 v[164:167], v15, s[28:31], s39 offen sc1
    s_add_u32 s41, s41, 1
    s_and_b32 s41, s41, 15
    buffer_load_dword v20, v19, s[28:31], 0 offen sc1
    s_waitcnt vmcnt(11)
    ds_read_b64_tr_b16 v[208:209], v7 offset:14336
    ds_read_b64_tr_b16 v[210:211], v7 offset:15360
    ds_read_b64_tr_b16 v[212:213], v13 offset:14336
    ds_read_b64_tr_b16 v[214:215], v13 offset:15360
    s_waitcnt lgkmcnt(4)
    v_mfma_f32_32x32x16_bf16 v[64:79], v[200:203], v[136:139], v[64:79]
    s_add_u32 m0, s61, 16384
    s_lshl_b32 s43, s41, 16
    buffer_load_dwordx4 v6, s[56:59], s43 offen lds
    v_mfma_f32_32x32x16_bf16 v[80:95], v[200:203], v[140:143], v[80:95]
    s_add_u32 m0, m0, 1024
    s_add_u32 s43, s43, 8192
    buffer_load_dwordx4 v6, s[56:59], s43 offen lds
    v_mfma_f32_32x32x16_bf16 v[96:111], v[204:207], v[136:139], v[96:111]
    s_lshl_b32 s39, s41, 12
    s_add_u32 s39, s39, s42
    buffer_load_dwordx4 v[168:171], v15, s[28:31], s39 offen sc1
    v_mfma_f32_32x32x16_bf16 v[112:127], v[204:207], v[140:143], v[112:127]
    s_add_u32 s39, s39, s54
    buffer_load_dwordx4 v[172:175], v15, s[28:31], s39 offen sc1
    s_add_u32 s41, s41, 1
    s_and_b32 s41, s41, 15
    s_waitcnt vmcnt(11)
    ds_read_b64_tr_b16 v[200:201], v7 offset:8192
    ds_read_b64_tr_b16 v[202:203], v7 offset:9216
    ds_read_b64_tr_b16 v[204:205], v13 offset:8192
    ds_read_b64_tr_b16 v[206:207], v13 offset:9216
    s_waitcnt lgkmcnt(4)
    v_mfma_f32_32x32x16_bf16 v[64:79], v[208:211], v[144:147], v[64:79]
    s_add_u32 m0, s61, 18432
    s_lshl_b32 s43, s41, 16
    buffer_load_dwordx4 v6, s[56:59], s43 offen lds
    v_mfma_f32_32x32x16_bf16 v[80:95], v[208:211], v[148:151], v[80:95]
    s_add_u32 m0, m0, 1024
    s_add_u32 s43, s43, 8192
    buffer_load_dwordx4 v6, s[56:59], s43 offen lds
    v_mfma_f32_32x32x16_bf16 v[96:111], v[212:215], v[144:147], v[96:111]
    s_lshl_b32 s39, s41, 12
    s_add_u32 s39, s39, s42
    buffer_load_dwordx4 v[176:179], v15, s[28:31], s39 offen sc1
    v_mfma_f32_32x32x16_bf16 v[112:127], v[212:215], v[148:151], v[112:127]
    s_add_u32 s39, s39, s54
    buffer_load_dwordx4 v[180:183], v15, s[28:31], s39 offen sc1
    s_mov_b32 s41, s53
    s_setprio 3
    s_waitcnt vmcnt(8)
    v_cmp_ne_u32 s[6:7], s33, v20
    s_nop 3
    s_cmp_eq_u64 s[6:7], 0
    s_cbranch_scc1 L_g_pollh2_done
L_g_pollh2:
    buffer_load_dword v20, v19, s[28:31], 0 offen sc1
    s_waitcnt vmcnt(0)
    v_xor_b32 v20, s33, v20
    v_cmp_ne_u32 s[6:7], 0, v20
    s_nop 3
    s_cmp_eq_u64 s[6:7], 0
    s_cbranch_scc1 L_g_pollh2_done
    s_sleep 4
    s_sub_u32 s3, s3, 1
    s_cbranch_scc0 L_g_pollh2
    s_mov_b32 s3, 0
L_g_pollh2_done:
    s_setprio 0
    s_waitcnt vmcnt(11)
    ds_read_b64_tr_b16 v[208:209], v7 offset:10240
    ds_read_b64_tr_b16 v[210:211], v7 offset:11264
    ds_read_b64_tr_b16 v[212:213], v13 offset:10240
    ds_read_b64_tr_b16 v[214:215], v13 offset:11264
    s_waitcnt lgkmcnt(4)
    v_mfma_f32_32x32x16_bf16 v[64:79], v[200:203], v[152:155], v[64:79]
    s_add_u32 m0, s61, 0
    s_lshl_b32 s43, s41, 16
    buffer_load_dwordx4 v6, s[56:59], s43 offen lds
    v_mfma_f32_32x32x16_bf16 v[80:95], v[200:203], v[156:159], v[80:95]
    s_add_u32 m0, m0, 1024
    s_add_u32 s43, s43, 8192
    buffer_load_dwordx4 v6, s[56:59], s43 offen lds
    v_mfma_f32_32x32x16_bf16 v[96:111], v[204:207], v[152:155], v[96:111]
    s_lshl_b32 s39, s41, 12
    s_add_u32 s39, s39, s42
    buffer_load_dwordx4 v[184:187], v15, s[28:31], s39 offen sc1
    v_mfma_f32_32x32x16_bf16 v[112:127], v[204:207], v[156:159], v[112:127]
    s_add_u32 s39, s39, s54
    buffer_load_dwordx4 v[188:191], v15, s[28:31], s39 offen sc1
    s_add_u32 s41, s41, 1
    s_cmp_eq_u32 s41, 28
    s_cselect_b32 s41, 16, s41
    s_waitcnt vmcnt(10)
    ds_read_b64_tr_b16 v[200:201], v7 offset:16384
    ds_read_b64_tr_b16 v[202:203], v7 offset:17408
    ds_read_b64_tr_b16 v[204:205], v13 offset:16384
    ds_read_b64_tr_b16 v[206:207], v13 offset:17408
    s_waitcnt lgkmcnt(4)
    v_mfma_f32_32x32x16_bf16 v[64:79], v[208:211], v[160:163], v[64:79]
    s_add_u32 m0, s61, 2048
    s_lshl_b32 s43, s41, 16
    buffer_load_dwordx4 v6, s[56:59], s43 offen lds
    v_mfma_f32_32x32x16_bf16 v[80:95], v[208:211], v[164:167], v[80:95]
    s_add_u32 m0, m0, 1024
    s_add_u32 s43, s43, 8192
    buffer_load_dwordx4 v6, s[56:59], s43 offen lds
    v_mfma_f32_32x32x16_bf16 v[96:111], v[212:215], v[160:163], v[96:111]
    s_lshl_b32 s39, s41, 12
    s_add_u32 s39, s39, s42
    buffer_load_dwordx4 v[192:195], v15, s[28:31], s39 offen sc1
    v_mfma_f32_32x32x16_bf16 v[112:127], v[212:215], v[164:167], v[112:127]
    s_add_u32 s39, s39, s54
    buffer_load_dwordx4 v[196:199], v15, s[28:31], s39 offen sc1
    s_add_u32 s41, s41, 1
    s_cmp_eq_u32 s41, 28
    s_cselect_b32 s41, 16, s41
    s_waitcnt vmcnt(10)
    ds_read_b64_tr_b16 v[208:209], v7 offset:18432
    ds_read_b64_tr_b16 v[210:211], v7 offset:19456
    ds_read_b64_tr_b16 v[212:213], v13 offset:18432
    ds_read_b64_tr_b16 v[214:215], v13 offset:19456
    s_waitcnt lgkmcnt(4)
    v_mfma_f32_32x32x16_bf16 v[64:79], v[200:203], v[168:171], v[64:79]
    s_add_u32 m0, s61, 4096
    s_lshl_b32 s43, s41, 16
    buffer_load_dwordx4 v6, s[56:59], s43 offen lds
    v_mfma_f32_32x32x16_bf16 v[80:95], v[200:203], v[172:175], v[80:95]
    s_add_u32 m0, m0, 1024
    s_add_u32 s43, s43, 8192
    buffer_load_dwordx4 v6, s[56:59], s43 offen lds
    v_mfma_f32_32x32x16_bf16 v[96:111], v[204:207], v[168:171], v[96:111]
    s_lshl_b32 s39, s41, 12
    s_add_u32 s39, s39, s42
    buffer_load_dwordx4 v[128:131], v15, s[28:31], s39 offen sc1
    v_mfma_f32_32x32x16_bf16 v[112:127], v[204:207], v[172:175], v[112:127]
    s_add_u32 s39, s39, s54
    buffer_load_dwordx4 v[132:135], v15, s[28:31], s39 offen sc1
    s_add_u32 s41, s41, 1
    s_cmp_eq_u32 s41, 28
    s_cselect_b32 s41, 16, s41
    s_waitcnt vmcnt(10)
    ds_read_b64_tr_b16 v[200:201], v7 offset:0
    ds_read_b64_tr_b16 v[202:203], v7 offset:1024
    ds_read_b64_tr_b16 v[204:205], v13 offset:0
    ds_read_b64_tr_b16 v[206:207], v13 offset:1024
    s_waitcnt lgkmcnt(4)
    v_mfma_f32_32x32x16_bf16 v[64:79], v[208:211], v[176:179], v[64:79]
    s_add_u32 m0, s61, 6144
    s_lshl_b32 s43, s41, 16
    buffer_load_dwordx4 v6, s[56:59], s43 offen lds
    v_mfma_f32_32x32x16_bf16 v[80:95], v[208:211], v[180:183], v[80:95]
    s_add_u32 m0, m0, 1024
    s_add_u32 s43, s43, 8192
    buffer_load_dwordx4 v6, s[56:59], s43 offen lds
    v_mfma_f32_32x32x16_bf16 v[96:111], v[212:215], v[176:179], v[96:111]
    s_lshl_b32 s39, s41, 12
    s_add_u32 s39, s39, s42
    buffer_load_dwordx4 v[136:139], v15, s[28:31], s39 offen sc1
    v_mfma_f32_32x32x16_bf16 v[112:127], v[212:215], v[180:183], v[112:127]
    s_add_u32 s39, s39, s54
    buffer_load_dwordx4 v[140:143], v15, s[28:31], s39 offen sc1
    s_add_u32 s41, s41, 1
    s_cmp_eq_u32 s41, 28
    s_cselect_b32 s41, 16, s41
    s_waitcnt vmcnt(10)
    ds_read_b64_tr_b16 v[208:209], v7 offset:2048
    ds_read_b64_tr_b16 v[210:211], v7 offset:3072
    ds_read_b64_tr_b16 v[212:213], v13 offset:2048
    ds_read_b64_tr_b16 v[214:215], v13 offset:3072
    s_waitcnt lgkmcnt(4)
    v_mfma_f32_32x32x16_bf16 v[64:79], v[200:203], v[184:187], v[64:79]
    s_add_u32 m0, s61, 12288
    s_lshl_b32 s43, s41, 16
    buffer_load_dwordx4 v6, s[56:59], s43 offen lds
    v_mfma_f32_32x32x16_bf16 v[80:95], v[200:203], v[188:191], v[80:95]
    s_add_u32 m0, m0, 1024
    s_add_u32 s43, s43, 8192
    buffer_load_dwordx4 v6, s[56:59], s43 offen lds
    v_mfma_f32_32x32x16_bf16 v[96:111], v[204:207], v[184:187], v[96:111]
    s_lshl_b32 s39, s41, 12
    s_add_u32 s39, s39, s42
    buffer_load_dwordx4 v[144:147], v15, s[28:31], s39 offen sc1
    v_mfma_f32_32x32x16_bf16 v[112:127], v[204:207], v[188:191], v[112:127]
    s_add_u32 s39, s39, s54
    buffer_load_dwordx4 v[148:151], v15, s[28:31], s39 offen sc1
    s_add_u32 s41, s41, 1
    s_cmp_eq_u32 s41, 28
    s_cselect_b32 s41, 16, s41
    s_waitcnt vmcnt(10)
    ds_read_b64_tr_b16 v[200:201], v7 offset:4096
    ds_read_b64_tr_b16 v[202:203], v7 offset:5120
    ds_read_b64_tr_b16 v[204:205], v13 offset:4096
    ds_read_b64_tr_b16 v[206:207], v13 offset:5120
    s_waitcnt lgkmcnt(4)
    v_mfma_f32_32x32x16_bf16 v[64:79], v[208:211], v[192:195], v[64:79]
    s_add_u32 m0, s61, 14336
    s_lshl_b32 s43, s41, 16
    buffer_load_dwordx4 v6, s[56:59], s43 offen lds
    v_mfma_f32_32x32x16_bf16 v[80:95], v[208:211], v[196:199], v[80:95]
    s_add_u32 m0, m0, 1024
    s_add_u32 s43, s43, 8192
    buffer_load_dwordx4 v6, s[56:59], s43 offen lds
    v_mfma_f32_32x32x16_bf16 v[96:111], v[212:215], v[192:195], v[96:111]
    s_lshl_b32 s39, s41, 12
    s_add_u32 s39, s39, s42
    buffer_load_dwordx4 v[152:155], v15, s[28:31], s39 offen sc1
    v_mfma_f32_32x32x16_bf16 v[112:127], v[212:215], v[196:199], v[112:127]
    s_add_u32 s39, s39, s54
    buffer_load_dwordx4 v[156:159], v15, s[28:31], s39 offen sc1
    s_add_u32 s41, s41, 1
    s_cmp_eq_u32 s41, 28
    s_cselect_b32 s41, 16, s41
    s_waitcnt vmcnt(10)
    ds_read_b64_tr_b16 v[208:209], v7 offset:6144
    ds_read_b64_tr_b16 v[210:211], v7 offset:7168
    ds_read_b64_tr_b16 v[212:213], v13 offset:6144
    ds_read_b64_tr_b16 v[214:215], v13 offset:7168
    s_waitcnt lgkmcnt(4)
    v_mfma_f32_32x32x16_bf16 v[64:79], v[200:203], v[128:131], v[64:79]
    s_add_u32 m0, s61, 8192
    s_lshl_b32 s43, s41, 16
    buffer_load_dwordx4 v6, s[56:59], s43 offen lds
    v_mfma_f32_32x32x16_bf16 v[80:95], v[200:203], v[132:135], v[80:95]
    s_add_u32 m0, m0, 1024
    s_add_u32 s43, s43, 8192
    buffer_load_dwordx4 v6, s[56:59], s43 offen lds
    v_mfma_f32_32x32x16_bf16 v[96:111], v[204:207], v[128:131], v[96:111]
    s_lshl_b32 s39, s41, 12
    s_add_u32 s39, s39, s42
    buffer_load_dwordx4 v[160:163], v15, s[28:31], s39 offen sc1
    v_mfma_f32_32x32x16_bf16 v[112:127], v[204:207], v[132:135], v[112:127]
    s_add_u32 s39, s39, s54
    buffer_load_dwordx4 v[164:167], v15, s[28:31], s39 offen sc1
    s_add_u32 s41, s41, 1
    s_cmp_eq_u32 s41, 28
    s_cselect_b32 s41, 16, s41
    s_waitcnt vmcnt(10)
    ds_read_b64_tr_b16 v[200:201], v7 offset:12288
    ds_read_b64_tr_b16 v[202:203], v7 offset:13312
    ds_read_b64_tr_b16 v[204:205], v13 offset:12288
    ds_read_b64_tr_b16 v[206:207], v13 offset:13312
    s_waitcnt lgkmcnt(4)
    v_mfma_f32_32x32x16_bf16 v[64:79], v[208:211], v[136:139], v[64:79]
    s_add_u32 m0, s61, 10240
    s_lshl_b32 s43, s41, 16
    buffer_load_dwordx4 v6, s[56:59], s43 offen lds
    v_mfma_f32_32x32x16_bf16 v[80:95], v[208:211], v[140:143], v[80:95]
    s_add_u32 m0, m0, 1024
    s_add_u32 s43, s43, 8192
    buffer_load_dwordx4 v6, s[56:59], s43 offen lds
    v_mfma_f32_32x32x16_bf16 v[96:111], v[212:215], v[136:139], v[96:111]
    s_lshl_b32 s39, s41, 12
    s_add_u32 s39, s39, s42
    buffer_load_dwordx4 v[168:171], v15, s[28:31], s39 offen sc1
    v_mfma_f32_32x32x16_bf16 v[112:127], v[212:215], v[140:143], v[112:127]
    s_add_u32 s39, s39, s54
    buffer_load_dwordx4 v[172:175], v15, s[28:31], s39 offen sc1
    s_add_u32 s41, s41, 1
    s_cmp_eq_u32 s41, 28
    s_cselect_b32 s41, 16, s41
    s_waitcnt vmcnt(10)
    ds_read_b64_tr_b16 v[208:209], v7 offset:14336
    ds_read_b64_tr_b16 v[210:211], v7 offset:15360
    ds_read_b64_tr_b16 v[212:213], v13 offset:14336
    ds_read_b64_tr_b16 v[214:215], v13 offset:15360
    s_waitcnt lgkmcnt(4)
    v_mfma_f32_32x32x16_bf16 v[64:79], v[200:203], v[144:147], v[64:79]
    s_add_u32 m0, s61, 16384
    s_lshl_b32 s43, s41, 16
    buffer_load_dwordx4 v6, s[56:59], s43 offen lds
    v_mfma_f32_32x32x16_bf16 v[80:95], v[200:203], v[148:151], v[80:95]
    s_add_u32 m0, m0, 1024
    s_add_u32 s43, s43, 8192
    buffer_load_dwordx4 v6, s[56:59], s43 offen lds
    v_mfma_f32_32x32x16_bf16 v[96:111], v[204:207], v[144:147], v[96:111]
    s_lshl_b32 s39, s41, 12
    s_add_u32 s39, s39, s42
    buffer_load_dwordx4 v[176:179], v15, s[28:31], s39 offen sc1
    v_mfma_f32_32x32x16_bf16 v[112:127], v[204:207], v[148:151], v[112:127]
    s_add_u32 s39, s39, s54
    buffer_load_dwordx4 v[180:183], v15, s[28:31], s39 offen sc1
    s_add_u32 s41, s41, 1
    s_cmp_eq_u32 s41, 28
    s_cselect_b32 s41, 16, s41
    s_waitcnt vmcnt(10)
    ds_read_b64_tr_b16 v[200:201], v7 offset:8192
    ds_read_b64_tr_b16 v[202:203], v7 offset:9216
    ds_read_b64_tr_b16 v[204:205], v13 offset:8192
    ds_read_b64_tr_b16 v[206:207], v13 offset:9216
    s_waitcnt lgkmcnt(4)
    v_mfma_f32_32x32x16_bf16 v[64:79], v[208:211], v[152:155], v[64:79]
    s_add_u32 m0, s61, 18432
    s_lshl_b32 s43, s41, 16
    buffer_load_dwordx4 v6, s[56:59], s43 offen lds
    v_mfma_f32_32x32x16_bf16 v[80:95], v[208:211], v[156:159], v[80:95]
    s_add_u32 m0, m0, 1024
    s_add_u32 s43, s43, 8192
    buffer_load_dwordx4 v6, s[56:59], s43 offen lds
    v_mfma_f32_32x32x16_bf16 v[96:111], v[212:215], v[152:155], v[96:111]
    s_lshl_b32 s39, s41, 12
    s_add_u32 s39, s39, s42
    buffer_load_dwordx4 v[184:187], v15, s[28:31], s39 offen sc1
    v_mfma_f32_32x32x16_bf16 v[112:127], v[212:215], v[156:159], v[112:127]
    s_add_u32 s39, s39, s54
    buffer_load_dwordx4 v[188:191], v15, s[28:31], s39 offen sc1
    s_add_u32 s41, s41, 1
    s_cmp_eq_u32 s41, 28
    s_cselect_b32 s41, 16, s41
    s_waitcnt vmcnt(10)
    ds_read_b64_tr_b16 v[208:209], v7 offset:10240
    ds_read_b64_tr_b16 v[210:211], v7 offset:11264
    ds_read_b64_tr_b16 v[212:213], v13 offset:10240
    ds_read_b64_tr_b16 v[214:215], v13 offset:11264
    s_waitcnt lgkmcnt(4)
    v_mfma_f32_32x32x16_bf16 v[64:79], v[200:203], v[160:163], v[64:79]
    s_add_u32 m0, s61, 0
    s_lshl_b32 s43, s41, 16
    buffer_load_dwordx4 v6, s[56:59], s43 offen lds
    v_mfma_f32_32x32x16_bf16 v[80:95], v[200:203], v[164:167], v[80:95]
    s_add_u32 m0, m0, 1024
    s_add_u32 s43, s43, 8192
    buffer_load_dwordx4 v6, s[56:59], s43 offen lds
    v_mfma_f32_32x32x16_bf16 v[96:111], v[204:207], v[160:163], v[96:111]
    s_lshl_b32 s39, s41, 12
    s_add_u32 s39, s39, s42
    buffer_load_dwordx4 v[192:195], v15, s[28:31], s39 offen sc1
    v_mfma_f32_32x32x16_bf16 v[112:127], v[204:207], v[164:167], v[112:127]
    s_add_u32 s39, s39, s54
    buffer_load_dwordx4 v[196:199], v15, s[28:31], s39 offen sc1
    s_add_u32 s41, s41, 1
    s_cmp_eq_u32 s41, 28
    s_cselect_b32 s41, 16, s41
    s_waitcnt vmcnt(10)
    ds_read_b64_tr_b16 v[200:201], v7 offset:16384
    ds_read_b64_tr_b16 v[202:203], v7 offset:17408
    ds_read_b64_tr_b16 v[204:205], v13 offset:16384
    ds_read_b64_tr_b16 v[206:207], v13 offset:17408
    s_waitcnt lgkmcnt(4)
    v_mfma_f32_32x32x16_bf16 v[64:79], v[208:211], v[168:171], v[64:79]
    s_add_u32 m0, s61, 2048
    s_lshl_b32 s43, s41, 16
    buffer_load_dwordx4 v6, s[56:59], s43 offen lds
    v_mfma_f32_32x32x16_bf16 v[80:95], v[208:211], v[172:175], v[80:95]
    s_add_u32 m0, m0, 1024
    s_add_u32 s43, s43, 8192
    buffer_load_dwordx4 v6, s[56:59], s43 offen lds
    v_mfma_f32_32x32x16_bf16 v[96:111], v[212:215], v[168:171], v[96:111]
    s_lshl_b32 s39, s41, 12
    s_add_u32 s39, s39, s42
    buffer_load_dwordx4 v[128:131], v15, s[28:31], s39 offen sc1
    v_mfma_f32_32x32x16_bf16 v[112:127], v[212:215], v[172:175], v[112:127]
    s_add_u32 s39, s39, s54
    buffer_load_dwordx4 v[132:135], v15, s[28:31], s39 offen sc1
    s_add_u32 s41, s41, 1
    s_cmp_eq_u32 s41, 28
    s_cselect_b32 s41, 16, s41
    s_waitcnt vmcnt(10)
    ds_read_b64_tr_b16 v[208:209], v7 offset:18432
    ds_read_b64_tr_b16 v[210:211], v7 offset:19456
    ds_read_b64_tr_b16 v[212:213], v13 offset:18432
    ds_read_b64_tr_b16 v[214:215], v13 offset:19456
    s_waitcnt lgkmcnt(4)
    v_mfma_f32_32x32x16_bf16 v[64:79], v[200:203], v[176:179], v[64:79]
    s_add_u32 m0, s61, 4096
    s_mov_b32 s43, 0
    buffer_load_dwordx4 v6, s[12:15], s43 offen lds
    v_mfma_f32_32x32x16_bf16 v[80:95], v[200:203], v[180:183], v[80:95]
    s_add_u32 m0, m0, 1024
    s_add_u32 s43, s43, 8192
    buffer_load_dwordx4 v6, s[12:15], s43 offen lds
    v_mfma_f32_32x32x16_bf16 v[96:111], v[204:207], v[176:179], v[96:111]
    s_add_u32 m0, s61, 6144
    s_mov_b32 s43, 65536
    buffer_load_dwordx4 v6, s[12:15], s43 offen lds
    v_mfma_f32_32x32x16_bf16 v[112:127], v[204:207], v[180:183], v[112:127]
    s_add_u32 m0, m0, 1024
    s_add_u32 s43, s43, 8192
    buffer_load_dwordx4 v6, s[12:15], s43 offen lds
    s_waitcnt vmcnt(10)
    ds_read_b64_tr_b16 v[200:201], v7 offset:0
    ds_read_b64_tr_b16 v[202:203], v7 offset:1024
    ds_read_b64_tr_b16 v[204:205], v13 offset:0
    ds_read_b64_tr_b16 v[206:207], v13 offset:1024
    s_waitcnt lgkmcnt(4)
    v_mfma_f32_32x32x16_bf16 v[64:79], v[208:211], v[184:187], v[64:79]
    s_add_u32 m0, s61, 12288
    s_mov_b32 s43, 131072
    buffer_load_dwordx4 v6, s[12:15], s43 offen lds
    v_mfma_f32_32x32x16_bf16 v[80:95], v[208:211], v[188:191], v[80:95]
    s_add_u32 m0, m0, 1024
    s_add_u32 s43, s43, 8192
    buffer_load_dwordx4 v6, s[12:15], s43 offen lds
    v_mfma_f32_32x32x16_bf16 v[96:111], v[212:215], v[184:187], v[96:111]
    s_add_u32 m0, s61, 14336
    s_mov_b32 s43, 196608
    buffer_load_dwordx4 v6, s[12:15], s43 offen lds
    v_mfma_f32_32x32x16_bf16 v[112:127], v[212:215], v[188:191], v[112:127]
    s_add_u32 m0, m0, 1024
    s_add_u32 s43, s43, 8192
    buffer_load_dwordx4 v6, s[12:15], s43 offen lds
    s_waitcnt vmcnt(10)
    ds_read_b64_tr_b16 v[208:209], v7 offset:2048
    ds_read_b64_tr_b16 v[210:211], v7 offset:3072
    ds_read_b64_tr_b16 v[212:213], v13 offset:2048
    ds_read_b64_tr_b16 v[214:215], v13 offset:3072
    s_waitcnt lgkmcnt(4)
    v_mfma_f32_32x32x16_bf16 v[64:79], v[200:203], v[192:195], v[64:79]
    s_add_u32 m0, s61, 8192
    s_mov_b32 s43, 262144
    buffer_load_dwordx4 v6, s[12:15], s43 offen lds
    v_mfma_f32_32x32x16_bf16 v[80:95], v[200:203], v[196:199], v[80:95]
    s_add_u32 m0, m0, 1024
    s_add_u32 s43, s43, 8192
    buffer_load_dwordx4 v6, s[12:15], s43 offen lds
    v_mfma_f32_32x32x16_bf16 v[96:111], v[204:207], v[192:195], v[96:111]
    s_add_u32 m0, s61, 10240
    s_mov_b32 s43, 327680
    buffer_load_dwordx4 v6, s[12:15], s43 offen lds
    v_mfma_f32_32x32x16_bf16 v[112:127], v[204:207], v[196:199], v[112:127]
    s_add_u32 m0, m0, 1024
    s_add_u32 s43, s43, 8192
    buffer_load_dwordx4 v6, s[12:15], s43 offen lds
    s_waitcnt vmcnt(12)
    s_waitcnt lgkmcnt(0)
    v_mfma_f32_32x32x16_bf16 v[64:79], v[208:211], v[128:131], v[64:79]
    s_add_u32 m0, s61, 16384
    s_mov_b32 s43, 393216
    buffer_load_dwordx4 v6, s[12:15], s43 offen lds
    v_mfma_f32_32x32x16_bf16 v[80:95], v[208:211], v[132:135], v[80:95]
    s_add_u32 m0, m0, 1024
    s_add_u32 s43, s43, 8192
    buffer_load_dwordx4 v6, s[12:15], s43 offen lds
    v_mfma_f32_32x32x16_bf16 v[96:111], v[212:215], v[128:131], v[96:111]
    s_add_u32 m0, s61, 18432
    s_mov_b32 s43, 458752
    buffer_load_dwordx4 v6, s[12:15], s43 offen lds
    v_mfma_f32_32x32x16_bf16 v[112:127], v[212:215], v[132:135], v[112:127]
    s_add_u32 m0, m0, 1024
    s_add_u32 s43, s43, 8192
    buffer_load_dwordx4 v6, s[12:15], s43 offen lds
    s_setprio 3
    v_and_b32 v42, 7, v1
    v_lshlrev_b32 v42, 12, v42
    s_sub_u32 s47, s42, 32768
    s_mov_b32 s46, 0xff
    buffer_load_dword v43, v42, s[28:31], s47 offen sc1
    v_add_u32 v36, s61, v15
    s_xor_b32 s37, s32, 1
    s_mul_i32 s37, s37, 20480
    v_add_u32 v37, s37, v15
    s_xor_b32 s37, s32, 2
    s_mul_i32 s37, s37, 20480
    v_add_u32 v38, s37, v15
    s_xor_b32 s37, s32, 3
    s_mul_i32 s37, s37, 20480
    v_add_u32 v39, s37, v15
    v_lshlrev_b32 v40, 16, v44
    v_and_b32 v41, 0xffff0000, v44
    v_add_f32 v64, v64, v40
    v_add_f32 v65, v65, v41
    v_lshlrev_b32 v40, 16, v45
    v_and_b32 v41, 0xffff0000, v45
    v_add_f32 v66, v66, v40
    v_add_f32 v67, v67, v41
    v_lshlrev_b32 v40, 16, v46
    v_and_b32 v41, 0xffff0000, v46
    v_add_f32 v68, v68, v40
    v_add_f32 v69, v69, v41
    v_lshlrev_b32 v40, 16, v47
    v_and_b32 v41, 0xffff0000, v47
    v_add_f32 v70, v70, v40
    v_add_f32 v71, v71, v41
    v_lshlrev_b32 v40, 16, v48
    v_and_b32 v41, 0xffff0000, v48
    v_add_f32 v72, v72, v40
    v_add_f32 v73, v73, v41
    v_lshlrev_b32 v40, 16, v49
    v_and_b32 v41, 0xffff0000, v49
    v_add_f32 v74, v74, v40
    v_add_f32 v75, v75, v41
    v_lshlrev_b32 v40, 16, v50
    v_and_b32 v41, 0xffff0000, v50
    v_add_f32 v76, v76, v40
    v_add_f32 v77, v77, v41
    v_lshlrev_b32 v40, 16, v51
    v_and_b32 v41, 0xffff0000, v51
    v_add_f32 v78, v78, v40
    v_add_f32 v79, v79, v41
    s_waitcnt vmcnt(1)
    ds_read_b64_tr_b16 v[192:193], v7 offset:4096
    ds_read_b64_tr_b16 v[194:195], v7 offset:5120
    ds_read_b64_tr_b16 v[196:197], v13 offset:4096
    ds_read_b64_tr_b16 v[198:199], v13 offset:5120
    ds_read_b64_tr_b16 v[200:201], v7 offset:6144
    ds_read_b64_tr_b16 v[202:203], v7 offset:7168
    ds_read_b64_tr_b16 v[204:205], v13 offset:6144
    ds_read_b64_tr_b16 v[206:207], v13 offset:7168
    ds_read_b64_tr_b16 v[208:209], v7 offset:12288
    ds_read_b64_tr_b16 v[210:211], v7 offset:13312
    ds_read_b64_tr_b16 v[212:213], v13 offset:12288
    ds_read_b64_tr_b16 v[214:215], v13 offset:13312
    ds_read_b64_tr_b16 v[216:217], v7 offset:14336
    ds_read_b64_tr_b16 v[218:219], v7 offset:15360
    ds_read_b64_tr_b16 v[220:221], v13 offset:14336
    ds_read_b64_tr_b16 v[222:223], v13 offset:15360
    ds_read_b64_tr_b16 v[224:225], v7 offset:8192
    ds_read_b64_tr_b16 v[226:227], v7 offset:9216
    ds_read_b64_tr_b16 v[228:229], v13 offset:8192
    ds_read_b64_tr_b16 v[230:231], v13 offset:9216
    ds_read_b64_tr_b16 v[232:233], v7 offset:10240
    ds_read_b64_tr_b16 v[234:235], v7 offset:11264
    ds_read_b64_tr_b16 v[236:237], v13 offset:10240
    ds_read_b64_tr_b16 v[238:239], v13 offset:11264
    ds_read_b64_tr_b16 v[240:241], v7 offset:16384
    ds_read_b64_tr_b16 v[242:243], v7 offset:17408
    ds_read_b64_tr_b16 v[244:245], v13 offset:16384
    ds_read_b64_tr_b16 v[246:247], v13 offset:17408
    ds_read_b64_tr_b16 v[248:249], v7 offset:18432
    ds_read_b64_tr_b16 v[250:251], v7 offset:19456
    ds_read_b64_tr_b16 v[252:253], v13 offset:18432
    ds_read_b64_tr_b16 v[254:255], v13 offset:19456
L_g_round:
    s_mov_b32 s52, s46
    s_bcnt1_i32_b32 s37, s46
    s_cmp_le_u32 s37, 4
    s_cbranch_scc1 L_g_full
    s_cmp_eq_u32 s3, 0
    s_cbranch_scc1 L_g_full
    s_waitcnt vmcnt(0)
    v_cmp_ne_u32 s[6:7], -1, v43
    s_nop 3
    s_and_b32 s52, s6, s46
    s_cbranch_scc1 L_g_full
    s_sleep 4
    buffer_load_dword v43, v42, s[28:31], s47 offen sc1
    s_branch L_g_next
L_g_full:
    s_and_b32 s37, s52, 15
    s_cbranch_scc0 L_g_nl3
    s_and_b32 s37, s52, 3
    s_cbranch_scc0 L_g_nl1
    s_bitcmp1_b32 s52, 0
    s_cbranch_scc0 L_g_nl0
    s_add_u32 s39, s47, 0
    s_add_u32 s37, s39, s54
    buffer_load_dwordx4 v[128:131], v15, s[28:31], s39 offen sc1
    buffer_load_dwordx4 v[132:135], v15, s[28:31], s37 offen sc1
L_g_nl0:
    s_bitcmp1_b32 s52, 1
    s_cbranch_scc0 L_g_nl1
    s_add_u32 s39, s47, 4096
    s_add_u32 s37, s39, s54
    buffer_load_dwordx4 v[136:139], v15, s[28:31], s39 offen sc1
    buffer_load_dwordx4 v[140:143], v15, s[28:31], s37 offen sc1
L_g_nl1:
    s_and_b32 s37, s52, 12
    s_cbranch_scc0 L_g_nl3
    s_bitcmp1_b32 s52, 2
    s_cbranch_scc0 L_g_nl2
    s_add_u32 s39, s47, 8192
    s_add_u32 s37, s39, s54
    buffer_load_dwordx4 v[144:147], v15, s[28:31], s39 offen sc1
    buffer_load_dwordx4 v[148:151], v15, s[28:31], s37 offen sc1
L_g_nl2:
    s_bitcmp1_b32 s52, 3
    s_cbranch_scc0 L_g_nl3
    s_add_u32 s39, s47, 12288
    s_add_u32 s37, s39, s54
    buffer_load_dwordx4 v[152:155], v15, s[28:31], s39 offen sc1
    buffer_load_dwordx4 v[156:159], v15, s[28:31], s37 offen sc1
L_g_nl3:
    s_and_b32 s37, s52, 240
    s_cbranch_scc0 L_g_nl7
    s_and_b32 s37, s52, 48
    s_cbranch_scc0 L_g_nl5
    s_bitcmp1_b32 s52, 4
    s_cbranch_scc0 L_g_nl4
    s_add_u32 s39, s47, 16384
    s_add_u32 s37, s39, s54
    buffer_load_dwordx4 v[160:163], v15, s[28:31], s39 offen sc1
    buffer_load_dwordx4 v[164:167], v15, s[28:31], s37 offen sc1
L_g_nl4:
    s_bitcmp1_b32 s52, 5
    s_cbranch_scc0 L_g_nl5
    s_add_u32 s39, s47, 20480
    s_add_u32 s37, s39, s54
    buffer_load_dwordx4 v[168:171], v15, s[28:31], s39 offen sc1
    buffer_load_dwordx4 v[172:175], v15, s[28:31], s37 offen sc1
L_g_nl5:
    s_and_b32 s37, s52, 192
    s_cbranch_scc0 L_g_nl7
    s_bitcmp1_b32 s52, 6
    s_cbranch_scc0 L_g_nl6
    s_add_u32 s39, s47, 24576
    s_add_u32 s37, s39, s54
    buffer_load_dwordx4 v[176:179], v15, s[28:31], s39 offen sc1
    buffer_load_dwordx4 v[180:183], v15, s[28:31], s37 offen sc1
L_g_nl6:
    s_bitcmp1_b32 s52, 7
    s_cbranch_scc0 L_g_nl7
    s_add_u32 s39, s47, 28672
    s_add_u32 s37, s39, s54
    buffer_load_dwordx4 v[184:187], v15, s[28:31], s39 offen sc1
    buffer_load_dwordx4 v[188:191], v15, s[28:31], s37 offen sc1
L_g_nl7:
    s_andn2_b32 s37, s46, s52
    s_bcnt1_i32_b32 s37, s37
    s_cmp_le_u32 s37, 4
    s_cselect_b32 s48, 0x20000000, s47
    s_waitcnt vmcnt(0) lgkmcnt(0)
    buffer_load_dword v43, v42, s[28:31], s48 offen sc1
    s_and_b32 s37, s52, 15
    s_cbranch_scc0 L_g_nm3
    s_and_b32 s37, s52, 3
    s_cbranch_scc0 L_g_nm1
    s_bitcmp1_b32 s52, 0
    s_cbranch_scc0 L_g_nm0
    v_max3_u32 v40, v128, v129, v130
    v_max3_u32 v41, v131, v132, v133
    v_max3_u32 v40, v40, v134, v135
    v_max_u32 v40, v40, v41
    v_cmp_eq_u32 s[6:7], -1, v40
    s_cmp_eq_u32 s3, 0
    s_cbranch_scc1 L_g_go0
    s_nop 0
    s_cmp_lg_u64 s[6:7], 0
    s_cbranch_scc1 L_g_nm0
L_g_go0:
    s_bitset0_b32 s46, 0
    v_mfma_f32_32x32x16_bf16 v[80:95], v[192:195], v[132:135], v[80:95]
    v_mfma_f32_32x32x16_bf16 v[96:111], v[196:199], v[128:131], v[96:111]
    v_mfma_f32_32x32x16_bf16 v[112:127], v[196:199], v[132:135], v[112:127]
    v_mfma_f32_32x32x16_bf16 v[64:79], v[192:195], v[128:131], v[64:79]
    s_cmp_eq_u32 s46, 0
    s_cbranch_scc1 L_g_fin
L_g_nm0:
    s_bitcmp1_b32 s52, 1
    s_cbranch_scc0 L_g_nm1
    v_max3_u32 v40, v136, v137, v138
    v_max3_u32 v41, v139, v140, v141
    v_max3_u32 v40, v40, v142, v143
    v_max_u32 v40, v40, v41
    v_cmp_eq_u32 s[6:7], -1, v40
    s_cmp_eq_u32 s3, 0
    s_cbranch_scc1 L_g_go1
    s_nop 0
    s_cmp_lg_u64 s[6:7], 0
    s_cbranch_scc1 L_g_nm1
L_g_go1:
    s_bitset0_b32 s46, 1
    v_mfma_f32_32x32x16_bf16 v[80:95], v[200:203], v[140:143], v[80:95]
    v_mfma_f32_32x32x16_bf16 v[96:111], v[204:207], v[136:139], v[96:111]
    v_mfma_f32_32x32x16_bf16 v[112:127], v[204:207], v[140:143], v[112:127]
    v_mfma_f32_32x32x16_bf16 v[64:79], v[200:203], v[136:139], v[64:79]
    s_cmp_eq_u32 s46, 0
    s_cbranch_scc1 L_g_fin
L_g_nm1:
    s_and_b32 s37, s52, 12
    s_cbranch_scc0 L_g_nm3
    s_bitcmp1_b32 s52, 2
    s_cbranch_scc0 L_g_nm2
    v_max3_u32 v40, v144, v145, v146
    v_max3_u32 v41, v147, v148, v149
    v_max3_u32 v40, v40, v150, v151
    v_max_u32 v40, v40, v41
    v_cmp_eq_u32 s[6:7], -1, v40
    s_cmp_eq_u32 s3, 0
    s_cbranch_scc1 L_g_go2
    s_nop 0
    s_cmp_lg_u64 s[6:7], 0
    s_cbranch_scc1 L_g_nm2
L_g_go2:
    s_bitset0_b32 s46, 2
    v_mfma_f32_32x32x16_bf16 v[80:95], v[208:211], v[148:151], v[80:95]
    v_mfma_f32_32x32x16_bf16 v[96:111], v[212:215], v[144:147], v[96:111]
    v_mfma_f32_32x32x16_bf16 v[112:127], v[212:215], v[148:151], v[112:127]
    v_mfma_f32_32x32x16_bf16 v[64:79], v[208:211], v[144:147], v[64:79]
    s_cmp_eq_u32 s46, 0
    s_cbranch_scc1 L_g_fin
L_g_nm2:
    s_bitcmp1_b32 s52, 3
    s_cbranch_scc0 L_g_nm3
    v_max3_u32 v40, v152, v153, v154
    v_max3_u32 v41, v155, v156, v157
    v_max3_u32 v40, v40, v158, v159
    v_max_u32 v40, v40, v41
    v_cmp_eq_u32 s[6:7], -1, v40
    s_cmp_eq_u32 s3, 0
    s_cbranch_scc1 L_g_go3
    s_nop 0
    s_cmp_lg_u64 s[6:7], 0
    s_cbranch_scc1 L_g_nm3
L_g_go3:
    s_bitset0_b32 s46, 3
    v_mfma_f32_32x32x16_bf16 v[80:95], v[216:219], v[156:159], v[80:95]
    v_mfma_f32_32x32x16_bf16 v[96:111], v[220:223], v[152:155], v[96:111]
    v_mfma_f32_32x32x16_bf16 v[112:127], v[220:223], v[156:159], v[112:127]
    v_mfma_f32_32x32x16_bf16 v[64:79], v[216:219], v[152:155], v[64:79]
    s_cmp_eq_u32 s46, 0
    s_cbranch_scc1 L_g_fin
L_g_nm3:
    s_and_b32 s37, s52, 240
    s_cbranch_scc0 L_g_nm7
    s_and_b32 s37, s52, 48
    s_cbranch_scc0 L_g_nm5
    s_bitcmp1_b32 s52, 4
    s_cbranch_scc0 L_g_nm4
    v_max3_u32 v40, v160, v161, v162
    v_max3_u32 v41, v163, v164, v165
    v_max3_u32 v40, v40, v166, v167
    v_max_u32 v40, v40, v41
    v_cmp_eq_u32 s[6:7], -1, v40
    s_cmp_eq_u32 s3, 0
    s_cbranch_scc1 L_g_go4
    s_nop 0
    s_cmp_lg_u64 s[6:7], 0
    s_cbranch_scc1 L_g_nm4
L_g_go4:
    s_bitset0_b32 s46, 4
    v_mfma_f32_32x32x16_bf16 v[80:95], v[224:227], v[164:167], v[80:95]
    v_mfma_f32_32x32x16_bf16 v[96:111], v[228:231], v[160:163], v[96:111]
    v_mfma_f32_32x32x16_bf16 v[112:127], v[228:231], v[164:167], v[112:127]
    v_mfma_f32_32x32x16_bf16 v[64:79], v[224:227], v[160:163], v[64:79]
    s_cmp_eq_u32 s46, 0
    s_cbranch_scc1 L_g_fin
L_g_nm4:
    s_bitcmp1_b32 s52, 5
    s_cbranch_scc0 L_g_nm5
    v_max3_u32 v40, v168, v169, v170
    v_max3_u32 v41, v171, v172, v173
    v_max3_u32 v40, v40, v174, v175
    v_max_u32 v40, v40, v41
    v_cmp_eq_u32 s[6:7], -1, v40
    s_cmp_eq_u32 s3, 0
    s_cbranch_scc1 L_g_go5
    s_nop 0
    s_cmp_lg_u64 s[6:7], 0
    s_cbranch_scc1 L_g_nm5
L_g_go5:
    s_bitset0_b32 s46, 5
    v_mfma_f32_32x32x16_bf16 v[80:95], v[232:235], v[172:175], v[80:95]
    v_mfma_f32_32x32x16_bf16 v[96:111], v[236:239], v[168:171], v[96:111]
    v_mfma_f32_32x32x16_bf16 v[112:127], v[236:239], v[172:175], v[112:127]
    v_mfma_f32_32x32x16_bf16 v[64:79], v[232:235], v[168:171], v[64:79]
    s_cmp_eq_u32 s46, 0
    s_cbranch_scc1 L_g_fin
L_g_nm5:
    s_and_b32 s37, s52, 192
    s_cbranch_scc0 L_g_nm7
    s_bitcmp1_b32 s52, 6
    s_cbranch_scc0 L_g_nm6
    v_max3_u32 v40, v176, v177, v178
    v_max3_u32 v41, v179, v180, v181
    v_max3_u32 v40, v40, v182, v183
    v_max_u32 v40, v40, v41
    v_cmp_eq_u32 s[6:7], -1, v40
    s_cmp_eq_u32 s3, 0
    s_cbranch_scc1 L_g_go6
    s_nop 0
    s_cmp_lg_u64 s[6:7], 0
    s_cbranch_scc1 L_g_nm6
L_g_go6:
    s_bitset0_b32 s46, 6
    v_mfma_f32_32x32x16_bf16 v[80:95], v[240:243], v[180:183], v[80:95]
    v_mfma_f32_32x32x16_bf16 v[96:111], v[244:247], v[176:179], v[96:111]
    v_mfma_f32_32x32x16_bf16 v[112:127], v[244:247], v[180:183], v[112:127]
    v_mfma_f32_32x32x16_bf16 v[64:79], v[240:243], v[176:179], v[64:79]
    s_cmp_eq_u32 s46, 0
    s_cbranch_scc1 L_g_fin
L_g_nm6:
    s_bitcmp1_b32 s52, 7
    s_cbranch_scc0 L_g_nm7
    v_max3_u32 v40, v184, v185, v186
    v_max3_u32 v41, v187, v188, v189
    v_max3_u32 v40, v40, v190, v191
    v_max_u32 v40, v40, v41
    v_cmp_eq_u32 s[6:7], -1, v40
    s_cmp_eq_u32 s3, 0
    s_cbranch_scc1 L_g_go7
    s_nop 0
    s_cmp_lg_u64 s[6:7], 0
    s_cbranch_scc1 L_g_nm7
L_g_go7:
    s_bitset0_b32 s46, 7
    v_mfma_f32_32x32x16_bf16 v[80:95], v[248:251], v[188:191], v[80:95]
    v_mfma_f32_32x32x16_bf16 v[96:111], v[252:255], v[184:187], v[96:111]
    v_mfma_f32_32x32x16_bf16 v[112:127], v[252:255], v[188:191], v[112:127]
    v_mfma_f32_32x32x16_bf16 v[64:79], v[248:251], v[184:187], v[64:79]
    s_cmp_eq_u32 s46, 0
    s_cbranch_scc1 L_g_fin
L_g_nm7:
L_g_next:
    s_sub_u32 s3, s3, 1
    s_cbranch_scc0 L_g_round
    s_mov_b32 s3, 0
    s_branch L_g_round
L_g_fin:
    s_nop 6
    ds_write_b128 v36, v[80:83] offset:0
    ds_write_b128 v36, v[84:87] offset:1024
    ds_write_b128 v36, v[88:91] offset:2048
    ds_write_b128 v36, v[92:95] offset:3072
    ds_write_b128 v36, v[96:99] offset:4096
    ds_write_b128 v36, v[100:103] offset:5120
    ds_write_b128 v36, v[104:107] offset:6144
    ds_write_b128 v36, v[108:111] offset:7168
    ds_write_b128 v36, v[112:115] offset:8192
    ds_write_b128 v36, v[116:119] offset:9216
    ds_write_b128 v36, v[120:123] offset:10240
    ds_write_b128 v36, v[124:127] offset:11264
    s_waitcnt lgkmcnt(0)
    s_barrier
    ds_read_b128 v[80:83], v37 offset:0
    ds_read_b128 v[84:87], v37 offset:1024
    ds_read_b128 v[88:91], v37 offset:2048
    ds_read_b128 v[92:95], v37 offset:3072
    ds_read_b128 v[96:99], v38 offset:4096
    ds_read_b128 v[100:103], v38 offset:5120
    ds_read_b128 v[104:107], v38 offset:6144
    ds_read_b128 v[108:111], v38 offset:7168
    ds_read_b128 v[112:115], v39 offset:8192
    ds_read_b128 v[116:119], v39 offset:9216
    ds_read_b128 v[120:123], v39 offset:10240
    ds_read_b128 v[124:127], v39 offset:11264
    s_waitcnt lgkmcnt(8)
    v_pk_add_f32 v[64:65], v[64:65], v[80:81]
    v_pk_add_f32 v[66:67], v[66:67], v[82:83]
    v_pk_add_f32 v[68:69], v[68:69], v[84:85]
    v_pk_add_f32 v[70:71], v[70:71], v[86:87]
    v_pk_add_f32 v[72:73], v[72:73], v[88:89]
    v_pk_add_f32 v[74:75], v[74:75], v[90:91]
    v_pk_add_f32 v[76:77], v[76:77], v[92:93]
    v_pk_add_f32 v[78:79], v[78:79], v[94:95]
    s_waitcnt lgkmcnt(4)
    v_pk_add_f32 v[64:65], v[64:65], v[96:97]
    v_pk_add_f32 v[66:67], v[66:67], v[98:99]
    v_pk_add_f32 v[68:69], v[68:69], v[100:101]
    v_pk_add_f32 v[70:71], v[70:71], v[102:103]
    v_pk_add_f32 v[72:73], v[72:73], v[104:105]
    v_pk_add_f32 v[74:75], v[74:75], v[106:107]
    v_pk_add_f32 v[76:77], v[76:77], v[108:109]
    v_pk_add_f32 v[78:79], v[78:79], v[110:111]
    s_waitcnt lgkmcnt(0)
    v_pk_add_f32 v[64:65], v[64:65], v[112:113]
    v_pk_add_f32 v[66:67], v[66:67], v[114:115]
    v_pk_add_f32 v[68:69], v[68:69], v[116:117]
    v_pk_add_f32 v[70:71], v[70:71], v[118:119]
    v_pk_add_f32 v[72:73], v[72:73], v[120:121]
    v_pk_add_f32 v[74:75], v[74:75], v[122:123]
    v_pk_add_f32 v[76:77], v[76:77], v[124:125]
    v_pk_add_f32 v[78:79], v[78:79], v[126:127]
    v_cvt_pk_bf16_f32 v28, v64, v65
    v_cvt_pk_bf16_f32 v29, v66, v67
    v_cvt_pk_bf16_f32 v30, v68, v69
    v_cvt_pk_bf16_f32 v31, v70, v71
    v_cvt_pk_bf16_f32 v32, v72, v73
    v_cvt_pk_bf16_f32 v33, v74, v75
    v_cvt_pk_bf16_f32 v34, v76, v77
    v_cvt_pk_bf16_f32 v35, v78, v79
    s_nop 1
    v_permlane32_swap_b32 v28, v30
    v_permlane32_swap_b32 v29, v31
    v_permlane32_swap_b32 v32, v34
    v_permlane32_swap_b32 v33, v35
    buffer_store_dwordx4 v[28:31], v16, s[24:27], 0 offen sc0 nt
    buffer_store_dwordx4 v[32:35], v16, s[24:27], 0 offen offset:32 sc0 nt
    s_endpgm
L_attn:
    s_waitcnt lgkmcnt(0)
    s_mov_b32 s28, s78
    s_mov_b32 s29, s79
    s_mov_b32 s30, 268435456
    s_mov_b32 s31, 0x20000
    s_mov_b32 s4, s76
    s_mov_b32 s5, s77
    s_sub_u32 s2, s2, 256
    s_or_b32 s36, s2, s32
    s_cmp_lg_u32 s36, 0
    s_cbranch_scc1 L_a_nopub
    s_memrealtime s[6:7]
    s_getreg_b32 s8, hwreg(HW_REG_XCC_ID)
    s_xor_b32 s8, s8, 0
    s_and_b32 s8, s8, 1
    s_lshl_b32 s8, s8, 1
    s_or_b32 s8, s8, 1
    s_waitcnt lgkmcnt(0)
    s_lshl_b32 s6, s6, 2
    s_or_b32 s6, s6, s8
    v_mov_b32 v8, 0
    v_mov_b32 v9, s6
    s_mov_b64 exec, 1
    global_store_dword v8, v9, s[4:5] sc1
    s_mov_b64 exec, -1
L_a_nopub:
    v_lshlrev_b32 v2, 4, v1
    s_and_b32 s34, s2, 7
    s_lshl_b32 s34, s34, 2
    s_lshr_b32 s36, s2, 3
    s_and_b32 s36, s36, 3
    s_add_u32 s34, s34, s36
    s_lshr_b32 s35, s2, 5
    s_lshl_b32 s38, s34, 17
    s_lshl_b32 s43, s32, 12
    s_add_u32 s38, s38, s43
    s_add_u32 s38, s38, 2097152
    v_and_b32 v11, 3, v0
    v_cmp_eq_u32 s[6:7], 0, v11
    v_mov_b32 v12, 0x3f803f80
    s_nop 0
    v_cndmask_b32 v12, 0, v12, s[6:7]
    v_mov_b32 v13, v12
    v_mov_b32 v14, v12
    v_mov_b32 v15, v12
    v_lshlrev_b32 v11, 4, v0
    v_add_u32 v11, 65536, v11
    ds_write_b128 v11, v[12:15]
    ds_write_b128 v11, v[12:15] offset:4096
    v_mov_b32 v3, v2
    v_lshrrev_b32 v48, 5, v1
    v_and_b32 v49, 15, v1
    v_lshlrev_b32 v49, 4, v49
    v_lshl_add_u32 v48, v48, 8, v49
    v_add_u32 v49, 4, v1
    v_and_b32 v49, 8, v49
    v_lshlrev_b32 v49, 3, v49
    v_add_u32 v49, 65536, v49
    v_and_b32 v50, 11, v1
    v_min_u32 v50, 1, v50
    v_lshl_add_u32 v49, v50, 4, v49
    v_and_b32 v50, 16, v1
    v_cmp_eq_u32 s[6:7], 0, v50
    v_mov_b32 v50, -1
    v_mov_b32 v6, 0xdddddddd
    v_cndmask_b32 v7, v49, v48, s[6:7]
    v_cndmask_b32 v5, 0, v50, s[6:7]
    v_mov_b32 v4, v7
    v_mov_b32 v48, 0
    v_mov_b32 v49, 0
    v_mov_b32 v50, 0
    v_mov_b32 v51, 0
    v_mov_b32 v52, 0
    v_mov_b32 v53, 0
    v_mov_b32 v54, 0
    v_mov_b32 v55, 0
    v_mov_b32 v56, 0
    v_mov_b32 v57, 0
    v_mov_b32 v58, 0
    v_mov_b32 v59, 0
    v_mov_b32 v60, 0
    v_mov_b32 v61, 0
    v_mov_b32 v62, 0
    v_mov_b32 v63, 0
    v_mov_b32 v64, 0
    v_mov_b32 v65, 0
    v_mov_b32 v66, 0
    v_mov_b32 v67, 0
    v_mov_b32 v68, 0
    v_mov_b32 v69, 0
    v_mov_b32 v70, 0
    v_mov_b32 v71, 0
    v_mov_b32 v72, 0
    v_mov_b32 v73, 0
    v_mov_b32 v74, 0
    v_mov_b32 v75, 0
    v_mov_b32 v76, 0
    v_mov_b32 v77, 0
    v_mov_b32 v78, 0
    v_mov_b32 v79, 0
    v_mov_b32 v136, 0
    v_mov_b32 v137, 0
    v_mov_b32 v138, 0
    v_mov_b32 v139, 0
    v_mov_b32 v140, 0
    v_mov_b32 v141, 0
    v_mov_b32 v142, 0
    v_mov_b32 v143, 0
    s_lshl_b32 s36, s35, 2
    s_add_u32 s44, s36, s32
    s_mul_i32 s48, s44, 294912
    s_lshl_b32 s37, s34, 10
    s_add_u32 s48, s48, s37
    s_add_u32 s48, s48, 6291456
    s_add_u32 s49, s48, 147456
    s_lshl_b32 s44, s44, 12
    s_lshl_b32 s46, s34, 7
    s_add_u32 s44, s44, s46
    s_add_u32 s50, s44, 17170432
    v_mov_b32 v36, -1
    v_mov_b32 v37, -1
    v_mov_b32 v38, -1
    v_mov_b32 v39, -1
    s_waitcnt vmcnt(0)
    s_sleep 48
    v_mov_b32 v8, 0
L_a_nonce:
    global_load_dword v9, v8, s[4:5] sc1
    s_waitcnt vmcnt(0)
    v_readfirstlane_b32 s33, v9
    s_nop 3
    s_cmp_lg_u32 s33, 0
    s_cbranch_scc1 L_a_nonce_done
    s_sleep 2
    s_sub_u32 s3, s3, 1
    s_cbranch_scc0 L_a_nonce
    s_mov_b32 s3, 0
L_a_nonce_done:
    s_sleep 70
    s_lshr_b32 s36, s34, 1
    s_lshr_b32 s37, s34, 2
    s_add_u32 s44, s37, 8
    v_mov_b32 v9, s36
    v_mov_b32 v10, s44
    v_and_b32 v11, 2, v1
    v_cmp_eq_u32 s[6:7], 0, v11
    v_lshrrev_b32 v11, 2, v1
    v_mov_b32 v12, s35
    v_cndmask_b32 v9, v9, v10, s[6:7]
    v_cmp_gt_u32 s[6:7], 32, v1
    v_mov_b32 v10, s37
    s_lshl_b32 s44, s32, 1
    v_cndmask_b32 v9, v10, v9, s[6:7]
    v_cndmask_b32 v11, v12, v11, s[6:7]
    v_and_b32 v10, 1, v1
    v_lshl_add_u32 v11, v9, 3, v11
    v_lshl_add_u32 v11, v11, 3, v10
    v_add_u32 v11, s44, v11
    v_lshlrev_b32 v11, 7, v11
    v_add_u32 v8, 16777216, v11
    s_lshl_b32 s36, s34, 16
    s_lshl_b32 s44, s35, 13
    s_add_u32 s36, s36, s44
    s_lshl_b32 s44, s32, 11
    s_add_u32 s45, s36, s44
    s_mov_b32 s42, 0
    s_lshl_b32 s51, s2, 7
    s_add_u32 s51, s51, 17301504
    s_mov_b32 exec_lo, 15
    s_mov_b32 exec_hi, 3
L_a_poll1:
    buffer_load_dword v9, v8, s[28:31], 0 offen sc1
    s_waitcnt vmcnt(0)
    v_xor_b32 v9, s33, v9
    v_cmp_ne_u32 s[6:7], 0, v9
    s_nop 3
    s_cmp_eq_u64 s[6:7], 0
    s_cbranch_scc1 L_a_poll1_done
    s_sleep 4
    s_sub_u32 s3, s3, 1
    s_cbranch_scc0 L_a_poll1
    s_mov_b32 s3, 0
L_a_poll1_done:
    s_mov_b64 exec, -1
    s_setprio 2
    s_lshl_b32 s36, s42, 14
    s_add_u32 s37, s36, s38
    s_and_b32 s36, s36, 0xffff
    s_add_u32 m0, s36, s43
    s_add_u32 s42, s42, 1
    buffer_load_dwordx4 v2, s[28:31], s37 offen offset:0 sc1 lds
    buffer_load_dwordx4 v2, s[28:31], s37 offen offset:1024 sc1 lds
    buffer_load_dwordx4 v2, s[28:31], s37 offen offset:2048 sc1 lds
    buffer_load_dwordx4 v2, s[28:31], s37 offen offset:3072 sc1 lds
    buffer_load_dwordx4 v[16:19], v2, s[28:31], s45 offen offset:0 sc1
    buffer_load_dwordx4 v[20:23], v2, s[28:31], s45 offen offset:1024 sc1
    s_mov_b32 s40, 0
    v_mov_b32 v40, s33
    v_mov_b32 v41, 0
    s_waitcnt vmcnt(0) lgkmcnt(0)
    s_barrier
    buffer_load_dword v9, v8, s[28:31], 0 offen sc1
    ds_read_b128 v[24:27], v3 offset:0
    ds_read_b128 v[44:47], v3 offset:2048
    ds_read_b128 v[28:31], v4 offset:1024
    ds_read_b128 v[32:35], v4 offset:1536
    s_waitcnt lgkmcnt(3)
    v_mfma_f32_32x32x16_bf16 v[80:95], v[24:27], v[16:19], 0
    v_mfma_f32_32x32x16_bf16 v[112:127], v[24:27], v[20:23], 0
    s_nop 7
    s_nop 3
    s_waitcnt lgkmcnt(0)
.p2align 6
    v_mfma_f32_32x32x16_bf16 v[96:111], v[44:47], v[16:19], 0
    v_exp_f32 v80, v80
    v_exp_f32 v81, v81
    v_exp_f32 v82, v82
    v_exp_f32 v83, v83
    v_exp_f32 v84, v84
    v_exp_f32 v85, v85
    v_smfmac_f32_32x32x32_bf16 v[64:79], v[32:35], v[136:143], v6
    s_waitcnt lgkmcnt(0)
    ds_read_b128 v[32:35], v4 offset:1536
    v_exp_f32 v86, v86
    v_exp_f32 v87, v87
    v_exp_f32 v88, v88
    v_exp_f32 v89, v89
    v_exp_f32 v90, v90
    v_smfmac_f32_32x32x32_bf16 v[48:63], v[28:31], v[80:87], v6
    ds_read_b128 v[24:27], v3 offset:4096
    v_exp_f32 v91, v91
    v_exp_f32 v92, v92
    v_exp_f32 v93, v93
    v_exp_f32 v94, v94
    v_exp_f32 v95, v95
    v_mfma_f32_32x32x16_bf16 v[128:143], v[44:47], v[20:23], 0
    s_waitcnt lgkmcnt(1)
    v_exp_f32 v112, v112
    v_exp_f32 v113, v113
    v_exp_f32 v114, v114
    v_exp_f32 v115, v115
    v_exp_f32 v116, v116
    v_exp_f32 v117, v117
    v_smfmac_f32_32x32x32_bf16 v[48:63], v[32:35], v[88:95], v6
    v_exp_f32 v118, v118
    v_exp_f32 v119, v119
    v_exp_f32 v120, v120
    v_exp_f32 v121, v121
    v_exp_f32 v122, v122
    v_smfmac_f32_32x32x32_bf16 v[64:79], v[28:31], v[112:119], v6
    s_waitcnt lgkmcnt(0)
    ds_read_b128 v[28:31], v4 offset:3072
    v_exp_f32 v123, v123
    v_exp_f32 v124, v124
    v_exp_f32 v125, v125
    v_exp_f32 v126, v126
    v_exp_f32 v127, v127
    v_mfma_f32_32x32x16_bf16 v[80:95], v[24:27], v[16:19], 0
    s_add_u32 s40, s40, 8192
    v_exp_f32 v96, v96
    v_exp_f32 v97, v97
    v_exp_f32 v98, v98
    v_exp_f32 v99, v99
    v_exp_f32 v100, v100
    v_exp_f32 v101, v101
    v_smfmac_f32_32x32x32_bf16 v[64:79], v[32:35], v[120:127], v6
    s_waitcnt lgkmcnt(0)
    ds_read_b128 v[32:35], v4 offset:3584
    v_exp_f32 v102, v102
    v_exp_f32 v103, v103
    v_exp_f32 v104, v104
    v_exp_f32 v105, v105
    v_exp_f32 v106, v106
    v_smfmac_f32_32x32x32_bf16 v[48:63], v[28:31], v[96:103], v6
    s_and_b32 s40, s40, 0xffff
    ds_read_b128 v[44:47], v3 offset:6144
    v_exp_f32 v107, v107
    v_exp_f32 v108, v108
    v_exp_f32 v109, v109
    v_exp_f32 v110, v110
    v_exp_f32 v111, v111
    v_mfma_f32_32x32x16_bf16 v[112:127], v[24:27], v[20:23], 0
    s_waitcnt lgkmcnt(1)
    v_exp_f32 v128, v128
    v_exp_f32 v129, v129
    v_exp_f32 v130, v130
    v_exp_f32 v131, v131
    v_exp_f32 v132, v132
    v_exp_f32 v133, v133
    v_smfmac_f32_32x32x32_bf16 v[48:63], v[32:35], v[104:111], v6
    v_or_b32 v3, s40, v2
    v_exp_f32 v134, v134
    v_exp_f32 v135, v135
    v_exp_f32 v136, v136
    v_exp_f32 v137, v137
    v_exp_f32 v138, v138
    v_smfmac_f32_32x32x32_bf16 v[64:79], v[28:31], v[128:135], v6
    s_waitcnt lgkmcnt(0)
    ds_read_b128 v[28:31], v4 offset:5120
    v_exp_f32 v139, v139
    v_exp_f32 v140, v140
    v_exp_f32 v141, v141
    v_exp_f32 v142, v142
    v_exp_f32 v143, v143
    v_mfma_f32_32x32x16_bf16 v[96:111], v[44:47], v[16:19], 0
    v_exp_f32 v80, v80
    v_exp_f32 v81, v81
    v_exp_f32 v82, v82
    v_exp_f32 v83, v83
    v_exp_f32 v84, v84
    v_exp_f32 v85, v85
    v_smfmac_f32_32x32x32_bf16 v[64:79], v[32:35], v[136:143], v6
    s_waitcnt lgkmcnt(0)
    ds_read_b128 v[32:35], v4 offset:5632
    v_exp_f32 v86, v86
    v_exp_f32 v87, v87
    v_exp_f32 v88, v88
    v_exp_f32 v89, v89
    v_exp_f32 v90, v90
    v_smfmac_f32_32x32x32_bf16 v[48:63], v[28:31], v[80:87], v6
    ds_read_b128 v[24:27], v3 offset:0
    v_exp_f32 v91, v91
    v_exp_f32 v92, v92
    v_exp_f32 v93, v93
    v_exp_f32 v94, v94
    v_exp_f32 v95, v95
    v_mfma_f32_32x32x16_bf16 v[128:143], v[44:47], v[20:23], 0
    s_waitcnt lgkmcnt(1)
    v_exp_f32 v112, v112
    v_exp_f32 v113, v113
    v_exp_f32 v114, v114
    v_exp_f32 v115, v115
    v_exp_f32 v116, v116
    v_exp_f32 v117, v117
    v_smfmac_f32_32x32x32_bf16 v[48:63], v[32:35], v[88:95], v6
    s_waitcnt vmcnt(0)
    v_cmp_ne_u32 s[6:7], s33, v9
    s_nop 3
    s_cmp_lg_u64 s[6:7], 0
    s_cbranch_scc1 L_a_poll
L_a_poll_done:
    s_add_u32 s37, s37, 16384
    s_add_u32 m0, m0, 16384
    s_and_b32 m0, m0, 0xffff
    s_nop 0
    buffer_load_dwordx4 v2, s[28:31], s37 offen offset:0 sc1 lds
    buffer_load_dwordx4 v2, s[28:31], s37 offen offset:1024 sc1 lds
    buffer_load_dwordx4 v2, s[28:31], s37 offen offset:2048 sc1 lds
    buffer_load_dwordx4 v2, s[28:31], s37 offen offset:3072 sc1 lds
    v_exp_f32 v118, v118
    v_exp_f32 v119, v119
    v_exp_f32 v120, v120
    v_exp_f32 v121, v121
    v_exp_f32 v122, v122
    v_smfmac_f32_32x32x32_bf16 v[64:79], v[28:31], v[112:119], v6
    s_waitcnt lgkmcnt(0)
    ds_read_b128 v[28:31], v4 offset:7168
    v_exp_f32 v123, v123
    v_exp_f32 v124, v124
    v_exp_f32 v125, v125
    v_exp_f32 v126, v126
    v_exp_f32 v127, v127
    v_mfma_f32_32x32x16_bf16 v[80:95], v[24:27], v[16:19], 0
    v_exp_f32 v96, v96
    v_exp_f32 v97, v97
    v_exp_f32 v98, v98
    v_exp_f32 v99, v99
    v_exp_f32 v100, v100
    v_exp_f32 v101, v101
    v_smfmac_f32_32x32x32_bf16 v[64:79], v[32:35], v[120:127], v6
    s_waitcnt lgkmcnt(0)
    ds_read_b128 v[32:35], v4 offset:7680
    v_exp_f32 v102, v102
    v_exp_f32 v103, v103
    v_exp_f32 v104, v104
    v_exp_f32 v105, v105
    v_exp_f32 v106, v106
    v_smfmac_f32_32x32x32_bf16 v[48:63], v[28:31], v[96:103], v6
    ds_read_b128 v[44:47], v3 offset:2048
    v_exp_f32 v107, v107
    v_exp_f32 v108, v108
    v_exp_f32 v109, v109
    v_exp_f32 v110, v110
    v_exp_f32 v111, v111
    v_mfma_f32_32x32x16_bf16 v[112:127], v[24:27], v[20:23], 0
    s_waitcnt lgkmcnt(1)
    v_exp_f32 v128, v128
    v_exp_f32 v129, v129
    v_exp_f32 v130, v130
    v_exp_f32 v131, v131
    v_exp_f32 v132, v132
    v_exp_f32 v133, v133
    v_smfmac_f32_32x32x32_bf16 v[48:63], v[32:35], v[104:111], v6
    v_and_or_b32 v4, s40, v5, v7
    v_exp_f32 v134, v134
    v_exp_f32 v135, v135
    v_exp_f32 v136, v136
    v_exp_f32 v137, v137
    v_exp_f32 v138, v138
    v_smfmac_f32_32x32x32_bf16 v[64:79], v[28:31], v[128:135], v6
    s_waitcnt lgkmcnt(0)
    ds_read_b128 v[28:31], v4 offset:1024
    v_exp_f32 v139, v139
    v_exp_f32 v140, v140
    v_exp_f32 v141, v141
    v_exp_f32 v142, v142
    v_exp_f32 v143, v143
    v_mfma_f32_32x32x16_bf16 v[96:111], v[44:47], v[16:19], 0
    s_add_u32 s37, s37, 16384
    v_exp_f32 v80, v80
    v_exp_f32 v81, v81
    v_exp_f32 v82, v82
    v_exp_f32 v83, v83
    v_exp_f32 v84, v84
    v_exp_f32 v85, v85
    v_smfmac_f32_32x32x32_bf16 v[64:79], v[32:35], v[136:143], v6
    s_waitcnt lgkmcnt(0)
    ds_read_b128 v[32:35], v4 offset:1536
    v_exp_f32 v86, v86
    v_exp_f32 v87, v87
    v_exp_f32 v88, v88
    v_exp_f32 v89, v89
    v_exp_f32 v90, v90
    v_smfmac_f32_32x32x32_bf16 v[48:63], v[28:31], v[80:87], v6
    s_add_u32 m0, m0, 16384
    s_and_b32 m0, m0, 0xffff
    ds_read_b128 v[24:27], v3 offset:4096
    v_exp_f32 v91, v91
    v_exp_f32 v92, v92
    v_exp_f32 v93, v93
    v_exp_f32 v94, v94
    v_exp_f32 v95, v95
    v_mfma_f32_32x32x16_bf16 v[128:143], v[44:47], v[20:23], 0
    s_waitcnt lgkmcnt(1)
    v_exp_f32 v112, v112
    v_exp_f32 v113, v113
    v_exp_f32 v114, v114
    v_exp_f32 v115, v115
    v_exp_f32 v116, v116
    v_exp_f32 v117, v117
    v_smfmac_f32_32x32x32_bf16 v[48:63], v[32:35], v[88:95], v6
    buffer_load_dwordx4 v2, s[28:31], s37 offen offset:0 sc1 lds
    buffer_load_dwordx4 v2, s[28:31], s37 offen offset:1024 sc1 lds
    buffer_load_dwordx4 v2, s[28:31], s37 offen offset:2048 sc1 lds
    buffer_load_dwordx4 v2, s[28:31], s37 offen offset:3072 sc1 lds
    buffer_store_dwordx4 v[36:39], v2, s[28:31], s48 offen sc1
    buffer_store_dwordx4 v[36:39], v2, s[28:31], s49 offen sc1
    v_exp_f32 v118, v118
    v_exp_f32 v119, v119
    v_exp_f32 v120, v120
    v_exp_f32 v121, v121
    v_exp_f32 v122, v122
    v_smfmac_f32_32x32x32_bf16 v[64:79], v[28:31], v[112:119], v6
    s_waitcnt lgkmcnt(0)
    ds_read_b128 v[28:31], v4 offset:3072
    v_exp_f32 v123, v123
    v_exp_f32 v124, v124
    v_exp_f32 v125, v125
    v_exp_f32 v126, v126
    v_exp_f32 v127, v127
    v_mfma_f32_32x32x16_bf16 v[80:95], v[24:27], v[16:19], 0
    s_add_u32 s40, s40, 8192
    v_exp_f32 v96, v96
    v_exp_f32 v97, v97
    v_exp_f32 v98, v98
    v_exp_f32 v99, v99
    v_exp_f32 v100, v100
    v_exp_f32 v101, v101
    v_smfmac_f32_32x32x32_bf16 v[64:79], v[32:35], v[120:127], v6
    s_waitcnt lgkmcnt(0)
    ds_read_b128 v[32:35], v4 offset:3584
    v_exp_f32 v102, v102
    v_exp_f32 v103, v103
    v_exp_f32 v104, v104
    v_exp_f32 v105, v105
    v_exp_f32 v106, v106
    v_smfmac_f32_32x32x32_bf16 v[48:63], v[28:31], v[96:103], v6
    s_and_b32 s40, s40, 0xffff
    ds_read_b128 v[44:47], v3 offset:6144
    v_exp_f32 v107, v107
    v_exp_f32 v108, v108
    v_exp_f32 v109, v109
    v_exp_f32 v110, v110
    v_exp_f32 v111, v111
    v_mfma_f32_32x32x16_bf16 v[112:127], v[24:27], v[20:23], 0
    s_waitcnt lgkmcnt(1)
    v_exp_f32 v128, v128
    v_exp_f32 v129, v129
    v_exp_f32 v130, v130
    v_exp_f32 v131, v131
    v_exp_f32 v132, v132
    v_exp_f32 v133, v133
    v_smfmac_f32_32x32x32_bf16 v[48:63], v[32:35], v[104:111], v6
    v_or_b32 v3, s40, v2
    v_exp_f32 v134, v134
    v_exp_f32 v135, v135
    v_exp_f32 v136, v136
    v_exp_f32 v137, v137
    v_exp_f32 v138, v138
    v_smfmac_f32_32x32x32_bf16 v[64:79], v[28:31], v[128:135], v6
    s_waitcnt lgkmcnt(0)
    ds_read_b128 v[28:31], v4 offset:5120
    v_exp_f32 v139, v139
    v_exp_f32 v140, v140
    v_exp_f32 v141, v141
    v_exp_f32 v142, v142
    v_exp_f32 v143, v143
    v_mfma_f32_32x32x16_bf16 v[96:111], v[44:47], v[16:19], 0
    s_add_u32 s37, s37, 16384
    v_exp_f32 v80, v80
    v_exp_f32 v81, v81
    v_exp_f32 v82, v82
    v_exp_f32 v83, v83
    v_exp_f32 v84, v84
    v_exp_f32 v85, v85
    v_smfmac_f32_32x32x32_bf16 v[64:79], v[32:35], v[136:143], v6
    s_waitcnt lgkmcnt(0)
    ds_read_b128 v[32:35], v4 offset:5632
    v_exp_f32 v86, v86
    v_exp_f32 v87, v87
    v_exp_f32 v88, v88
    v_exp_f32 v89, v89
    v_exp_f32 v90, v90
    v_smfmac_f32_32x32x32_bf16 v[48:63], v[28:31], v[80:87], v6
    s_waitcnt vmcnt(6)
    s_barrier
    ds_read_b128 v[24:27], v3 offset:0
    v_exp_f32 v91, v91
    v_exp_f32 v92, v92
    v_exp_f32 v93, v93
    v_exp_f32 v94, v94
    v_exp_f32 v95, v95
    v_mfma_f32_32x32x16_bf16 v[128:143], v[44:47], v[20:23], 0
    s_waitcnt lgkmcnt(1)
    v_exp_f32 v112, v112
    v_exp_f32 v113, v113
    v_exp_f32 v114, v114
    v_exp_f32 v115, v115
    v_exp_f32 v116, v116
    v_exp_f32 v117, v117
    v_smfmac_f32_32x32x32_bf16 v[48:63], v[32:35], v[88:95], v6
    s_add_u32 m0, m0, 16384
    s_and_b32 m0, m0, 0xffff
    s_nop 0
    buffer_load_dwordx4 v2, s[28:31], s37 offen offset:0 sc1 lds
    buffer_load_dwordx4 v2, s[28:31], s37 offen offset:1024 sc1 lds
    buffer_load_dwordx4 v2, s[28:31], s37 offen offset:2048 sc1 lds
    buffer_load_dwordx4 v2, s[28:31], s37 offen offset:3072 sc1 lds
    v_exp_f32 v118, v118
    v_exp_f32 v119, v119
    v_exp_f32 v120, v120
    v_exp_f32 v121, v121
    v_exp_f32 v122, v122
    v_smfmac_f32_32x32x32_bf16 v[64:79], v[28:31], v[112:119], v6
    s_waitcnt lgkmcnt(0)
    ds_read_b128 v[28:31], v4 offset:7168
    v_exp_f32 v123, v123
    v_exp_f32 v124, v124
    v_exp_f32 v125, v125
    v_exp_f32 v126, v126
    v_exp_f32 v127, v127
    v_mfma_f32_32x32x16_bf16 v[80:95], v[24:27], v[16:19], 0
    v_exp_f32 v96, v96
    v_exp_f32 v97, v97
    v_exp_f32 v98, v98
    v_exp_f32 v99, v99
    v_exp_f32 v100, v100
    v_exp_f32 v101, v101
    v_smfmac_f32_32x32x32_bf16 v[64:79], v[32:35], v[120:127], v6
    s_waitcnt lgkmcnt(0)
    ds_read_b128 v[32:35], v4 offset:7680
    v_exp_f32 v102, v102
    v_exp_f32 v103, v103
    v_exp_f32 v104, v104
    v_exp_f32 v105, v105
    v_exp_f32 v106, v106
    v_smfmac_f32_32x32x32_bf16 v[48:63], v[28:31], v[96:103], v6
    ds_read_b128 v[44:47], v3 offset:2048
    v_exp_f32 v107, v107
    v_exp_f32 v108, v108
    v_exp_f32 v109, v109
    v_exp_f32 v110, v110
    v_exp_f32 v111, v111
    v_mfma_f32_32x32x16_bf16 v[112:127], v[24:27], v[20:23], 0
    s_waitcnt lgkmcnt(1)
    v_exp_f32 v128, v128
    v_exp_f32 v129, v129
    v_exp_f32 v130, v130
    v_exp_f32 v131, v131
    v_exp_f32 v132, v132
    v_exp_f32 v133, v133
    v_smfmac_f32_32x32x32_bf16 v[48:63], v[32:35], v[104:111], v6
    v_and_or_b32 v4, s40, v5, v7
    v_exp_f32 v134, v134
    v_exp_f32 v135, v135
    v_exp_f32 v136, v136
    v_exp_f32 v137, v137
    v_exp_f32 v138, v138
    v_smfmac_f32_32x32x32_bf16 v[64:79], v[28:31], v[128:135], v6
    s_waitcnt lgkmcnt(0)
    ds_read_b128 v[28:31], v4 offset:1024
    v_exp_f32 v139, v139
    v_exp_f32 v140, v140
    v_exp_f32 v141, v141
    v_exp_f32 v142, v142
    v_exp_f32 v143, v143
    s_mov_b32 s39, 4
.p2align 6
L_a_loop:
    v_mfma_f32_32x32x16_bf16 v[96:111], v[44:47], v[16:19], 0
    v_exp_f32 v80, v80
    v_exp_f32 v81, v81
    v_exp_f32 v82, v82
    v_exp_f32 v83, v83
    v_exp_f32 v84, v84
    v_exp_f32 v85, v85
    v_smfmac_f32_32x32x32_bf16 v[64:79], v[32:35], v[136:143], v6
    s_waitcnt lgkmcnt(0)
    ds_read_b128 v[32:35], v4 offset:1536
    v_exp_f32 v86, v86
    v_exp_f32 v87, v87
    v_exp_f32 v88, v88
    v_exp_f32 v89, v89
    v_exp_f32 v90, v90
    v_smfmac_f32_32x32x32_bf16 v[48:63], v[28:31], v[80:87], v6
    s_waitcnt vmcnt(4)
    s_barrier
    ds_read_b128 v[24:27], v3 offset:4096
    v_exp_f32 v91, v91
    v_exp_f32 v92, v92
    v_exp_f32 v93, v93
    v_exp_f32 v94, v94
    v_exp_f32 v95, v95
    v_mfma_f32_32x32x16_bf16 v[128:143], v[44:47], v[20:23], 0
    s_waitcnt lgkmcnt(1)
    v_exp_f32 v112, v112
    v_exp_f32 v113, v113
    v_exp_f32 v114, v114
    v_exp_f32 v115, v115
    v_exp_f32 v116, v116
    v_exp_f32 v117, v117
    v_smfmac_f32_32x32x32_bf16 v[48:63], v[32:35], v[88:95], v6
    buffer_store_dword v40, v41, s[28:31], s50 offen sc1
    v_exp_f32 v118, v118
    v_exp_f32 v119, v119
    v_exp_f32 v120, v120
    v_exp_f32 v121, v121
    v_exp_f32 v122, v122
    v_smfmac_f32_32x32x32_bf16 v[64:79], v[28:31], v[112:119], v6
    s_waitcnt lgkmcnt(0)
    ds_read_b128 v[28:31], v4 offset:3072
    v_exp_f32 v123, v123
    v_exp_f32 v124, v124
    v_exp_f32 v125, v125
    v_exp_f32 v126, v126
    v_exp_f32 v127, v127
    v_mfma_f32_32x32x16_bf16 v[80:95], v[24:27], v[16:19], 0
    s_add_u32 s40, s40, 8192
    v_exp_f32 v96, v96
    v_exp_f32 v97, v97
    v_exp_f32 v98, v98
    v_exp_f32 v99, v99
    v_exp_f32 v100, v100
    v_exp_f32 v101, v101
    v_smfmac_f32_32x32x32_bf16 v[64:79], v[32:35], v[120:127], v6
    s_waitcnt lgkmcnt(0)
    ds_read_b128 v[32:35], v4 offset:3584
    v_exp_f32 v102, v102
    v_exp_f32 v103, v103
    v_exp_f32 v104, v104
    v_exp_f32 v105, v105
    v_exp_f32 v106, v106
    v_smfmac_f32_32x32x32_bf16 v[48:63], v[28:31], v[96:103], v6
    s_and_b32 s40, s40, 0xffff
    ds_read_b128 v[44:47], v3 offset:6144
    v_exp_f32 v107, v107
    v_exp_f32 v108, v108
    v_exp_f32 v109, v109
    v_exp_f32 v110, v110
    v_exp_f32 v111, v111
    v_mfma_f32_32x32x16_bf16 v[112:127], v[24:27], v[20:23], 0
    s_waitcnt lgkmcnt(1)
    v_exp_f32 v128, v128
    v_exp_f32 v129, v129
    v_exp_f32 v130, v130
    v_exp_f32 v131, v131
    v_exp_f32 v132, v132
    v_exp_f32 v133, v133
    v_smfmac_f32_32x32x32_bf16 v[48:63], v[32:35], v[104:111], v6
    v_or_b32 v3, s40, v2
    v_exp_f32 v134, v134
    v_exp_f32 v135, v135
    v_exp_f32 v136, v136
    v_exp_f32 v137, v137
    v_exp_f32 v138, v138
    v_smfmac_f32_32x32x32_bf16 v[64:79], v[28:31], v[128:135], v6
    s_waitcnt lgkmcnt(0)
    ds_read_b128 v[28:31], v4 offset:5120
    v_exp_f32 v139, v139
    v_exp_f32 v140, v140
    v_exp_f32 v141, v141
    v_exp_f32 v142, v142
    v_exp_f32 v143, v143
    v_mfma_f32_32x32x16_bf16 v[96:111], v[44:47], v[16:19], 0
    s_add_u32 s37, s37, 16384
    v_exp_f32 v80, v80
    v_exp_f32 v81, v81
    v_exp_f32 v82, v82
    v_exp_f32 v83, v83
    v_exp_f32 v84, v84
    v_exp_f32 v85, v85
    v_smfmac_f32_32x32x32_bf16 v[64:79], v[32:35], v[136:143], v6
    s_waitcnt lgkmcnt(0)
    ds_read_b128 v[32:35], v4 offset:5632
    v_exp_f32 v86, v86
    v_exp_f32 v87, v87
    v_exp_f32 v88, v88
    v_exp_f32 v89, v89
    v_exp_f32 v90, v90
    v_smfmac_f32_32x32x32_bf16 v[48:63], v[28:31], v[80:87], v6
    s_add_u32 m0, m0, 16384
    s_and_b32 m0, m0, 0xffff
    ds_read_b128 v[24:27], v3 offset:0
    v_exp_f32 v91, v91
    v_exp_f32 v92, v92
    v_exp_f32 v93, v93
    v_exp_f32 v94, v94
    v_exp_f32 v95, v95
    v_mfma_f32_32x32x16_bf16 v[128:143], v[44:47], v[20:23], 0
    s_waitcnt lgkmcnt(1)
    v_exp_f32 v112, v112
    v_exp_f32 v113, v113
    v_exp_f32 v114, v114
    v_exp_f32 v115, v115
    v_exp_f32 v116, v116
    v_exp_f32 v117, v117
    v_smfmac_f32_32x32x32_bf16 v[48:63], v[32:35], v[88:95], v6
    buffer_load_dwordx4 v2, s[28:31], s37 offen offset:0 sc1 lds
    v_exp_f32 v118, v118
    v_exp_f32 v119, v119
    v_exp_f32 v120, v120
    v_exp_f32 v121, v121
    v_exp_f32 v122, v122
    v_smfmac_f32_32x32x32_bf16 v[64:79], v[28:31], v[112:119], v6
    s_waitcnt lgkmcnt(0)
    ds_read_b128 v[28:31], v4 offset:7168
    v_exp_f32 v123, v123
    v_exp_f32 v124, v124
    v_exp_f32 v125, v125
    v_exp_f32 v126, v126
    v_exp_f32 v127, v127
    v_mfma_f32_32x32x16_bf16 v[80:95], v[24:27], v[16:19], 0
    s_mov_b32 s50, 0x20000000
    v_exp_f32 v96, v96
    v_exp_f32 v97, v97
    v_exp_f32 v98, v98
    v_exp_f32 v99, v99
    v_exp_f32 v100, v100
    v_exp_f32 v101, v101
    v_smfmac_f32_32x32x32_bf16 v[64:79], v[32:35], v[120:127], v6
    s_waitcnt lgkmcnt(0)
    ds_read_b128 v[32:35], v4 offset:7680
    v_exp_f32 v102, v102
    v_exp_f32 v103, v103
    v_exp_f32 v104, v104
    v_exp_f32 v105, v105
    v_exp_f32 v106, v106
    v_smfmac_f32_32x32x32_bf16 v[48:63], v[28:31], v[96:103], v6
    ds_read_b128 v[44:47], v3 offset:2048
    v_exp_f32 v107, v107
    v_exp_f32 v108, v108
    v_exp_f32 v109, v109
    v_exp_f32 v110, v110
    v_exp_f32 v111, v111
    v_mfma_f32_32x32x16_bf16 v[112:127], v[24:27], v[20:23], 0
    s_waitcnt lgkmcnt(1)
    v_exp_f32 v128, v128
    v_exp_f32 v129, v129
    v_exp_f32 v130, v130
    v_exp_f32 v131, v131
    v_exp_f32 v132, v132
    v_exp_f32 v133, v133
    v_smfmac_f32_32x32x32_bf16 v[48:63], v[32:35], v[104:111], v6
    v_and_or_b32 v4, s40, v5, v7
    v_exp_f32 v134, v134
    v_exp_f32 v135, v135
    v_exp_f32 v136, v136
    v_exp_f32 v137, v137
    v_exp_f32 v138, v138
    v_smfmac_f32_32x32x32_bf16 v[64:79], v[28:31], v[128:135], v6
    s_waitcnt lgkmcnt(0)
    ds_read_b128 v[28:31], v4 offset:1024
    v_exp_f32 v139, v139
    v_exp_f32 v140, v140
    v_exp_f32 v141, v141
    v_exp_f32 v142, v142
    v_exp_f32 v143, v143
    v_mfma_f32_32x32x16_bf16 v[96:111], v[44:47], v[16:19], 0
    v_exp_f32 v80, v80
    v_exp_f32 v81, v81
    v_exp_f32 v82, v82
    v_exp_f32 v83, v83
    v_exp_f32 v84, v84
    v_exp_f32 v85, v85
    v_smfmac_f32_32x32x32_bf16 v[64:79], v[32:35], v[136:143], v6
    s_waitcnt lgkmcnt(0)
    ds_read_b128 v[32:35], v4 offset:1536
    v_exp_f32 v86, v86
    v_exp_f32 v87, v87
    v_exp_f32 v88, v88
    v_exp_f32 v89, v89
    v_exp_f32 v90, v90
    v_smfmac_f32_32x32x32_bf16 v[48:63], v[28:31], v[80:87], v6
    ds_read_b128 v[24:27], v3 offset:4096
    v_exp_f32 v91, v91
    v_exp_f32 v92, v92
    v_exp_f32 v93, v93
    v_exp_f32 v94, v94
    v_exp_f32 v95, v95
    v_mfma_f32_32x32x16_bf16 v[128:143], v[44:47], v[20:23], 0
    s_waitcnt lgkmcnt(1)
    v_exp_f32 v112, v112
    v_exp_f32 v113, v113
    v_exp_f32 v114, v114
    v_exp_f32 v115, v115
    v_exp_f32 v116, v116
    v_exp_f32 v117, v117
    v_smfmac_f32_32x32x32_bf16 v[48:63], v[32:35], v[88:95], v6
    buffer_load_dwordx4 v2, s[28:31], s37 offen offset:1024 sc1 lds
    v_exp_f32 v118, v118
    v_exp_f32 v119, v119
    v_exp_f32 v120, v120
    v_exp_f32 v121, v121
    v_exp_f32 v122, v122
    v_smfmac_f32_32x32x32_bf16 v[64:79], v[28:31], v[112:119], v6
    s_waitcnt lgkmcnt(0)
    ds_read_b128 v[28:31], v4 offset:3072
    v_exp_f32 v123, v123
    v_exp_f32 v124, v124
    v_exp_f32 v125, v125
    v_exp_f32 v126, v126
    v_exp_f32 v127, v127
    v_mfma_f32_32x32x16_bf16 v[80:95], v[24:27], v[16:19], 0
    s_add_u32 s40, s40, 8192
    v_exp_f32 v96, v96
    v_exp_f32 v97, v97
    v_exp_f32 v98, v98
    v_exp_f32 v99, v99
    v_exp_f32 v100, v100
    v_exp_f32 v101, v101
    v_smfmac_f32_32x32x32_bf16 v[64:79], v[32:35], v[120:127], v6
    s_waitcnt lgkmcnt(0)
    ds_read_b128 v[32:35], v4 offset:3584
    v_exp_f32 v102, v102
    v_exp_f32 v103, v103
    v_exp_f32 v104, v104
    v_exp_f32 v105, v105
    v_exp_f32 v106, v106
    v_smfmac_f32_32x32x32_bf16 v[48:63], v[28:31], v[96:103], v6
    s_and_b32 s40, s40, 0xffff
    ds_read_b128 v[44:47], v3 offset:6144
    v_exp_f32 v107, v107
    v_exp_f32 v108, v108
    v_exp_f32 v109, v109
    v_exp_f32 v110, v110
    v_exp_f32 v111, v111
    v_mfma_f32_32x32x16_bf16 v[112:127], v[24:27], v[20:23], 0
    s_waitcnt lgkmcnt(1)
    v_exp_f32 v128, v128
    v_exp_f32 v129, v129
    v_exp_f32 v130, v130
    v_exp_f32 v131, v131
    v_exp_f32 v132, v132
    v_exp_f32 v133, v133
    v_smfmac_f32_32x32x32_bf16 v[48:63], v[32:35], v[104:111], v6
    buffer_load_dwordx4 v2, s[28:31], s37 offen offset:2048 sc1 lds
    v_or_b32 v3, s40, v2
    v_exp_f32 v134, v134
    v_exp_f32 v135, v135
    v_exp_f32 v136, v136
    v_exp_f32 v137, v137
    v_exp_f32 v138, v138
    v_smfmac_f32_32x32x32_bf16 v[64:79], v[28:31], v[128:135], v6
    s_waitcnt lgkmcnt(0)
    ds_read_b128 v[28:31], v4 offset:5120
    v_exp_f32 v139, v139
    v_exp_f32 v140, v140
    v_exp_f32 v141, v141
    v_exp_f32 v142, v142
    v_exp_f32 v143, v143
    v_mfma_f32_32x32x16_bf16 v[96:111], v[44:47], v[16:19], 0
    v_exp_f32 v80, v80
    v_exp_f32 v81, v81
    v_exp_f32 v82, v82
    v_exp_f32 v83, v83
    v_exp_f32 v84, v84
    v_exp_f32 v85, v85
    v_smfmac_f32_32x32x32_bf16 v[64:79], v[32:35], v[136:143], v6
    s_waitcnt lgkmcnt(0)
    ds_read_b128 v[32:35], v4 offset:5632
    v_exp_f32 v86, v86
    v_exp_f32 v87, v87
    v_exp_f32 v88, v88
    v_exp_f32 v89, v89
    v_exp_f32 v90, v90
    v_smfmac_f32_32x32x32_bf16 v[48:63], v[28:31], v[80:87], v6
    ds_read_b128 v[24:27], v3 offset:0
    v_exp_f32 v91, v91
    v_exp_f32 v92, v92
    v_exp_f32 v93, v93
    v_exp_f32 v94, v94
    v_exp_f32 v95, v95
    v_mfma_f32_32x32x16_bf16 v[128:143], v[44:47], v[20:23], 0
    s_waitcnt lgkmcnt(1)
    v_exp_f32 v112, v112
    v_exp_f32 v113, v113
    v_exp_f32 v114, v114
    v_exp_f32 v115, v115
    v_exp_f32 v116, v116
    v_exp_f32 v117, v117
    v_smfmac_f32_32x32x32_bf16 v[48:63], v[32:35], v[88:95], v6
    buffer_load_dwordx4 v2, s[28:31], s37 offen offset:3072 sc1 lds
    v_exp_f32 v118, v118
    v_exp_f32 v119, v119
    v_exp_f32 v120, v120
    v_exp_f32 v121, v121
    v_exp_f32 v122, v122
    v_smfmac_f32_32x32x32_bf16 v[64:79], v[28:31], v[112:119], v6
    s_waitcnt lgkmcnt(0)
    ds_read_b128 v[28:31], v4 offset:7168
    v_exp_f32 v123, v123
    v_exp_f32 v124, v124
    v_exp_f32 v125, v125
    v_exp_f32 v126, v126
    v_exp_f32 v127, v127
    v_mfma_f32_32x32x16_bf16 v[80:95], v[24:27], v[16:19], 0
    s_sub_u32 s39, s39, 1
    v_exp_f32 v96, v96
    v_exp_f32 v97, v97
    v_exp_f32 v98, v98
    v_exp_f32 v99, v99
    v_exp_f32 v100, v100
    v_exp_f32 v101, v101
    v_smfmac_f32_32x32x32_bf16 v[64:79], v[32:35], v[120:127], v6
    s_waitcnt lgkmcnt(0)
    ds_read_b128 v[32:35], v4 offset:7680
    v_exp_f32 v102, v102
    v_exp_f32 v103, v103
    v_exp_f32 v104, v104
    v_exp_f32 v105, v105
    v_exp_f32 v106, v106
    v_smfmac_f32_32x32x32_bf16 v[48:63], v[28:31], v[96:103], v6
    s_cmp_lg_u32 s39, 0
    ds_read_b128 v[44:47], v3 offset:2048
    v_exp_f32 v107, v107
    v_exp_f32 v108, v108
    v_exp_f32 v109, v109
    v_exp_f32 v110, v110
    v_exp_f32 v111, v111
    v_mfma_f32_32x32x16_bf16 v[112:127], v[24:27], v[20:23], 0
    s_waitcnt lgkmcnt(1)
    v_exp_f32 v128, v128
    v_exp_f32 v129, v129
    v_exp_f32 v130, v130
    v_exp_f32 v131, v131
    v_exp_f32 v132, v132
    v_exp_f32 v133, v133
    v_smfmac_f32_32x32x32_bf16 v[48:63], v[32:35], v[104:111], v6
    v_and_or_b32 v4, s40, v5, v7
    v_exp_f32 v134, v134
    v_exp_f32 v135, v135
    v_exp_f32 v136, v136
    v_exp_f32 v137, v137
    v_exp_f32 v138, v138
    v_smfmac_f32_32x32x32_bf16 v[64:79], v[28:31], v[128:135], v6
    s_waitcnt lgkmcnt(0)
    ds_read_b128 v[28:31], v4 offset:1024
    v_exp_f32 v139, v139
    v_exp_f32 v140, v140
    v_exp_f32 v141, v141
    v_exp_f32 v142, v142
    v_exp_f32 v143, v143
    s_cbranch_scc1 L_a_loop
    s_mov_b32 s39, 3
.p2align 6
L_a_loop2:
    v_mfma_f32_32x32x16_bf16 v[96:111], v[44:47], v[16:19], 0
    v_exp_f32 v80, v80
    v_exp_f32 v81, v81
    v_exp_f32 v82, v82
    v_exp_f32 v83, v83
    v_exp_f32 v84, v84
    v_exp_f32 v85, v85
    v_smfmac_f32_32x32x32_bf16 v[64:79], v[32:35], v[136:143], v6
    s_waitcnt lgkmcnt(0)
    ds_read_b128 v[32:35], v4 offset:1536
    v_exp_f32 v86, v86
    v_exp_f32 v87, v87
    v_exp_f32 v88, v88
    v_exp_f32 v89, v89
    v_exp_f32 v90, v90
    v_smfmac_f32_32x32x32_bf16 v[48:63], v[28:31], v[80:87], v6
    ds_read_b128 v[24:27], v3 offset:4096
    v_exp_f32 v91, v91
    v_exp_f32 v92, v92
    v_exp_f32 v93, v93
    v_exp_f32 v94, v94
    v_exp_f32 v95, v95
    v_mfma_f32_32x32x16_bf16 v[128:143], v[44:47], v[20:23], 0
    s_waitcnt lgkmcnt(1)
    v_exp_f32 v112, v112
    v_exp_f32 v113, v113
    v_exp_f32 v114, v114
    v_exp_f32 v115, v115
    v_exp_f32 v116, v116
    v_exp_f32 v117, v117
    v_smfmac_f32_32x32x32_bf16 v[48:63], v[32:35], v[88:95], v6
    v_exp_f32 v118, v118
    v_exp_f32 v119, v119
    v_exp_f32 v120, v120
    v_exp_f32 v121, v121
    v_exp_f32 v122, v122
    v_smfmac_f32_32x32x32_bf16 v[64:79], v[28:31], v[112:119], v6
    s_waitcnt lgkmcnt(0)
    ds_read_b128 v[28:31], v4 offset:3072
    v_exp_f32 v123, v123
    v_exp_f32 v124, v124
    v_exp_f32 v125, v125
    v_exp_f32 v126, v126
    v_exp_f32 v127, v127
    v_mfma_f32_32x32x16_bf16 v[80:95], v[24:27], v[16:19], 0
    s_add_u32 s40, s40, 8192
    v_exp_f32 v96, v96
    v_exp_f32 v97, v97
    v_exp_f32 v98, v98
    v_exp_f32 v99, v99
    v_exp_f32 v100, v100
    v_exp_f32 v101, v101
    v_smfmac_f32_32x32x32_bf16 v[64:79], v[32:35], v[120:127], v6
    s_waitcnt lgkmcnt(0)
    ds_read_b128 v[32:35], v4 offset:3584
    v_exp_f32 v102, v102
    v_exp_f32 v103, v103
    v_exp_f32 v104, v104
    v_exp_f32 v105, v105
    v_exp_f32 v106, v106
    v_smfmac_f32_32x32x32_bf16 v[48:63], v[28:31], v[96:103], v6
    s_and_b32 s40, s40, 0xffff
    ds_read_b128 v[44:47], v3 offset:6144
    v_exp_f32 v107, v107
    v_exp_f32 v108, v108
    v_exp_f32 v109, v109
    v_exp_f32 v110, v110
    v_exp_f32 v111, v111
    v_mfma_f32_32x32x16_bf16 v[112:127], v[24:27], v[20:23], 0
    s_waitcnt lgkmcnt(1)
    v_exp_f32 v128, v128
    v_exp_f32 v129, v129
    v_exp_f32 v130, v130
    v_exp_f32 v131, v131
    v_exp_f32 v132, v132
    v_exp_f32 v133, v133
    v_smfmac_f32_32x32x32_bf16 v[48:63], v[32:35], v[104:111], v6
    v_or_b32 v3, s40, v2
    v_exp_f32 v134, v134
    v_exp_f32 v135, v135
    v_exp_f32 v136, v136
    v_exp_f32 v137, v137
    v_exp_f32 v138, v138
    v_smfmac_f32_32x32x32_bf16 v[64:79], v[28:31], v[128:135], v6
    s_waitcnt lgkmcnt(0)
    ds_read_b128 v[28:31], v4 offset:5120
    v_exp_f32 v139, v139
    v_exp_f32 v140, v140
    v_exp_f32 v141, v141
    v_exp_f32 v142, v142
    v_exp_f32 v143, v143
    v_mfma_f32_32x32x16_bf16 v[96:111], v[44:47], v[16:19], 0
    v_exp_f32 v80, v80
    v_exp_f32 v81, v81
    v_exp_f32 v82, v82
    v_exp_f32 v83, v83
    v_exp_f32 v84, v84
    v_exp_f32 v85, v85
    v_smfmac_f32_32x32x32_bf16 v[64:79], v[32:35], v[136:143], v6
    s_waitcnt lgkmcnt(0)
    ds_read_b128 v[32:35], v4 offset:5632
    v_exp_f32 v86, v86
    v_exp_f32 v87, v87
    v_exp_f32 v88, v88
    v_exp_f32 v89, v89
    v_exp_f32 v90, v90
    v_smfmac_f32_32x32x32_bf16 v[48:63], v[28:31], v[80:87], v6
    ds_read_b128 v[24:27], v3 offset:0
    v_exp_f32 v91, v91
    v_exp_f32 v92, v92
    v_exp_f32 v93, v93
    v_exp_f32 v94, v94
    v_exp_f32 v95, v95
    v_mfma_f32_32x32x16_bf16 v[128:143], v[44:47], v[20:23], 0
    s_waitcnt lgkmcnt(1)
    v_exp_f32 v112, v112
    v_exp_f32 v113, v113
    v_exp_f32 v114, v114
    v_exp_f32 v115, v115
    v_exp_f32 v116, v116
    v_exp_f32 v117, v117
    v_smfmac_f32_32x32x32_bf16 v[48:63], v[32:35], v[88:95], v6
    v_exp_f32 v118, v118
    v_exp_f32 v119, v119
    v_exp_f32 v120, v120
    v_exp_f32 v121, v121
    v_exp_f32 v122, v122
    v_smfmac_f32_32x32x32_bf16 v[64:79], v[28:31], v[112:119], v6
    s_waitcnt lgkmcnt(0)
    ds_read_b128 v[28:31], v4 offset:7168
    v_exp_f32 v123, v123
    v_exp_f32 v124, v124
    v_exp_f32 v125, v125
    v_exp_f32 v126, v126
    v_exp_f32 v127, v127
    v_mfma_f32_32x32x16_bf16 v[80:95], v[24:27], v[16:19], 0
    v_exp_f32 v96, v96
    v_exp_f32 v97, v97
    v_exp_f32 v98, v98
    v_exp_f32 v99, v99
    v_exp_f32 v100, v100
    v_exp_f32 v101, v101
    v_smfmac_f32_32x32x32_bf16 v[64:79], v[32:35], v[120:127], v6
    s_waitcnt lgkmcnt(0)
    ds_read_b128 v[32:35], v4 offset:7680
    v_exp_f32 v102, v102
    v_exp_f32 v103, v103
    v_exp_f32 v104, v104
    v_exp_f32 v105, v105
    v_exp_f32 v106, v106
    v_smfmac_f32_32x32x32_bf16 v[48:63], v[28:31], v[96:103], v6
    ds_read_b128 v[44:47], v3 offset:2048
    v_exp_f32 v107, v107
    v_exp_f32 v108, v108
    v_exp_f32 v109, v109
    v_exp_f32 v110, v110
    v_exp_f32 v111, v111
    v_mfma_f32_32x32x16_bf16 v[112:127], v[24:27], v[20:23], 0
    s_waitcnt lgkmcnt(1)
    v_exp_f32 v128, v128
    v_exp_f32 v129, v129
    v_exp_f32 v130, v130
    v_exp_f32 v131, v131
    v_exp_f32 v132, v132
    v_exp_f32 v133, v133
    v_smfmac_f32_32x32x32_bf16 v[48:63], v[32:35], v[104:111], v6
    v_and_or_b32 v4, s40, v5, v7
    v_exp_f32 v134, v134
    v_exp_f32 v135, v135
    v_exp_f32 v136, v136
    v_exp_f32 v137, v137
    v_exp_f32 v138, v138
    v_smfmac_f32_32x32x32_bf16 v[64:79], v[28:31], v[128:135], v6
    s_waitcnt lgkmcnt(0)
    ds_read_b128 v[28:31], v4 offset:1024
    v_exp_f32 v139, v139
    v_exp_f32 v140, v140
    v_exp_f32 v141, v141
    v_exp_f32 v142, v142
    v_exp_f32 v143, v143
    v_mfma_f32_32x32x16_bf16 v[96:111], v[44:47], v[16:19], 0
    v_exp_f32 v80, v80
    v_exp_f32 v81, v81
    v_exp_f32 v82, v82
    v_exp_f32 v83, v83
    v_exp_f32 v84, v84
    v_exp_f32 v85, v85
    v_smfmac_f32_32x32x32_bf16 v[64:79], v[32:35], v[136:143], v6
    s_waitcnt lgkmcnt(0)
    ds_read_b128 v[32:35], v4 offset:1536
    v_exp_f32 v86, v86
    v_exp_f32 v87, v87
    v_exp_f32 v88, v88
    v_exp_f32 v89, v89
    v_exp_f32 v90, v90
    v_smfmac_f32_32x32x32_bf16 v[48:63], v[28:31], v[80:87], v6
    s_waitcnt vmcnt(0)
    s_barrier
    ds_read_b128 v[24:27], v3 offset:4096
    v_exp_f32 v91, v91
    v_exp_f32 v92, v92
    v_exp_f32 v93, v93
    v_exp_f32 v94, v94
    v_exp_f32 v95, v95
    v_mfma_f32_32x32x16_bf16 v[128:143], v[44:47], v[20:23], 0
    s_waitcnt lgkmcnt(1)
    v_exp_f32 v112, v112
    v_exp_f32 v113, v113
    v_exp_f32 v114, v114
    v_exp_f32 v115, v115
    v_exp_f32 v116, v116
    v_exp_f32 v117, v117
    v_smfmac_f32_32x32x32_bf16 v[48:63], v[32:35], v[88:95], v6
    v_exp_f32 v118, v118
    v_exp_f32 v119, v119
    v_exp_f32 v120, v120
    v_exp_f32 v121, v121
    v_exp_f32 v122, v122
    v_smfmac_f32_32x32x32_bf16 v[64:79], v[28:31], v[112:119], v6
    s_waitcnt lgkmcnt(0)
    ds_read_b128 v[28:31], v4 offset:3072
    v_exp_f32 v123, v123
    v_exp_f32 v124, v124
    v_exp_f32 v125, v125
    v_exp_f32 v126, v126
    v_exp_f32 v127, v127
    v_mfma_f32_32x32x16_bf16 v[80:95], v[24:27], v[16:19], 0
    s_add_u32 s40, s40, 8192
    v_exp_f32 v96, v96
    v_exp_f32 v97, v97
    v_exp_f32 v98, v98
    v_exp_f32 v99, v99
    v_exp_f32 v100, v100
    v_exp_f32 v101, v101
    v_smfmac_f32_32x32x32_bf16 v[64:79], v[32:35], v[120:127], v6
    s_waitcnt lgkmcnt(0)
    ds_read_b128 v[32:35], v4 offset:3584
    v_exp_f32 v102, v102
    v_exp_f32 v103, v103
    v_exp_f32 v104, v104
    v_exp_f32 v105, v105
    v_exp_f32 v106, v106
    v_smfmac_f32_32x32x32_bf16 v[48:63], v[28:31], v[96:103], v6
    s_and_b32 s40, s40, 0xffff
    ds_read_b128 v[44:47], v3 offset:6144
    v_exp_f32 v107, v107
    v_exp_f32 v108, v108
    v_exp_f32 v109, v109
    v_exp_f32 v110, v110
    v_exp_f32 v111, v111
    v_mfma_f32_32x32x16_bf16 v[112:127], v[24:27], v[20:23], 0
    s_waitcnt lgkmcnt(1)
    v_exp_f32 v128, v128
    v_exp_f32 v129, v129
    v_exp_f32 v130, v130
    v_exp_f32 v131, v131
    v_exp_f32 v132, v132
    v_exp_f32 v133, v133
    v_smfmac_f32_32x32x32_bf16 v[48:63], v[32:35], v[104:111], v6
    v_or_b32 v3, s40, v2
    v_exp_f32 v134, v134
    v_exp_f32 v135, v135
    v_exp_f32 v136, v136
    v_exp_f32 v137, v137
    v_exp_f32 v138, v138
    v_smfmac_f32_32x32x32_bf16 v[64:79], v[28:31], v[128:135], v6
    s_waitcnt lgkmcnt(0)
    ds_read_b128 v[28:31], v4 offset:5120
    v_exp_f32 v139, v139
    v_exp_f32 v140, v140
    v_exp_f32 v141, v141
    v_exp_f32 v142, v142
    v_exp_f32 v143, v143
    v_mfma_f32_32x32x16_bf16 v[96:111], v[44:47], v[16:19], 0
    v_exp_f32 v80, v80
    v_exp_f32 v81, v81
    v_exp_f32 v82, v82
    v_exp_f32 v83, v83
    v_exp_f32 v84, v84
    v_exp_f32 v85, v85
    v_smfmac_f32_32x32x32_bf16 v[64:79], v[32:35], v[136:143], v6
    s_waitcnt lgkmcnt(0)
    ds_read_b128 v[32:35], v4 offset:5632
    v_exp_f32 v86, v86
    v_exp_f32 v87, v87
    v_exp_f32 v88, v88
    v_exp_f32 v89, v89
    v_exp_f32 v90, v90
    v_smfmac_f32_32x32x32_bf16 v[48:63], v[28:31], v[80:87], v6
    ds_read_b128 v[24:27], v3 offset:0
    v_exp_f32 v91, v91
    v_exp_f32 v92, v92
    v_exp_f32 v93, v93
    v_exp_f32 v94, v94
    v_exp_f32 v95, v95
    v_mfma_f32_32x32x16_bf16 v[128:143], v[44:47], v[20:23], 0
    s_waitcnt lgkmcnt(1)
    v_exp_f32 v112, v112
    v_exp_f32 v113, v113
    v_exp_f32 v114, v114
    v_exp_f32 v115, v115
    v_exp_f32 v116, v116
    v_exp_f32 v117, v117
    v_smfmac_f32_32x32x32_bf16 v[48:63], v[32:35], v[88:95], v6
    v_exp_f32 v118, v118
    v_exp_f32 v119, v119
    v_exp_f32 v120, v120
    v_exp_f32 v121, v121
    v_exp_f32 v122, v122
    v_smfmac_f32_32x32x32_bf16 v[64:79], v[28:31], v[112:119], v6
    s_waitcnt lgkmcnt(0)
    ds_read_b128 v[28:31], v4 offset:7168
    v_exp_f32 v123, v123
    v_exp_f32 v124, v124
    v_exp_f32 v125, v125
    v_exp_f32 v126, v126
    v_exp_f32 v127, v127
    v_mfma_f32_32x32x16_bf16 v[80:95], v[24:27], v[16:19], 0
    s_sub_u32 s39, s39, 1
    v_exp_f32 v96, v96
    v_exp_f32 v97, v97
    v_exp_f32 v98, v98
    v_exp_f32 v99, v99
    v_exp_f32 v100, v100
    v_exp_f32 v101, v101
    v_smfmac_f32_32x32x32_bf16 v[64:79], v[32:35], v[120:127], v6
    s_waitcnt lgkmcnt(0)
    ds_read_b128 v[32:35], v4 offset:7680
    v_exp_f32 v102, v102
    v_exp_f32 v103, v103
    v_exp_f32 v104, v104
    v_exp_f32 v105, v105
    v_exp_f32 v106, v106
    v_smfmac_f32_32x32x32_bf16 v[48:63], v[28:31], v[96:103], v6
    s_cmp_lg_u32 s39, 0
    ds_read_b128 v[44:47], v3 offset:2048
    v_exp_f32 v107, v107
    v_exp_f32 v108, v108
    v_exp_f32 v109, v109
    v_exp_f32 v110, v110
    v_exp_f32 v111, v111
    v_mfma_f32_32x32x16_bf16 v[112:127], v[24:27], v[20:23], 0
    s_waitcnt lgkmcnt(1)
    v_exp_f32 v128, v128
    v_exp_f32 v129, v129
    v_exp_f32 v130, v130
    v_exp_f32 v131, v131
    v_exp_f32 v132, v132
    v_exp_f32 v133, v133
    v_smfmac_f32_32x32x32_bf16 v[48:63], v[32:35], v[104:111], v6
    v_and_or_b32 v4, s40, v5, v7
    v_exp_f32 v134, v134
    v_exp_f32 v135, v135
    v_exp_f32 v136, v136
    v_exp_f32 v137, v137
    v_exp_f32 v138, v138
    v_smfmac_f32_32x32x32_bf16 v[64:79], v[28:31], v[128:135], v6
    s_waitcnt lgkmcnt(0)
    ds_read_b128 v[28:31], v4 offset:1024
    v_exp_f32 v139, v139
    v_exp_f32 v140, v140
    v_exp_f32 v141, v141
    v_exp_f32 v142, v142
    v_exp_f32 v143, v143
    s_cbranch_scc1 L_a_loop2
    s_nop 1
    v_smfmac_f32_32x32x32_bf16 v[64:79], v[32:35], v[136:143], v6
    s_mov_b32 s44, 0x30800000
    s_mov_b32 s46, 0x5d800000
    s_nop 0
    v_mov_b32 v8, 0x1f8
    v_rcp_f32 v88, v56
    v_cmp_le_f32 s[6:7], s44, v56
    v_cmp_ge_f32 s[8:9], s46, v56
    v_mul_f32 v80, v48, v88
    v_mul_f32 v81, v49, v88
    v_mul_f32 v82, v50, v88
    v_mul_f32 v83, v51, v88
    v_mul_f32 v84, v52, v88
    v_mul_f32 v85, v53, v88
    v_mul_f32 v86, v54, v88
    v_mul_f32 v87, v55, v88
    v_cvt_pk_bf16_f32 v92, v80, v81
    v_cvt_pk_bf16_f32 v93, v82, v83
    v_cvt_pk_bf16_f32 v94, v84, v85
    v_cvt_pk_bf16_f32 v95, v86, v87
    v_fma_f32 v89, v80, 0, v81
    v_fma_f32 v90, v82, 0, v83
    v_fma_f32 v91, v84, 0, v85
    v_fma_f32 v88, v86, 0, v87
    v_fma_f32 v89, v89, 0, v90
    v_fma_f32 v91, v91, 0, v88
    v_fma_f32 v89, v89, 0, v91
    v_min_u32 v92, -2, v92
    v_min_u32 v93, -2, v93
    v_min_u32 v94, -2, v94
    v_min_u32 v95, -2, v95
    v_cmp_class_f32 s[14:15], v89, v8
    v_rcp_f32 v104, v72
    v_cmp_le_f32 s[10:11], s44, v72
    v_cmp_ge_f32 s[12:13], s46, v72
    v_mul_f32 v96, v64, v104
    v_mul_f32 v97, v65, v104
    v_mul_f32 v98, v66, v104
    v_mul_f32 v99, v67, v104
    v_mul_f32 v100, v68, v104
    v_mul_f32 v101, v69, v104
    v_mul_f32 v102, v70, v104
    v_mul_f32 v103, v71, v104
    v_cvt_pk_bf16_f32 v108, v96, v97
    v_cvt_pk_bf16_f32 v109, v98, v99
    v_cvt_pk_bf16_f32 v110, v100, v101
    v_cvt_pk_bf16_f32 v111, v102, v103
    v_fma_f32 v105, v96, 0, v97
    v_fma_f32 v106, v98, 0, v99
    v_fma_f32 v107, v100, 0, v101
    v_fma_f32 v104, v102, 0, v103
    v_fma_f32 v105, v105, 0, v106
    v_fma_f32 v107, v107, 0, v104
    v_fma_f32 v105, v105, 0, v107
    v_min_u32 v108, -2, v108
    v_min_u32 v109, -2, v109
    v_min_u32 v110, -2, v110
    v_min_u32 v111, -2, v111
    v_cmp_class_f32 s[16:17], v105, v8
    s_and_b64 s[6:7], s[6:7], s[8:9]
    s_and_b64 s[10:11], s[10:11], s[12:13]
    s_and_b64 s[6:7], s[6:7], s[10:11]
    s_and_b64 s[6:7], s[6:7], s[14:15]
    s_and_b64 s[6:7], s[6:7], s[16:17]
    s_cmp_eq_u64 s[6:7], -1
    s_cbranch_scc0 L_a_slow
L_a_fin:
    buffer_store_dwordx4 v[92:95], v2, s[28:31], s48 offen sc1
    buffer_store_dwordx4 v[108:111], v2, s[28:31], s49 offen sc1
L_end:
    s_endpgm
L_code_end:
L_a_poll:
    buffer_load_dword v9, v8, s[28:31], 0 offen sc1
    s_waitcnt vmcnt(0)
    v_xor_b32 v9, s33, v9
    v_cmp_ne_u32 s[6:7], 0, v9
    s_nop 3
    s_cmp_eq_u64 s[6:7], 0
    s_cbranch_scc1 L_a_poll_done
    s_sleep 2
    s_sub_u32 s3, s3, 1
    s_cbranch_scc0 L_a_poll
    s_mov_b32 s3, 0
    s_branch L_a_poll_done
L_a_slow:
    s_waitcnt lgkmcnt(0)
    s_sub_u32 s38, s38, s43
    s_mov_b32 s36, s38
    s_mov_b32 s39, 64
    v_mov_b32 v8, 0xff800000
    v_mov_b32 v9, 0xff800000
L_a_s1:
    buffer_load_dwordx4 v[24:27], v2, s[28:31], s36 offen sc1
    s_waitcnt vmcnt(0)
    v_mfma_f32_32x32x16_bf16 v[80:95], v[24:27], v[16:19], 0
    v_mfma_f32_32x32x16_bf16 v[112:127], v[24:27], v[20:23], 0
    s_nop 15
    s_nop 3
    v_max3_f32 v8, v8, v80, v81
    v_max3_f32 v8, v8, v82, v83
    v_max3_f32 v8, v8, v84, v85
    v_max3_f32 v8, v8, v86, v87
    v_max3_f32 v8, v8, v88, v89
    v_max3_f32 v8, v8, v90, v91
    v_max3_f32 v8, v8, v92, v93
    v_max3_f32 v8, v8, v94, v95
    v_max3_f32 v9, v9, v112, v113
    v_max3_f32 v9, v9, v114, v115
    v_max3_f32 v9, v9, v116, v117
    v_max3_f32 v9, v9, v118, v119
    v_max3_f32 v9, v9, v120, v121
    v_max3_f32 v9, v9, v122, v123
    v_max3_f32 v9, v9, v124, v125
    v_max3_f32 v9, v9, v126, v127
    s_add_u32 s36, s36, 2048
    s_sub_u32 s39, s39, 1
    s_cmp_lg_u32 s39, 0
    s_cbranch_scc1 L_a_s1
    v_mov_b32 v10, v8
    v_mov_b32 v11, v9
    s_nop 1
    v_permlane32_swap_b32 v8, v10
    v_permlane32_swap_b32 v9, v11
    s_nop 1
    v_max_f32 v8, v8, v10
    v_max_f32 v9, v9, v11
    v_sub_f32 v96, 0, v8
    v_mov_b32 v48, 0
    v_sub_f32 v97, 0, v8
    v_mov_b32 v49, 0
    v_sub_f32 v98, 0, v8
    v_mov_b32 v50, 0
    v_sub_f32 v99, 0, v8
    v_mov_b32 v51, 0
    v_sub_f32 v100, 0, v8
    v_mov_b32 v52, 0
    v_sub_f32 v101, 0, v8
    v_mov_b32 v53, 0
    v_sub_f32 v102, 0, v8
    v_mov_b32 v54, 0
    v_sub_f32 v103, 0, v8
    v_mov_b32 v55, 0
    v_sub_f32 v104, 0, v8
    v_mov_b32 v56, 0
    v_sub_f32 v105, 0, v8
    v_mov_b32 v57, 0
    v_sub_f32 v106, 0, v8
    v_mov_b32 v58, 0
    v_sub_f32 v107, 0, v8
    v_mov_b32 v59, 0
    v_sub_f32 v108, 0, v8
    v_mov_b32 v60, 0
    v_sub_f32 v109, 0, v8
    v_mov_b32 v61, 0
    v_sub_f32 v110, 0, v8
    v_mov_b32 v62, 0
    v_sub_f32 v111, 0, v8
    v_mov_b32 v63, 0
    v_sub_f32 v128, 0, v9
    v_mov_b32 v64, 0
    v_sub_f32 v129, 0, v9
    v_mov_b32 v65, 0
    v_sub_f32 v130, 0, v9
    v_mov_b32 v66, 0
    v_sub_f32 v131, 0, v9
    v_mov_b32 v67, 0
    v_sub_f32 v132, 0, v9
    v_mov_b32 v68, 0
    v_sub_f32 v133, 0, v9
    v_mov_b32 v69, 0
    v_sub_f32 v134, 0, v9
    v_mov_b32 v70, 0
    v_sub_f32 v135, 0, v9
    v_mov_b32 v71, 0
    v_sub_f32 v136, 0, v9
    v_mov_b32 v72, 0
    v_sub_f32 v137, 0, v9
    v_mov_b32 v73, 0
    v_sub_f32 v138, 0, v9
    v_mov_b32 v74, 0
    v_sub_f32 v139, 0, v9
    v_mov_b32 v75, 0
    v_sub_f32 v140, 0, v9
    v_mov_b32 v76, 0
    v_sub_f32 v141, 0, v9
    v_mov_b32 v77, 0
    v_sub_f32 v142, 0, v9
    v_mov_b32 v78, 0
    v_sub_f32 v143, 0, v9
    v_mov_b32 v79, 0
    s_mov_b32 s36, s38
    s_mov_b32 s39, 64
L_a_s2:
    buffer_load_dwordx4 v[24:27], v2, s[28:31], s36 offen sc1
    s_mov_b32 exec_lo, 0xffff
    s_mov_b32 exec_hi, 0xffff
    buffer_load_dwordx4 v[28:31], v7, s[28:31], s36 offen offset:1024 sc1
    buffer_load_dwordx4 v[32:35], v7, s[28:31], s36 offen offset:1536 sc1
    s_mov_b64 exec, -1
    s_waitcnt vmcnt(0)
    v_mfma_f32_32x32x16_bf16 v[80:95], v[24:27], v[16:19], v[96:111]
    v_mfma_f32_32x32x16_bf16 v[112:127], v[24:27], v[20:23], v[128:143]
    s_nop 15
    s_nop 3
    v_exp_f32 v80, v80
    v_exp_f32 v81, v81
    v_exp_f32 v82, v82
    v_exp_f32 v83, v83
    v_exp_f32 v84, v84
    v_exp_f32 v85, v85
    v_exp_f32 v86, v86
    v_exp_f32 v87, v87
    v_exp_f32 v88, v88
    v_exp_f32 v89, v89
    v_exp_f32 v90, v90
    v_exp_f32 v91, v91
    v_exp_f32 v92, v92
    v_exp_f32 v93, v93
    v_exp_f32 v94, v94
    v_exp_f32 v95, v95
    v_exp_f32 v112, v112
    v_exp_f32 v113, v113
    v_exp_f32 v114, v114
    v_exp_f32 v115, v115
    v_exp_f32 v116, v116
    v_exp_f32 v117, v117
    v_exp_f32 v118, v118
    v_exp_f32 v119, v119
    v_exp_f32 v120, v120
    v_exp_f32 v121, v121
    v_exp_f32 v122, v122
    v_exp_f32 v123, v123
    v_exp_f32 v124, v124
    v_exp_f32 v125, v125
    v_exp_f32 v126, v126
    v_exp_f32 v127, v127
    s_nop 1
    v_smfmac_f32_32x32x32_bf16 v[48:63], v[28:31], v[80:87], v6
    v_smfmac_f32_32x32x32_bf16 v[48:63], v[32:35], v[88:95], v6
    v_smfmac_f32_32x32x32_bf16 v[64:79], v[28:31], v[112:119], v6
    v_smfmac_f32_32x32x32_bf16 v[64:79], v[32:35], v[120:127], v6
    s_add_u32 s36, s36, 2048
    s_sub_u32 s39, s39, 1
    s_cmp_lg_u32 s39, 0
    s_nop 15
    s_cbranch_scc1 L_a_s2
    s_nop 15
    v_rcp_f32 v88, v56
    s_nop 0
    v_mul_f32 v80, v48, v88
    v_mul_f32 v81, v49, v88
    v_mul_f32 v82, v50, v88
    v_mul_f32 v83, v51, v88
    v_mul_f32 v84, v52, v88
    v_mul_f32 v85, v53, v88
    v_mul_f32 v86, v54, v88
    v_mul_f32 v87, v55, v88
    v_cvt_pk_bf16_f32 v92, v80, v81
    v_cvt_pk_bf16_f32 v93, v82, v83
    v_cvt_pk_bf16_f32 v94, v84, v85
    v_cvt_pk_bf16_f32 v95, v86, v87
    v_min_u32 v92, -2, v92
    v_min_u32 v93, -2, v93
    v_min_u32 v94, -2, v94
    v_min_u32 v95, -2, v95
    v_rcp_f32 v104, v72
    s_nop 0
    v_mul_f32 v96, v64, v104
    v_mul_f32 v97, v65, v104
    v_mul_f32 v98, v66, v104
    v_mul_f32 v99, v67, v104
    v_mul_f32 v100, v68, v104
    v_mul_f32 v101, v69, v104
    v_mul_f32 v102, v70, v104
    v_mul_f32 v103, v71, v104
    v_cvt_pk_bf16_f32 v108, v96, v97
    v_cvt_pk_bf16_f32 v109, v98, v99
    v_cvt_pk_bf16_f32 v110, v100, v101
    v_cvt_pk_bf16_f32 v111, v102, v103
    v_min_u32 v108, -2, v108
    v_min_u32 v109, -2, v109
    v_min_u32 v110, -2, v110
    v_min_u32 v111, -2, v111
    s_branch L_a_fin
.section .rodata,"a"
.p2align 6
.amdhsa_kernel parallel_sum__mha_block__glu_gated_swiglu__prompt_kernel
  .amdhsa_next_free_vgpr 256
  .amdhsa_next_free_sgpr 102
  .amdhsa_accum_offset 256
  .amdhsa_group_segment_fixed_size 0
  .amdhsa_kernarg_size 80
  .amdhsa_user_sgpr_count 2
  .amdhsa_user_sgpr_kernarg_segment_ptr 1
  .amdhsa_system_sgpr_workgroup_id_x 1
  .amdhsa_float_denorm_mode_32 3
.end_amdhsa_kernel
```
